```python
import torch

def _softmax(x, axis=-1):
    return torch.softmax(x, dim=axis)

def _gelu(x):
    return torch.nn.functional.gelu(x, approximate='tanh')

def _silu(x):
    return torch.nn.functional.silu(x)

def _sigmoid(x):
    return torch.sigmoid(x)

def _layernorm(x, axis=-1, eps=1e-05):
    m = x.mean(dim=axis, keepdim=True)
    v = x.var(dim=axis, keepdim=True, unbiased=False)
    return (x - m) / torch.sqrt(v + eps)

def _scatter_add(tgt, idx, src, axis=0):
    return tgt.clone().index_add_(axis, idx, src)

def _segment_sum(src, seg, n):
    out = torch.zeros((n,) + src.shape[1:], dtype=src.dtype)
    return out.index_add_(0, seg, src)

def _pad(x, pw):
    flat = tuple((v for pair in reversed(pw) for v in pair))
    return torch.nn.functional.pad(x, flat)
kernel_name = 'gated_mix__memory_aug_recurrent_mem_tr__dense_activation_silu__prompt'

def setup_inputs():

    _w = lambda a: (lambda t: t.to(torch.bfloat16) if t.is_floating_point() else t)(torch.as_tensor(a))

    def _A_setup():
        B, S, Dm = (1, 2048, 512)
        H, Dh = (32, 128)
        M, seg = (8, 32)
        seg = min(seg, S)
        S = S // seg * seg
        return {'x': _w((lambda *s: torch.randn(*s, dtype=torch.bfloat16) * 0.05)(B, S, Dm)), 'mem0': _w((lambda *s: torch.randn(*s, dtype=torch.bfloat16) * 0.4)(B, M, Dm)), 'Wq': _w((lambda *s: torch.randn(*s, dtype=torch.bfloat16) * 6.4)(Dm, H, Dh) * Dm ** (-0.5)), 'Wk': _w((lambda *s: torch.randn(*s, dtype=torch.bfloat16) * 6.4)(Dm, H, Dh) * Dm ** (-0.5)), 'Wv': _w((lambda *s: torch.randn(*s, dtype=torch.bfloat16) * 0.4)(Dm, H, Dh) * Dm ** (-0.5)), 'Wo': _w((lambda *s: torch.randn(*s, dtype=torch.bfloat16) * 0.4)(H, Dh, Dm) * (H * Dh) ** (-0.5)), 'seg_len': seg}
    _A_in = _A_setup()

    def _B_setup():
        B, S, D, F = (1, 2048, 512, 1376)
        return {'x': _w((lambda *s: torch.randn(*s, dtype=torch.bfloat16) * 0.05)(B, S, D)), 'w1': _w((lambda *s: torch.randn(*s, dtype=torch.bfloat16) * 3.2)(D, F) * D ** (-0.5)), 'w2': _w((lambda *s: torch.randn(*s, dtype=torch.bfloat16) * 0.2)(F, D) * F ** (-0.5))}
    _B_in = _B_setup()
    return {'A_x': _A_in['x'], 'A_mem0': _A_in['mem0'], 'A_Wq': _A_in['Wq'], 'A_Wk': _A_in['Wk'], 'A_Wv': _A_in['Wv'], 'A_Wo': _A_in['Wo'], 'A_seg_len': _A_in['seg_len'], 'B_x': _B_in['x'], 'B_w1': _B_in['w1'], 'B_w2': _B_in['w2'], 'gate_w': _w((lambda *s: torch.randn(*s, dtype=torch.bfloat16) * 0.05)(512) * 16.0)}

def reference(A_x, A_mem0, A_Wq, A_Wk, A_Wv, A_Wo, A_seg_len, B_x, B_w1, B_w2, gate_w):

    def _A_ref(x, mem0, Wq, Wk, Wv, Wo, seg_len):
        B, S, Dm = x.shape
        H, Dh = (Wq.shape[1], Wq.shape[2])
        M = mem0.shape[1]
        scale = Dh ** (-0.5)
        n_seg = S // seg_len
        L = M + seg_len
        idx = torch.arange(L)
        mask = (idx[:, None] < M) | (idx[:, None] >= idx[None, :])
        mem = mem0
        outs = []
        for s in range(n_seg):
            xs = x[:, s * seg_len:(s + 1) * seg_len, :].clone()
            h = torch.concatenate([mem, xs], axis=1)
            q = torch.einsum('btd,dhe->bhte', h, Wq)
            k = torch.einsum('btd,dhe->bhte', h, Wk)
            v = torch.einsum('btd,dhe->bhte', h, Wv)
            scores = torch.einsum('bhqe,bhke->bhqk', q, k) * scale
            scores = torch.where(mask[None, None], scores, -1000000000.0)
            p = _softmax(scores, axis=-1)
            o = torch.einsum('bhqk,bhke->bhqe', p, v)
            o = torch.einsum('bhte,hed->btd', o, Wo)
            mem = o[:, :M, :].clone()
            outs.append(o[:, M:, :])
        return torch.concatenate(outs, axis=1)

    def _B_ref(x, w1, w2):
        h = torch.einsum('bsd,df->bsf', x, w1)
        h = _silu(h)
        out = torch.einsum('bsf,fd->bsd', h, w2)
        return out
    x = A_x
    g = _sigmoid((x * gate_w).sum(-1, keepdims=True))
    a = _A_ref(x, A_mem0, A_Wq, A_Wk, A_Wv, A_Wo, A_seg_len)
    b = _B_ref(x, B_w1, B_w2)
    return g * a + (1 - g) * b
```

```asm
; @launch grid=(256,1,1) block=(256,1,1) lds=163840
.amdgcn_target "amdgcn-amd-amdhsa--gfx950"
.text
.globl gated_mix__memory_aug_recurrent_mem_tr__dense_activation_silu__prompt_kernel
.p2align 8
.type gated_mix__memory_aug_recurrent_mem_tr__dense_activation_silu__prompt_kernel,@function
gated_mix__memory_aug_recurrent_mem_tr__dense_activation_silu__prompt_kernel:
s_cmp_ge_u32 s2, 256
s_cbranch_scc1 L_exit
s_load_dwordx4 s[4:7], s[0:1], 0
s_load_dwordx4 s[8:11], s[0:1], 16
s_load_dwordx4 s[12:15], s[0:1], 32
s_load_dwordx4 s[16:19], s[0:1], 64
s_load_dwordx4 s[20:23], s[0:1], 80
s_load_dwordx4 s[24:27], s[0:1], 96
s_getreg_b32 s28, hwreg(HW_REG_XCC_ID, 0, 4)
v_lshrrev_b32 v1, 6, v0
v_mov_b32 v255, v0
s_and_b32 s28, s28, 7
v_readfirstlane_b32 s29, v1
v_and_b32 v0, 63, v0
s_mov_b32 s31, 0
s_and_b32 s34, s2, 7
s_lshl_b32 s34, s34, 5
s_lshr_b32 s35, s2, 3
s_add_u32 s30, s34, s35
s_mul_i32 s34, s2, 3584
s_add_u32 s34, s34, 65536
v_lshlrev_b32 v4, 4, v255
v_add_u32 v5, s34, v4
v_mov_b32 v8, -1
v_mov_b32 v9, -1
v_mov_b32 v10, -1
v_mov_b32 v11, -1
s_lshl_b32 s34, s2, 7
v_add_u32 v6, s34, v4
v_mov_b32 v12, 0
v_mov_b32 v13, 0
v_mov_b32 v14, 0
v_mov_b32 v15, 0
s_waitcnt lgkmcnt(0)
v_cmp_gt_u32 vcc, 224, v255
s_and_saveexec_b64 s[36:37], vcc
global_store_dwordx4 v5, v[8:11], s[26:27] sc1
s_mov_b64 exec, s[36:37]
v_cmp_gt_u32 vcc, 8, v255
s_and_saveexec_b64 s[36:37], vcc
global_store_dwordx4 v6, v[12:15], s[26:27] sc1
s_mov_b64 exec, s[36:37]
s_mov_b32 s40, 0
s_cmp_lt_u32 s30, 128
s_cbranch_scc1 L_nolsp
s_sub_u32 s34, s30, 128
s_mul_i32 s35, s34, 1024
s_add_u32 s35, s35, 38666240
v_add_u32 v5, s35, v4
v_add_u32 v6, 4193280, v5
v_cmp_gt_u32 vcc, 64, v255
s_nop 1
v_cndmask_b32 v5, v6, v5, vcc
v_mov_b32 v6, 128
v_cmp_gt_u32 vcc, v6, v255
s_and_saveexec_b64 s[36:37], vcc
global_store_dwordx4 v5, v[8:11], s[26:27] sc1
s_mov_b64 exec, s[36:37]
L_nolsp:
s_cmp_lt_u32 s30, 32
s_cbranch_scc1 L_chain_pro
s_cmp_lt_u32 s30, 128
s_cbranch_scc1 L_kv_pro
s_branch L_out_pro
L_kv_pro:
s_sub_u32 s34, s30, 32
s_mul_i32 s32, s34, 171
s_lshr_b32 s32, s32, 9
s_mul_i32 s35, s32, 3
s_sub_u32 s33, s34, s35
v_lshrrev_b32 v8, 4, v0
v_and_b32 v9, 15, v0
s_lshl_b32 s34, s29, 3
v_add_u32 v1, s34, v8
v_lshlrev_b32 v1, 13, v1
v_lshlrev_b32 v10, 4, v9
v_add_u32 v1, v1, v10
v_add_u32 v2, 0x8000, v1
v_add_u32 v3, s34, v8
v_mul_u32_u24 v3, 288, v3
v_add_u32 v3, v3, v10
v_lshlrev_b32 v11, 3, v8
v_lshrrev_b32 v12, 2, v9
v_add_u32 v11, v11, v12
v_mul_u32_u24 v4, 288, v11
v_and_b32 v12, 3, v9
v_lshlrev_b32 v12, 3, v12
s_lshl_b32 s34, s29, 6
v_add_u32 v12, s34, v12
v_add_u32 v4, v4, v12
v_lshlrev_b32 v5, 4, v0
s_lshl_b32 s34, s29, 13
v_add_u32 v5, s34, v5
v_mul_u32_u24 v6, 1056, v9
v_lshlrev_b32 v12, 4, v8
v_add_u32 v6, v6, v12
s_lshl_b32 s34, s32, 13
s_lshl_b32 s35, s29, 11
s_add_u32 s34, s34, s35
v_lshlrev_b32 v7, 4, v0
v_add_u32 v7, s34, v7
s_mov_b32 s54, s33
s_mov_b32 s55, 20480
s_lshl_b32 s50, s54, 15
s_add_u32 s50, s4, s50
s_addc_u32 s51, s5, 0
s_mul_i32 s52, s29, 8448
s_add_u32 s52, s52, s55
s_add_u32 m0, s52, 0
s_nop 0
global_load_lds_dwordx4 v5, s[50:51] offset:0
s_add_u32 m0, s52, 32
s_nop 0
global_load_lds_dwordx4 v5, s[50:51] offset:1024
s_add_u32 m0, s52, 64
s_nop 0
global_load_lds_dwordx4 v5, s[50:51] offset:2048
s_add_u32 m0, s52, 96
s_nop 0
global_load_lds_dwordx4 v5, s[50:51] offset:3072
s_add_u32 s50, s50, 4096
s_addc_u32 s51, s51, 0
s_add_u32 m0, s52, 4224
s_nop 0
global_load_lds_dwordx4 v5, s[50:51] offset:0
s_add_u32 m0, s52, 4256
s_nop 0
global_load_lds_dwordx4 v5, s[50:51] offset:1024
s_add_u32 m0, s52, 4288
s_nop 0
global_load_lds_dwordx4 v5, s[50:51] offset:2048
s_add_u32 m0, s52, 4320
s_nop 0
global_load_lds_dwordx4 v5, s[50:51] offset:3072
s_lshl_b32 s46, s32, 8
s_add_u32 s48, s10, s46
s_addc_u32 s49, s11, 0
global_load_dwordx4 v[128:131], v1, s[48:49]
global_load_dwordx4 v[132:135], v2, s[48:49]
s_add_u32 s48, s48, 0x40000
s_addc_u32 s49, s49, 0
global_load_dwordx4 v[136:139], v1, s[48:49]
global_load_dwordx4 v[140:143], v2, s[48:49]
s_add_u32 s48, s48, 0x40000
s_addc_u32 s49, s49, 0
global_load_dwordx4 v[144:147], v1, s[48:49]
global_load_dwordx4 v[148:151], v2, s[48:49]
s_add_u32 s48, s48, 0x40000
s_addc_u32 s49, s49, 0
global_load_dwordx4 v[152:155], v1, s[48:49]
global_load_dwordx4 v[156:159], v2, s[48:49]
s_add_u32 s48, s48, 0x40000
s_addc_u32 s49, s49, 0
global_load_dwordx4 v[160:163], v1, s[48:49]
global_load_dwordx4 v[164:167], v2, s[48:49]
s_add_u32 s48, s48, 0x40000
s_addc_u32 s49, s49, 0
global_load_dwordx4 v[168:171], v1, s[48:49]
global_load_dwordx4 v[172:175], v2, s[48:49]
s_add_u32 s48, s48, 0x40000
s_addc_u32 s49, s49, 0
global_load_dwordx4 v[176:179], v1, s[48:49]
global_load_dwordx4 v[180:183], v2, s[48:49]
s_add_u32 s48, s48, 0x40000
s_addc_u32 s49, s49, 0
global_load_dwordx4 v[184:187], v1, s[48:49]
global_load_dwordx4 v[188:191], v2, s[48:49]
s_add_u32 s48, s48, 0x40000
s_addc_u32 s49, s49, 0
global_load_dwordx4 v[192:195], v1, s[48:49]
global_load_dwordx4 v[196:199], v2, s[48:49]
s_add_u32 s48, s48, 0x40000
s_addc_u32 s49, s49, 0
global_load_dwordx4 v[200:203], v1, s[48:49]
global_load_dwordx4 v[204:207], v2, s[48:49]
s_add_u32 s48, s48, 0x40000
s_addc_u32 s49, s49, 0
global_load_dwordx4 v[208:211], v1, s[48:49]
global_load_dwordx4 v[212:215], v2, s[48:49]
s_add_u32 s48, s48, 0x40000
s_addc_u32 s49, s49, 0
global_load_dwordx4 v[216:219], v1, s[48:49]
global_load_dwordx4 v[220:223], v2, s[48:49]
s_waitcnt vmcnt(22)
ds_write_b128 v3, v[128:131] offset:0
ds_write_b128 v3, v[132:135] offset:1152
s_add_u32 s48, s48, 0x40000
s_addc_u32 s49, s49, 0
global_load_dwordx4 v[128:131], v1, s[48:49]
global_load_dwordx4 v[132:135], v2, s[48:49]
s_waitcnt lgkmcnt(0)
s_barrier
s_cmp_eq_u32 s29, 0
s_cbranch_scc0 L_arr_1
v_mov_b32 v10, 128
v_mov_b32 v12, 1
s_mov_b64 exec, 1
global_atomic_add v10, v12, s[24:25] sc1
s_mov_b64 exec, -1
L_arr_1:
ds_read_b64_tr_b16 a[0:1], v4 offset:0
ds_read_b64_tr_b16 a[2:3], v4 offset:1152
ds_read_b64_tr_b16 a[64:65], v4 offset:32
ds_read_b64_tr_b16 a[66:67], v4 offset:1184
s_waitcnt vmcnt(22)
ds_write_b128 v3, v[136:139] offset:9216
ds_write_b128 v3, v[140:143] offset:10368
s_add_u32 s48, s48, 0x40000
s_addc_u32 s49, s49, 0
global_load_dwordx4 v[136:139], v1, s[48:49]
global_load_dwordx4 v[140:143], v2, s[48:49]
s_waitcnt lgkmcnt(0)
s_barrier
ds_read_b64_tr_b16 a[4:5], v4 offset:9216
ds_read_b64_tr_b16 a[6:7], v4 offset:10368
ds_read_b64_tr_b16 a[68:69], v4 offset:9248
ds_read_b64_tr_b16 a[70:71], v4 offset:10400
s_waitcnt vmcnt(22)
ds_write_b128 v3, v[144:147] offset:0
ds_write_b128 v3, v[148:151] offset:1152
s_add_u32 s48, s48, 0x40000
s_addc_u32 s49, s49, 0
global_load_dwordx4 v[144:147], v1, s[48:49]
global_load_dwordx4 v[148:151], v2, s[48:49]
s_waitcnt lgkmcnt(0)
s_barrier
ds_read_b64_tr_b16 a[8:9], v4 offset:0
ds_read_b64_tr_b16 a[10:11], v4 offset:1152
ds_read_b64_tr_b16 a[72:73], v4 offset:32
ds_read_b64_tr_b16 a[74:75], v4 offset:1184
s_waitcnt vmcnt(22)
ds_write_b128 v3, v[152:155] offset:9216
ds_write_b128 v3, v[156:159] offset:10368
s_add_u32 s48, s48, 0x40000
s_addc_u32 s49, s49, 0
global_load_dwordx4 v[152:155], v1, s[48:49]
global_load_dwordx4 v[156:159], v2, s[48:49]
s_waitcnt lgkmcnt(0)
s_barrier
ds_read_b64_tr_b16 a[12:13], v4 offset:9216
ds_read_b64_tr_b16 a[14:15], v4 offset:10368
ds_read_b64_tr_b16 a[76:77], v4 offset:9248
ds_read_b64_tr_b16 a[78:79], v4 offset:10400
s_waitcnt vmcnt(22)
ds_write_b128 v3, v[160:163] offset:0
ds_write_b128 v3, v[164:167] offset:1152
s_lshl_b32 s46, s32, 8
s_add_u32 s48, s12, s46
s_addc_u32 s49, s13, 0
global_load_dwordx4 v[160:163], v1, s[48:49]
global_load_dwordx4 v[164:167], v2, s[48:49]
s_waitcnt lgkmcnt(0)
s_barrier
ds_read_b64_tr_b16 a[16:17], v4 offset:0
ds_read_b64_tr_b16 a[18:19], v4 offset:1152
ds_read_b64_tr_b16 a[80:81], v4 offset:32
ds_read_b64_tr_b16 a[82:83], v4 offset:1184
s_waitcnt vmcnt(22)
ds_write_b128 v3, v[168:171] offset:9216
ds_write_b128 v3, v[172:175] offset:10368
s_add_u32 s48, s48, 0x40000
s_addc_u32 s49, s49, 0
global_load_dwordx4 v[168:171], v1, s[48:49]
global_load_dwordx4 v[172:175], v2, s[48:49]
s_waitcnt lgkmcnt(0)
s_barrier
ds_read_b64_tr_b16 a[20:21], v4 offset:9216
ds_read_b64_tr_b16 a[22:23], v4 offset:10368
ds_read_b64_tr_b16 a[84:85], v4 offset:9248
ds_read_b64_tr_b16 a[86:87], v4 offset:10400
s_waitcnt vmcnt(22)
ds_write_b128 v3, v[176:179] offset:0
ds_write_b128 v3, v[180:183] offset:1152
s_add_u32 s48, s48, 0x40000
s_addc_u32 s49, s49, 0
global_load_dwordx4 v[176:179], v1, s[48:49]
global_load_dwordx4 v[180:183], v2, s[48:49]
s_waitcnt lgkmcnt(0)
s_barrier
ds_read_b64_tr_b16 a[24:25], v4 offset:0
ds_read_b64_tr_b16 a[26:27], v4 offset:1152
ds_read_b64_tr_b16 a[88:89], v4 offset:32
ds_read_b64_tr_b16 a[90:91], v4 offset:1184
s_waitcnt vmcnt(22)
ds_write_b128 v3, v[184:187] offset:9216
ds_write_b128 v3, v[188:191] offset:10368
s_add_u32 s48, s48, 0x40000
s_addc_u32 s49, s49, 0
global_load_dwordx4 v[184:187], v1, s[48:49]
global_load_dwordx4 v[188:191], v2, s[48:49]
s_waitcnt lgkmcnt(0)
s_barrier
ds_read_b64_tr_b16 a[28:29], v4 offset:9216
ds_read_b64_tr_b16 a[30:31], v4 offset:10368
ds_read_b64_tr_b16 a[92:93], v4 offset:9248
ds_read_b64_tr_b16 a[94:95], v4 offset:10400
s_waitcnt vmcnt(22)
ds_write_b128 v3, v[192:195] offset:0
ds_write_b128 v3, v[196:199] offset:1152
s_add_u32 s48, s48, 0x40000
s_addc_u32 s49, s49, 0
global_load_dwordx4 v[192:195], v1, s[48:49]
global_load_dwordx4 v[196:199], v2, s[48:49]
s_waitcnt lgkmcnt(0)
s_barrier
ds_read_b64_tr_b16 a[32:33], v4 offset:0
ds_read_b64_tr_b16 a[34:35], v4 offset:1152
ds_read_b64_tr_b16 a[96:97], v4 offset:32
ds_read_b64_tr_b16 a[98:99], v4 offset:1184
s_waitcnt vmcnt(22)
ds_write_b128 v3, v[200:203] offset:9216
ds_write_b128 v3, v[204:207] offset:10368
s_add_u32 s48, s48, 0x40000
s_addc_u32 s49, s49, 0
global_load_dwordx4 v[200:203], v1, s[48:49]
global_load_dwordx4 v[204:207], v2, s[48:49]
s_waitcnt lgkmcnt(0)
s_barrier
ds_read_b64_tr_b16 a[36:37], v4 offset:9216
ds_read_b64_tr_b16 a[38:39], v4 offset:10368
ds_read_b64_tr_b16 a[100:101], v4 offset:9248
ds_read_b64_tr_b16 a[102:103], v4 offset:10400
s_waitcnt vmcnt(22)
ds_write_b128 v3, v[208:211] offset:0
ds_write_b128 v3, v[212:215] offset:1152
s_add_u32 s48, s48, 0x40000
s_addc_u32 s49, s49, 0
global_load_dwordx4 v[208:211], v1, s[48:49]
global_load_dwordx4 v[212:215], v2, s[48:49]
s_waitcnt lgkmcnt(0)
s_barrier
ds_read_b64_tr_b16 a[40:41], v4 offset:0
ds_read_b64_tr_b16 a[42:43], v4 offset:1152
ds_read_b64_tr_b16 a[104:105], v4 offset:32
ds_read_b64_tr_b16 a[106:107], v4 offset:1184
s_waitcnt vmcnt(22)
ds_write_b128 v3, v[216:219] offset:9216
ds_write_b128 v3, v[220:223] offset:10368
s_add_u32 s48, s48, 0x40000
s_addc_u32 s49, s49, 0
global_load_dwordx4 v[216:219], v1, s[48:49]
global_load_dwordx4 v[220:223], v2, s[48:49]
s_waitcnt lgkmcnt(0)
s_barrier
ds_read_b64_tr_b16 a[44:45], v4 offset:9216
ds_read_b64_tr_b16 a[46:47], v4 offset:10368
ds_read_b64_tr_b16 a[108:109], v4 offset:9248
ds_read_b64_tr_b16 a[110:111], v4 offset:10400
s_waitcnt vmcnt(22)
ds_write_b128 v3, v[128:131] offset:0
ds_write_b128 v3, v[132:135] offset:1152
s_add_u32 s48, s48, 0x40000
s_addc_u32 s49, s49, 0
global_load_dwordx4 v[128:131], v1, s[48:49]
global_load_dwordx4 v[132:135], v2, s[48:49]
s_waitcnt lgkmcnt(0)
s_barrier
ds_read_b64_tr_b16 a[48:49], v4 offset:0
ds_read_b64_tr_b16 a[50:51], v4 offset:1152
ds_read_b64_tr_b16 a[112:113], v4 offset:32
ds_read_b64_tr_b16 a[114:115], v4 offset:1184
s_waitcnt vmcnt(22)
ds_write_b128 v3, v[136:139] offset:9216
ds_write_b128 v3, v[140:143] offset:10368
s_add_u32 s48, s48, 0x40000
s_addc_u32 s49, s49, 0
global_load_dwordx4 v[136:139], v1, s[48:49]
global_load_dwordx4 v[140:143], v2, s[48:49]
s_waitcnt lgkmcnt(0)
s_barrier
ds_read_b64_tr_b16 a[52:53], v4 offset:9216
ds_read_b64_tr_b16 a[54:55], v4 offset:10368
ds_read_b64_tr_b16 a[116:117], v4 offset:9248
ds_read_b64_tr_b16 a[118:119], v4 offset:10400
s_waitcnt vmcnt(22)
ds_write_b128 v3, v[144:147] offset:0
ds_write_b128 v3, v[148:151] offset:1152
s_add_u32 s48, s48, 0x40000
s_addc_u32 s49, s49, 0
global_load_dwordx4 v[144:147], v1, s[48:49]
global_load_dwordx4 v[148:151], v2, s[48:49]
s_waitcnt lgkmcnt(0)
s_barrier
ds_read_b64_tr_b16 a[56:57], v4 offset:0
ds_read_b64_tr_b16 a[58:59], v4 offset:1152
ds_read_b64_tr_b16 a[120:121], v4 offset:32
ds_read_b64_tr_b16 a[122:123], v4 offset:1184
s_waitcnt vmcnt(22)
ds_write_b128 v3, v[152:155] offset:9216
ds_write_b128 v3, v[156:159] offset:10368
s_add_u32 s48, s48, 0x40000
s_addc_u32 s49, s49, 0
global_load_dwordx4 v[152:155], v1, s[48:49]
global_load_dwordx4 v[156:159], v2, s[48:49]
s_waitcnt lgkmcnt(0)
s_barrier
ds_read_b64_tr_b16 a[60:61], v4 offset:9216
ds_read_b64_tr_b16 a[62:63], v4 offset:10368
ds_read_b64_tr_b16 a[124:125], v4 offset:9248
ds_read_b64_tr_b16 a[126:127], v4 offset:10400
s_waitcnt vmcnt(22)
ds_write_b128 v3, v[160:163] offset:0
ds_write_b128 v3, v[164:167] offset:1152
s_add_u32 s48, s48, 0x40000
s_addc_u32 s49, s49, 0
global_load_dwordx4 v[160:163], v1, s[48:49]
global_load_dwordx4 v[164:167], v2, s[48:49]
s_waitcnt lgkmcnt(0)
s_barrier
ds_read_b64_tr_b16 a[128:129], v4 offset:0
ds_read_b64_tr_b16 a[130:131], v4 offset:1152
ds_read_b64_tr_b16 a[192:193], v4 offset:32
ds_read_b64_tr_b16 a[194:195], v4 offset:1184
s_waitcnt vmcnt(22)
ds_write_b128 v3, v[168:171] offset:9216
ds_write_b128 v3, v[172:175] offset:10368
s_add_u32 s48, s48, 0x40000
s_addc_u32 s49, s49, 0
global_load_dwordx4 v[168:171], v1, s[48:49]
global_load_dwordx4 v[172:175], v2, s[48:49]
s_waitcnt lgkmcnt(0)
s_barrier
ds_read_b64_tr_b16 a[132:133], v4 offset:9216
ds_read_b64_tr_b16 a[134:135], v4 offset:10368
ds_read_b64_tr_b16 a[196:197], v4 offset:9248
ds_read_b64_tr_b16 a[198:199], v4 offset:10400
s_waitcnt vmcnt(22)
ds_write_b128 v3, v[176:179] offset:0
ds_write_b128 v3, v[180:183] offset:1152
s_add_u32 s48, s48, 0x40000
s_addc_u32 s49, s49, 0
global_load_dwordx4 v[176:179], v1, s[48:49]
global_load_dwordx4 v[180:183], v2, s[48:49]
s_waitcnt lgkmcnt(0)
s_barrier
ds_read_b64_tr_b16 a[136:137], v4 offset:0
ds_read_b64_tr_b16 a[138:139], v4 offset:1152
ds_read_b64_tr_b16 a[200:201], v4 offset:32
ds_read_b64_tr_b16 a[202:203], v4 offset:1184
s_waitcnt vmcnt(22)
ds_write_b128 v3, v[184:187] offset:9216
ds_write_b128 v3, v[188:191] offset:10368
s_add_u32 s48, s48, 0x40000
s_addc_u32 s49, s49, 0
global_load_dwordx4 v[184:187], v1, s[48:49]
global_load_dwordx4 v[188:191], v2, s[48:49]
s_waitcnt lgkmcnt(0)
s_barrier
ds_read_b64_tr_b16 a[140:141], v4 offset:9216
ds_read_b64_tr_b16 a[142:143], v4 offset:10368
ds_read_b64_tr_b16 a[204:205], v4 offset:9248
ds_read_b64_tr_b16 a[206:207], v4 offset:10400
s_waitcnt vmcnt(22)
ds_write_b128 v3, v[192:195] offset:0
ds_write_b128 v3, v[196:199] offset:1152
s_waitcnt lgkmcnt(0)
s_barrier
ds_read_b64_tr_b16 a[144:145], v4 offset:0
ds_read_b64_tr_b16 a[146:147], v4 offset:1152
ds_read_b64_tr_b16 a[208:209], v4 offset:32
ds_read_b64_tr_b16 a[210:211], v4 offset:1184
s_waitcnt vmcnt(20)
ds_write_b128 v3, v[200:203] offset:9216
ds_write_b128 v3, v[204:207] offset:10368
s_waitcnt lgkmcnt(0)
s_barrier
ds_read_b64_tr_b16 a[148:149], v4 offset:9216
ds_read_b64_tr_b16 a[150:151], v4 offset:10368
ds_read_b64_tr_b16 a[212:213], v4 offset:9248
ds_read_b64_tr_b16 a[214:215], v4 offset:10400
s_waitcnt vmcnt(18)
ds_write_b128 v3, v[208:211] offset:0
ds_write_b128 v3, v[212:215] offset:1152
s_waitcnt lgkmcnt(0)
s_barrier
ds_read_b64_tr_b16 a[152:153], v4 offset:0
ds_read_b64_tr_b16 a[154:155], v4 offset:1152
ds_read_b64_tr_b16 a[216:217], v4 offset:32
ds_read_b64_tr_b16 a[218:219], v4 offset:1184
s_waitcnt vmcnt(16)
ds_write_b128 v3, v[216:219] offset:9216
ds_write_b128 v3, v[220:223] offset:10368
s_waitcnt lgkmcnt(0)
s_barrier
ds_read_b64_tr_b16 a[156:157], v4 offset:9216
ds_read_b64_tr_b16 a[158:159], v4 offset:10368
ds_read_b64_tr_b16 a[220:221], v4 offset:9248
ds_read_b64_tr_b16 a[222:223], v4 offset:10400
s_waitcnt vmcnt(14)
ds_write_b128 v3, v[128:131] offset:0
ds_write_b128 v3, v[132:135] offset:1152
s_waitcnt lgkmcnt(0)
s_barrier
ds_read_b64_tr_b16 a[160:161], v4 offset:0
ds_read_b64_tr_b16 a[162:163], v4 offset:1152
ds_read_b64_tr_b16 a[224:225], v4 offset:32
ds_read_b64_tr_b16 a[226:227], v4 offset:1184
s_waitcnt vmcnt(12)
ds_write_b128 v3, v[136:139] offset:9216
ds_write_b128 v3, v[140:143] offset:10368
s_waitcnt lgkmcnt(0)
s_barrier
ds_read_b64_tr_b16 a[164:165], v4 offset:9216
ds_read_b64_tr_b16 a[166:167], v4 offset:10368
ds_read_b64_tr_b16 a[228:229], v4 offset:9248
ds_read_b64_tr_b16 a[230:231], v4 offset:10400
s_waitcnt vmcnt(10)
ds_write_b128 v3, v[144:147] offset:0
ds_write_b128 v3, v[148:151] offset:1152
s_waitcnt lgkmcnt(0)
s_barrier
ds_read_b64_tr_b16 a[168:169], v4 offset:0
ds_read_b64_tr_b16 a[170:171], v4 offset:1152
ds_read_b64_tr_b16 a[232:233], v4 offset:32
ds_read_b64_tr_b16 a[234:235], v4 offset:1184
s_waitcnt vmcnt(8)
ds_write_b128 v3, v[152:155] offset:9216
ds_write_b128 v3, v[156:159] offset:10368
s_waitcnt lgkmcnt(0)
s_barrier
ds_read_b64_tr_b16 a[172:173], v4 offset:9216
ds_read_b64_tr_b16 a[174:175], v4 offset:10368
ds_read_b64_tr_b16 a[236:237], v4 offset:9248
ds_read_b64_tr_b16 a[238:239], v4 offset:10400
s_waitcnt vmcnt(6)
ds_write_b128 v3, v[160:163] offset:0
ds_write_b128 v3, v[164:167] offset:1152
s_waitcnt lgkmcnt(0)
s_barrier
ds_read_b64_tr_b16 a[176:177], v4 offset:0
ds_read_b64_tr_b16 a[178:179], v4 offset:1152
ds_read_b64_tr_b16 a[240:241], v4 offset:32
ds_read_b64_tr_b16 a[242:243], v4 offset:1184
s_waitcnt vmcnt(4)
ds_write_b128 v3, v[168:171] offset:9216
ds_write_b128 v3, v[172:175] offset:10368
s_waitcnt lgkmcnt(0)
s_barrier
ds_read_b64_tr_b16 a[180:181], v4 offset:9216
ds_read_b64_tr_b16 a[182:183], v4 offset:10368
ds_read_b64_tr_b16 a[244:245], v4 offset:9248
ds_read_b64_tr_b16 a[246:247], v4 offset:10400
s_waitcnt vmcnt(2)
ds_write_b128 v3, v[176:179] offset:0
ds_write_b128 v3, v[180:183] offset:1152
s_waitcnt lgkmcnt(0)
s_barrier
ds_read_b64_tr_b16 a[184:185], v4 offset:0
ds_read_b64_tr_b16 a[186:187], v4 offset:1152
ds_read_b64_tr_b16 a[248:249], v4 offset:32
ds_read_b64_tr_b16 a[250:251], v4 offset:1184
s_waitcnt vmcnt(0)
ds_write_b128 v3, v[184:187] offset:9216
ds_write_b128 v3, v[188:191] offset:10368
s_waitcnt lgkmcnt(0)
s_barrier
ds_read_b64_tr_b16 a[188:189], v4 offset:9216
ds_read_b64_tr_b16 a[190:191], v4 offset:10368
ds_read_b64_tr_b16 a[252:253], v4 offset:9248
ds_read_b64_tr_b16 a[254:255], v4 offset:10400
s_waitcnt lgkmcnt(0)
s_barrier
s_mov_b32 s43, 0
v_lshlrev_b32 v250, 2, v0
L_sb_poll_kv:
global_load_dword v251, v250, s[24:25] sc1
s_add_u32 s43, s43, 1
s_waitcnt vmcnt(0)
v_readlane_b32 s34, v251, 0
v_readlane_b32 s35, v251, 1
v_readlane_b32 s36, v251, 32
v_readlane_b32 s37, v251, 48
s_lshl_b32 s36, s36, 8
s_add_u32 s36, s36, s37
s_lshr_b32 s37, s35, 16
s_lshl_b32 s37, s37, 16
s_add_u32 s36, s36, s37
s_cmp_eq_u32 s36, 2121856
s_cbranch_scc1 L_sb_done_kv
s_cmp_lt_u32 s43, 400000
s_cbranch_scc1 L_sb_poll_kv
L_sb_done_kv:
s_mov_b32 s56, 0
L_kv_loop:
s_add_u32 s57, s54, 3
s_xor_b32 s58, s55, 33792
s_cmp_lt_u32 s57, 64
s_cbranch_scc0 L_kv_nopf
s_lshl_b32 s50, s57, 15
s_add_u32 s50, s4, s50
s_addc_u32 s51, s5, 0
s_mul_i32 s52, s29, 8448
s_add_u32 s52, s52, s58
s_add_u32 m0, s52, 0
s_nop 0
global_load_lds_dwordx4 v5, s[50:51] offset:0
s_add_u32 m0, s52, 32
s_nop 0
global_load_lds_dwordx4 v5, s[50:51] offset:1024
s_add_u32 m0, s52, 64
s_nop 0
global_load_lds_dwordx4 v5, s[50:51] offset:2048
s_add_u32 m0, s52, 96
s_nop 0
global_load_lds_dwordx4 v5, s[50:51] offset:3072
s_add_u32 s50, s50, 4096
s_addc_u32 s51, s51, 0
s_add_u32 m0, s52, 4224
s_nop 0
global_load_lds_dwordx4 v5, s[50:51] offset:0
s_add_u32 m0, s52, 4256
s_nop 0
global_load_lds_dwordx4 v5, s[50:51] offset:1024
s_add_u32 m0, s52, 4288
s_nop 0
global_load_lds_dwordx4 v5, s[50:51] offset:2048
s_add_u32 m0, s52, 4320
s_nop 0
global_load_lds_dwordx4 v5, s[50:51] offset:3072
L_kv_nopf:
v_add_u32 v8, s55, v6
ds_read_b128 v[16:19], v8 offset:0
ds_read_b128 v[20:23], v8 offset:16896
ds_read_b128 v[24:27], v8 offset:64
ds_read_b128 v[28:31], v8 offset:16960
ds_read_b128 v[32:35], v8 offset:128
ds_read_b128 v[36:39], v8 offset:17024
ds_read_b128 v[40:43], v8 offset:192
ds_read_b128 v[44:47], v8 offset:17088
s_waitcnt lgkmcnt(6)
v_mfma_f32_16x16x32_bf16 v[48:51], a[0:3], v[16:19], 0
v_mfma_f32_16x16x32_bf16 v[52:55], a[0:3], v[20:23], 0
v_mfma_f32_16x16x32_bf16 v[56:59], a[64:67], v[16:19], 0
v_mfma_f32_16x16x32_bf16 v[60:63], a[64:67], v[20:23], 0
v_mfma_f32_16x16x32_bf16 v[64:67], v[16:19], a[128:131], 0
v_mfma_f32_16x16x32_bf16 v[68:71], v[16:19], a[192:195], 0
v_mfma_f32_16x16x32_bf16 v[72:75], v[20:23], a[128:131], 0
v_mfma_f32_16x16x32_bf16 v[76:79], v[20:23], a[192:195], 0
ds_read_b128 v[16:19], v8 offset:256
ds_read_b128 v[20:23], v8 offset:17152
s_waitcnt lgkmcnt(6)
v_mfma_f32_16x16x32_bf16 v[48:51], a[4:7], v[24:27], v[48:51]
v_mfma_f32_16x16x32_bf16 v[52:55], a[4:7], v[28:31], v[52:55]
v_mfma_f32_16x16x32_bf16 v[56:59], a[68:71], v[24:27], v[56:59]
v_mfma_f32_16x16x32_bf16 v[60:63], a[68:71], v[28:31], v[60:63]
v_mfma_f32_16x16x32_bf16 v[64:67], v[24:27], a[132:135], v[64:67]
v_mfma_f32_16x16x32_bf16 v[68:71], v[24:27], a[196:199], v[68:71]
v_mfma_f32_16x16x32_bf16 v[72:75], v[28:31], a[132:135], v[72:75]
v_mfma_f32_16x16x32_bf16 v[76:79], v[28:31], a[196:199], v[76:79]
ds_read_b128 v[24:27], v8 offset:320
ds_read_b128 v[28:31], v8 offset:17216
s_waitcnt lgkmcnt(6)
v_mfma_f32_16x16x32_bf16 v[48:51], a[8:11], v[32:35], v[48:51]
v_mfma_f32_16x16x32_bf16 v[52:55], a[8:11], v[36:39], v[52:55]
v_mfma_f32_16x16x32_bf16 v[56:59], a[72:75], v[32:35], v[56:59]
v_mfma_f32_16x16x32_bf16 v[60:63], a[72:75], v[36:39], v[60:63]
v_mfma_f32_16x16x32_bf16 v[64:67], v[32:35], a[136:139], v[64:67]
v_mfma_f32_16x16x32_bf16 v[68:71], v[32:35], a[200:203], v[68:71]
v_mfma_f32_16x16x32_bf16 v[72:75], v[36:39], a[136:139], v[72:75]
v_mfma_f32_16x16x32_bf16 v[76:79], v[36:39], a[200:203], v[76:79]
ds_read_b128 v[32:35], v8 offset:384
ds_read_b128 v[36:39], v8 offset:17280
s_waitcnt lgkmcnt(6)
v_mfma_f32_16x16x32_bf16 v[48:51], a[12:15], v[40:43], v[48:51]
v_mfma_f32_16x16x32_bf16 v[52:55], a[12:15], v[44:47], v[52:55]
v_mfma_f32_16x16x32_bf16 v[56:59], a[76:79], v[40:43], v[56:59]
v_mfma_f32_16x16x32_bf16 v[60:63], a[76:79], v[44:47], v[60:63]
v_mfma_f32_16x16x32_bf16 v[64:67], v[40:43], a[140:143], v[64:67]
v_mfma_f32_16x16x32_bf16 v[68:71], v[40:43], a[204:207], v[68:71]
v_mfma_f32_16x16x32_bf16 v[72:75], v[44:47], a[140:143], v[72:75]
v_mfma_f32_16x16x32_bf16 v[76:79], v[44:47], a[204:207], v[76:79]
ds_read_b128 v[40:43], v8 offset:448
ds_read_b128 v[44:47], v8 offset:17344
s_waitcnt lgkmcnt(6)
v_mfma_f32_16x16x32_bf16 v[48:51], a[16:19], v[16:19], v[48:51]
v_mfma_f32_16x16x32_bf16 v[52:55], a[16:19], v[20:23], v[52:55]
v_mfma_f32_16x16x32_bf16 v[56:59], a[80:83], v[16:19], v[56:59]
v_mfma_f32_16x16x32_bf16 v[60:63], a[80:83], v[20:23], v[60:63]
v_mfma_f32_16x16x32_bf16 v[64:67], v[16:19], a[144:147], v[64:67]
v_mfma_f32_16x16x32_bf16 v[68:71], v[16:19], a[208:211], v[68:71]
v_mfma_f32_16x16x32_bf16 v[72:75], v[20:23], a[144:147], v[72:75]
v_mfma_f32_16x16x32_bf16 v[76:79], v[20:23], a[208:211], v[76:79]
ds_read_b128 v[16:19], v8 offset:512
ds_read_b128 v[20:23], v8 offset:17408
s_waitcnt lgkmcnt(6)
v_mfma_f32_16x16x32_bf16 v[48:51], a[20:23], v[24:27], v[48:51]
v_mfma_f32_16x16x32_bf16 v[52:55], a[20:23], v[28:31], v[52:55]
v_mfma_f32_16x16x32_bf16 v[56:59], a[84:87], v[24:27], v[56:59]
v_mfma_f32_16x16x32_bf16 v[60:63], a[84:87], v[28:31], v[60:63]
v_mfma_f32_16x16x32_bf16 v[64:67], v[24:27], a[148:151], v[64:67]
v_mfma_f32_16x16x32_bf16 v[68:71], v[24:27], a[212:215], v[68:71]
v_mfma_f32_16x16x32_bf16 v[72:75], v[28:31], a[148:151], v[72:75]
v_mfma_f32_16x16x32_bf16 v[76:79], v[28:31], a[212:215], v[76:79]
ds_read_b128 v[24:27], v8 offset:576
ds_read_b128 v[28:31], v8 offset:17472
s_waitcnt lgkmcnt(6)
v_mfma_f32_16x16x32_bf16 v[48:51], a[24:27], v[32:35], v[48:51]
v_mfma_f32_16x16x32_bf16 v[52:55], a[24:27], v[36:39], v[52:55]
v_mfma_f32_16x16x32_bf16 v[56:59], a[88:91], v[32:35], v[56:59]
v_mfma_f32_16x16x32_bf16 v[60:63], a[88:91], v[36:39], v[60:63]
v_mfma_f32_16x16x32_bf16 v[64:67], v[32:35], a[152:155], v[64:67]
v_mfma_f32_16x16x32_bf16 v[68:71], v[32:35], a[216:219], v[68:71]
v_mfma_f32_16x16x32_bf16 v[72:75], v[36:39], a[152:155], v[72:75]
v_mfma_f32_16x16x32_bf16 v[76:79], v[36:39], a[216:219], v[76:79]
ds_read_b128 v[32:35], v8 offset:640
ds_read_b128 v[36:39], v8 offset:17536
s_waitcnt lgkmcnt(6)
v_mfma_f32_16x16x32_bf16 v[48:51], a[28:31], v[40:43], v[48:51]
v_mfma_f32_16x16x32_bf16 v[52:55], a[28:31], v[44:47], v[52:55]
v_mfma_f32_16x16x32_bf16 v[56:59], a[92:95], v[40:43], v[56:59]
v_mfma_f32_16x16x32_bf16 v[60:63], a[92:95], v[44:47], v[60:63]
v_mfma_f32_16x16x32_bf16 v[64:67], v[40:43], a[156:159], v[64:67]
v_mfma_f32_16x16x32_bf16 v[68:71], v[40:43], a[220:223], v[68:71]
v_mfma_f32_16x16x32_bf16 v[72:75], v[44:47], a[156:159], v[72:75]
v_mfma_f32_16x16x32_bf16 v[76:79], v[44:47], a[220:223], v[76:79]
ds_read_b128 v[40:43], v8 offset:704
ds_read_b128 v[44:47], v8 offset:17600
s_waitcnt lgkmcnt(6)
v_mfma_f32_16x16x32_bf16 v[48:51], a[32:35], v[16:19], v[48:51]
v_mfma_f32_16x16x32_bf16 v[52:55], a[32:35], v[20:23], v[52:55]
v_mfma_f32_16x16x32_bf16 v[56:59], a[96:99], v[16:19], v[56:59]
v_mfma_f32_16x16x32_bf16 v[60:63], a[96:99], v[20:23], v[60:63]
v_mfma_f32_16x16x32_bf16 v[64:67], v[16:19], a[160:163], v[64:67]
v_mfma_f32_16x16x32_bf16 v[68:71], v[16:19], a[224:227], v[68:71]
v_mfma_f32_16x16x32_bf16 v[72:75], v[20:23], a[160:163], v[72:75]
v_mfma_f32_16x16x32_bf16 v[76:79], v[20:23], a[224:227], v[76:79]
ds_read_b128 v[16:19], v8 offset:768
ds_read_b128 v[20:23], v8 offset:17664
s_waitcnt lgkmcnt(6)
v_mfma_f32_16x16x32_bf16 v[48:51], a[36:39], v[24:27], v[48:51]
v_mfma_f32_16x16x32_bf16 v[52:55], a[36:39], v[28:31], v[52:55]
v_mfma_f32_16x16x32_bf16 v[56:59], a[100:103], v[24:27], v[56:59]
v_mfma_f32_16x16x32_bf16 v[60:63], a[100:103], v[28:31], v[60:63]
v_mfma_f32_16x16x32_bf16 v[64:67], v[24:27], a[164:167], v[64:67]
v_mfma_f32_16x16x32_bf16 v[68:71], v[24:27], a[228:231], v[68:71]
v_mfma_f32_16x16x32_bf16 v[72:75], v[28:31], a[164:167], v[72:75]
v_mfma_f32_16x16x32_bf16 v[76:79], v[28:31], a[228:231], v[76:79]
ds_read_b128 v[24:27], v8 offset:832
ds_read_b128 v[28:31], v8 offset:17728
s_waitcnt lgkmcnt(6)
v_mfma_f32_16x16x32_bf16 v[48:51], a[40:43], v[32:35], v[48:51]
v_mfma_f32_16x16x32_bf16 v[52:55], a[40:43], v[36:39], v[52:55]
v_mfma_f32_16x16x32_bf16 v[56:59], a[104:107], v[32:35], v[56:59]
v_mfma_f32_16x16x32_bf16 v[60:63], a[104:107], v[36:39], v[60:63]
v_mfma_f32_16x16x32_bf16 v[64:67], v[32:35], a[168:171], v[64:67]
v_mfma_f32_16x16x32_bf16 v[68:71], v[32:35], a[232:235], v[68:71]
v_mfma_f32_16x16x32_bf16 v[72:75], v[36:39], a[168:171], v[72:75]
v_mfma_f32_16x16x32_bf16 v[76:79], v[36:39], a[232:235], v[76:79]
ds_read_b128 v[32:35], v8 offset:896
ds_read_b128 v[36:39], v8 offset:17792
s_waitcnt lgkmcnt(6)
v_mfma_f32_16x16x32_bf16 v[48:51], a[44:47], v[40:43], v[48:51]
v_mfma_f32_16x16x32_bf16 v[52:55], a[44:47], v[44:47], v[52:55]
v_mfma_f32_16x16x32_bf16 v[56:59], a[108:111], v[40:43], v[56:59]
v_mfma_f32_16x16x32_bf16 v[60:63], a[108:111], v[44:47], v[60:63]
v_mfma_f32_16x16x32_bf16 v[64:67], v[40:43], a[172:175], v[64:67]
v_mfma_f32_16x16x32_bf16 v[68:71], v[40:43], a[236:239], v[68:71]
v_mfma_f32_16x16x32_bf16 v[72:75], v[44:47], a[172:175], v[72:75]
v_mfma_f32_16x16x32_bf16 v[76:79], v[44:47], a[236:239], v[76:79]
ds_read_b128 v[40:43], v8 offset:960
ds_read_b128 v[44:47], v8 offset:17856
s_waitcnt lgkmcnt(6)
v_mfma_f32_16x16x32_bf16 v[48:51], a[48:51], v[16:19], v[48:51]
v_mfma_f32_16x16x32_bf16 v[52:55], a[48:51], v[20:23], v[52:55]
v_mfma_f32_16x16x32_bf16 v[56:59], a[112:115], v[16:19], v[56:59]
v_mfma_f32_16x16x32_bf16 v[60:63], a[112:115], v[20:23], v[60:63]
v_mfma_f32_16x16x32_bf16 v[64:67], v[16:19], a[176:179], v[64:67]
v_mfma_f32_16x16x32_bf16 v[68:71], v[16:19], a[240:243], v[68:71]
v_mfma_f32_16x16x32_bf16 v[72:75], v[20:23], a[176:179], v[72:75]
v_mfma_f32_16x16x32_bf16 v[76:79], v[20:23], a[240:243], v[76:79]
s_waitcnt lgkmcnt(4)
v_mfma_f32_16x16x32_bf16 v[48:51], a[52:55], v[24:27], v[48:51]
v_mfma_f32_16x16x32_bf16 v[52:55], a[52:55], v[28:31], v[52:55]
v_mfma_f32_16x16x32_bf16 v[56:59], a[116:119], v[24:27], v[56:59]
v_mfma_f32_16x16x32_bf16 v[60:63], a[116:119], v[28:31], v[60:63]
v_mfma_f32_16x16x32_bf16 v[64:67], v[24:27], a[180:183], v[64:67]
v_mfma_f32_16x16x32_bf16 v[68:71], v[24:27], a[244:247], v[68:71]
v_mfma_f32_16x16x32_bf16 v[72:75], v[28:31], a[180:183], v[72:75]
v_mfma_f32_16x16x32_bf16 v[76:79], v[28:31], a[244:247], v[76:79]
s_waitcnt lgkmcnt(2)
v_mfma_f32_16x16x32_bf16 v[48:51], a[56:59], v[32:35], v[48:51]
v_mfma_f32_16x16x32_bf16 v[52:55], a[56:59], v[36:39], v[52:55]
v_mfma_f32_16x16x32_bf16 v[56:59], a[120:123], v[32:35], v[56:59]
v_mfma_f32_16x16x32_bf16 v[60:63], a[120:123], v[36:39], v[60:63]
v_mfma_f32_16x16x32_bf16 v[64:67], v[32:35], a[184:187], v[64:67]
v_mfma_f32_16x16x32_bf16 v[68:71], v[32:35], a[248:251], v[68:71]
v_mfma_f32_16x16x32_bf16 v[72:75], v[36:39], a[184:187], v[72:75]
v_mfma_f32_16x16x32_bf16 v[76:79], v[36:39], a[248:251], v[76:79]
s_waitcnt lgkmcnt(0)
v_mfma_f32_16x16x32_bf16 v[48:51], a[60:63], v[40:43], v[48:51]
v_mfma_f32_16x16x32_bf16 v[52:55], a[60:63], v[44:47], v[52:55]
v_mfma_f32_16x16x32_bf16 v[56:59], a[124:127], v[40:43], v[56:59]
v_mfma_f32_16x16x32_bf16 v[60:63], a[124:127], v[44:47], v[60:63]
v_mfma_f32_16x16x32_bf16 v[64:67], v[40:43], a[188:191], v[64:67]
v_mfma_f32_16x16x32_bf16 v[68:71], v[40:43], a[252:255], v[68:71]
v_mfma_f32_16x16x32_bf16 v[72:75], v[44:47], a[188:191], v[72:75]
v_mfma_f32_16x16x32_bf16 v[76:79], v[44:47], a[252:255], v[76:79]
v_cvt_pk_bf16_f32 v80, v48, v49
v_cvt_pk_bf16_f32 v81, v50, v51
v_cvt_pk_bf16_f32 v82, v56, v57
v_cvt_pk_bf16_f32 v83, v58, v59
v_cvt_pk_bf16_f32 v84, v52, v53
v_cvt_pk_bf16_f32 v85, v54, v55
v_cvt_pk_bf16_f32 v86, v60, v61
v_cvt_pk_bf16_f32 v87, v62, v63
v_cvt_pk_bf16_f32 v88, v64, v65
v_cvt_pk_bf16_f32 v89, v66, v67
v_cvt_pk_bf16_f32 v90, v72, v73
v_cvt_pk_bf16_f32 v91, v74, v75
v_cvt_pk_bf16_f32 v92, v68, v69
v_cvt_pk_bf16_f32 v93, v70, v71
v_cvt_pk_bf16_f32 v94, v76, v77
v_cvt_pk_bf16_f32 v95, v78, v79
s_lshl_b32 s50, s54, 18
s_add_u32 s50, s50, 1048576
s_add_u32 s50, s26, s50
s_addc_u32 s51, s27, 0
s_add_u32 s52, s50, 16777216
s_addc_u32 s53, s51, 0
global_store_dwordx4 v7, v[80:83], s[50:51] sc1
global_store_dwordx4 v7, v[84:87], s[50:51] offset:1024 sc1
global_store_dwordx4 v7, v[88:91], s[52:53] sc1
global_store_dwordx4 v7, v[92:95], s[52:53] offset:1024 sc1
s_add_u32 s56, s56, 1
s_waitcnt vmcnt(0)
s_barrier
s_cmp_eq_u32 s29, 0
s_cbranch_scc0 L_kv_noflag
s_lshl_b32 s34, s32, 7
s_lshl_b32 s35, s33, 2
s_add_u32 s34, s34, s35
s_add_u32 s34, s34, 0
v_mov_b32 v8, s34
v_mov_b32 v9, s56
v_cmp_eq_u32 vcc, 0, v0
s_and_saveexec_b64 s[36:37], vcc
global_store_dword v8, v9, s[26:27] sc1
s_mov_b64 exec, s[36:37]
L_kv_noflag:
s_mov_b32 s54, s57
s_mov_b32 s55, s58
s_cmp_lt_u32 s54, 64
s_cbranch_scc1 L_kv_loop
s_waitcnt vmcnt(0)
s_endpgm
L_chain_pro:
s_add_u32 s32, s30, 0
s_and_b32 s32, s32, 31
v_lshrrev_b32 v36, 4, v0
v_and_b32 v37, 15, v0
v_lshrrev_b32 v38, 2, v37
v_and_b32 v39, 3, v37
s_lshl_b32 s34, s29, 3
v_add_u32 v50, s34, v36
v_mul_u32_u24 v20, 288, v50
v_lshlrev_b32 v51, 4, v37
v_add_u32 v20, v20, v51
v_lshlrev_b32 v26, 13, v50
v_add_u32 v26, v26, v51
v_add_u32 v27, 0x8000, v26
s_and_b32 s35, s34, 15
v_add_u32 v50, s35, v36
v_lshlrev_b32 v18, 13, v50
v_add_u32 v18, v18, v51
v_add_u32 v19, 0x8000, v18
v_and_b32 v52, 1, v38
v_lshrrev_b32 v53, 1, v38
v_lshlrev_b32 v54, 2, v36
v_add_u32 v54, v54, v52
v_lshlrev_b32 v55, 3, v39
s_lshl_b32 s35, s29, 6
v_lshlrev_b32 v56, 4, v53
v_add_u32 v56, v56, v54
v_mul_u32_u24 v21, 288, v56
v_add_u32 v21, v21, v55
v_add_u32 v21, s35, v21
v_mul_u32_u24 v57, 288, v54
v_add_u32 v57, v57, v55
v_lshlrev_b32 v58, 5, v53
v_add_u32 v22, v57, v58
v_add_u32 v22, s35, v22
v_lshlrev_b32 v58, 6, v53
v_and_b32 v59, 1, v36
v_lshlrev_b32 v59, 3, v59
v_lshrrev_b32 v60, 1, v36
v_lshlrev_b32 v60, 2, v60
v_add_u32 v59, v59, v60
v_add_u32 v59, v59, v52
v_mul_u32_u24 v59, 288, v59
v_add_u32 v59, v59, v55
v_add_u32 v23, v59, v58
v_add_u32 v22, 131072, v22
v_add_u32 v21, 131072, v21
v_add_u32 v20, 131072, v20
s_mul_i32 s34, s29, 4608
s_add_u32 s34, s34, 131072
v_add_u32 v23, s34, v23
v_mul_u32_u24 v25, 288, v36
v_add_u32 v25, v25, v51
v_add_u32 v25, s34, v25
v_lshlrev_b32 v24, 10, v36
v_add_u32 v24, v24, v51
s_lshl_b32 s34, s29, 8
v_add_u32 v24, s34, v24
v_and_b32 v50, 7, v37
v_lshlrev_b32 v51, 4, v36
v_mul_u32_u24 v1, 16, v50
v_lshlrev_b32 v52, 7, v36
v_add_u32 v1, v1, v52
v_add_u32 v1, 147456, v1
v_cmp_gt_u32 s[60:61], 8, v37
v_cmp_le_u32 s[62:63], 8, v37
v_mov_b32 v2, 0xeeee
v_mov_b32 v52, 0x4444
v_cndmask_b32 v2, v2, v52, s[60:61]
v_lshlrev_b32 v52, 4, v0
s_lshl_b32 s34, s29, 15
v_add_u32 v3, s34, v52
s_lshl_b32 s34, s29, 4
v_add_u32 v53, s34, v37
v_mul_u32_u24 v4, 96, v53
v_lshrrev_b32 v54, 2, v37
v_xor_b32 v54, v54, v36
v_lshlrev_b32 v54, 3, v54
v_add_u32 v4, v4, v54
v_add_u32 v4, 155904, v4
v_lshlrev_b32 v53, 2, v36
v_add_u32 v53, v53, v38
v_mul_u32_u24 v53, 96, v53
v_add_u32 v53, 155904, v53
v_xor_b32 v54, v39, v36
v_lshlrev_b32 v54, 3, v54
v_add_u32 v5, v53, v54
s_mul_i32 s34, s29, 1536
v_add_u32 v6, s34, v53
v_or_b32 v54, 2, v39
v_xor_b32 v54, v54, v36
v_lshlrev_b32 v54, 3, v54
v_add_u32 v6, v6, v54
v_cmp_gt_u32 vcc, 2, v39
v_mov_b32 v54, 0
v_mov_b32 v57, 32
v_cndmask_b32 v54, v54, v57, vcc
v_add_u32 v6, v6, v54
v_add_u32 v7, 131072, v52
s_lshl_b32 s34, s29, 11
s_add_u32 s35, s34, 131072
v_add_u32 v8, s35, v52
v_and_b32 v53, 1, v36
v_lshlrev_b32 v53, 7, v53
v_lshrrev_b32 v54, 1, v36
v_lshlrev_b32 v54, 6, v54
v_add_u32 v53, v53, v54
v_mul_u32_u24 v9, 272, v37
v_add_u32 v9, v9, v53
s_lshl_b32 s34, s29, 4
s_add_u32 s34, s34, 147456
v_add_u32 v9, s34, v9
v_mul_u32_u24 v10, 272, v50
v_add_u32 v10, v10, v53
v_add_u32 v10, 147456, v10
s_lshl_b32 s34, s29, 3
v_add_u32 v53, s34, v36
v_mul_u32_u24 v11, 8320, v53
v_lshlrev_b32 v54, 4, v37
v_add_u32 v11, v11, v54
s_lshl_b32 s34, s32, 8
v_add_u32 v11, s34, v11
v_lshlrev_b32 v53, 3, v36
v_and_b32 v54, 7, v37
v_lshlrev_b32 v54, 5, v54
v_add_u32 v12, v53, v54
s_lshl_b32 s34, s32, 8
v_add_u32 v12, s34, v12
v_add_u32 v53, 0, v9
v_cndmask_b32 v9, v53, v9, s[60:61]
v_lshrrev_b32 v53, 1, v37
v_and_b32 v53, 3, v53
v_lshrrev_b32 v54, 3, v37
v_lshlrev_b32 v54, 5, v54
v_and_b32 v57, 1, v37
v_lshlrev_b32 v57, 4, v57
v_add_u32 v54, v54, v57
v_and_b32 v57, 1, v36
v_lshlrev_b32 v57, 2, v57
v_add_u32 v53, v53, v57
v_mul_u32_u24 v53, 1056, v53
v_add_u32 v53, v53, v54
v_lshrrev_b32 v57, 1, v36
v_lshlrev_b32 v57, 6, v57
v_add_u32 v53, v53, v57
v_add_u32 v13, 147456, v53
v_mov_b32 v53, 512
v_cndmask_b32 v53, 0, v53, s[62:63]
v_sub_u32 v13, v1, v53
v_add_u32 v1, v1, v53
s_lshl_b32 s34, s32, 11
s_lshl_b32 s35, s29, 9
s_add_u32 s34, s34, s35
v_lshlrev_b32 v53, 7, v36
v_and_b32 v54, 7, v37
v_lshlrev_b32 v54, 4, v54
v_add_u32 v53, v53, v54
v_mov_b32 v54, 0
v_mov_b32 v57, 8
v_cndmask_b32 v54, v54, v57, s[60:61]
v_add_u32 v53, v53, v54
v_add_u32 v14, s34, v53
v_lshlrev_b32 v53, 3, v0
v_add_u32 v15, s34, v53
v_mov_b32 v53, 0xf149f2ca
v_cmp_gt_u32 vcc, 2, v36
s_nop 1
v_cndmask_b32 v16, 0, v53, vcc
v_lshlrev_b32 v53, 4, v37
v_add_u32 v17, 162048, v53
v_mov_b32 v53, 0x3f80
v_mov_b32 v54, 0x3f800000
v_mov_b32 v56, 0
v_cmp_eq_u32 vcc, 0, v37
s_nop 1
v_cndmask_b32 v56, v56, v53, vcc
v_cmp_eq_u32 vcc, 1, v37
s_nop 1
v_cndmask_b32 v56, v56, v54, vcc
v_mov_b32 v57, 0
v_cmp_eq_u32 vcc, 2, v37
s_nop 1
v_cndmask_b32 v57, v57, v53, vcc
v_cmp_eq_u32 vcc, 3, v37
s_nop 1
v_cndmask_b32 v57, v57, v54, vcc
v_mov_b32 v58, 0
v_cmp_eq_u32 vcc, 4, v37
s_nop 1
v_cndmask_b32 v58, v58, v53, vcc
v_cmp_eq_u32 vcc, 5, v37
s_nop 1
v_cndmask_b32 v58, v58, v54, vcc
v_mov_b32 v59, 0
v_cmp_eq_u32 vcc, 6, v37
s_nop 1
v_cndmask_b32 v59, v59, v53, vcc
v_cmp_eq_u32 vcc, 7, v37
s_nop 1
v_cndmask_b32 v59, v59, v54, vcc
ds_write_b128 v17, v[56:59]
v_lshrrev_b32 v53, 2, v37
v_lshlrev_b32 v53, 8, v53
v_lshrrev_b32 v54, 1, v36
v_lshlrev_b32 v54, 7, v54
v_add_u32 v53, v53, v54
v_and_b32 v54, 3, v37
v_lshlrev_b32 v54, 5, v54
v_add_u32 v53, v53, v54
v_and_b32 v54, 1, v36
v_lshlrev_b32 v54, 4, v54
v_add_u32 v17, v53, v54
v_lshrrev_b32 v53, 1, v38
v_lshlrev_b32 v54, 5, v53
v_add_u32 v22, v21, v54
v_mul_u32_u24 v54, 9216, v53
v_sub_u32 v26, v22, v54
v_add_u32 v26, 4608, v26
s_cmp_lt_u32 s29, 2
s_cselect_b32 s74, 0, 0x40000
s_cmp_lt_u32 s29, 2
s_cselect_b32 s72, s8, s10
s_cselect_b32 s73, s9, s11
s_lshl_b32 s46, s32, 8
s_add_u32 s72, s72, s46
s_addc_u32 s73, s73, 0
v_lshlrev_b32 v28, 4, v0
v_lshlrev_b32 v29, 2, v0
s_xor_b32 s46, s74, 0
s_add_u32 s46, s46, 0
s_add_u32 s48, s72, s46
s_addc_u32 s49, s73, 0
global_load_dwordx4 v[48:51], v18, s[48:49]
global_load_dwordx4 v[52:55], v19, s[48:49]
s_xor_b32 s46, s74, 0
s_add_u32 s46, s46, 131072
s_add_u32 s48, s72, s46
s_addc_u32 s49, s73, 0
global_load_dwordx4 v[56:59], v18, s[48:49]
global_load_dwordx4 v[60:63], v19, s[48:49]
s_xor_b32 s46, s74, 262144
s_add_u32 s46, s46, 0
s_add_u32 s48, s72, s46
s_addc_u32 s49, s73, 0
global_load_dwordx4 v[64:67], v18, s[48:49]
global_load_dwordx4 v[68:71], v19, s[48:49]
s_xor_b32 s46, s74, 262144
s_add_u32 s46, s46, 131072
s_add_u32 s48, s72, s46
s_addc_u32 s49, s73, 0
global_load_dwordx4 v[72:75], v18, s[48:49]
global_load_dwordx4 v[76:79], v19, s[48:49]
s_xor_b32 s46, s74, 524288
s_add_u32 s46, s46, 0
s_add_u32 s48, s72, s46
s_addc_u32 s49, s73, 0
global_load_dwordx4 v[80:83], v18, s[48:49]
global_load_dwordx4 v[84:87], v19, s[48:49]
s_xor_b32 s46, s74, 524288
s_add_u32 s46, s46, 131072
s_add_u32 s48, s72, s46
s_addc_u32 s49, s73, 0
global_load_dwordx4 v[88:91], v18, s[48:49]
global_load_dwordx4 v[92:95], v19, s[48:49]
s_xor_b32 s46, s74, 786432
s_add_u32 s46, s46, 0
s_add_u32 s48, s72, s46
s_addc_u32 s49, s73, 0
global_load_dwordx4 v[96:99], v18, s[48:49]
global_load_dwordx4 v[100:103], v19, s[48:49]
s_xor_b32 s46, s74, 786432
s_add_u32 s46, s46, 131072
s_add_u32 s48, s72, s46
s_addc_u32 s49, s73, 0
global_load_dwordx4 v[104:107], v18, s[48:49]
global_load_dwordx4 v[108:111], v19, s[48:49]
s_xor_b32 s46, s74, 1048576
s_add_u32 s46, s46, 0
s_add_u32 s48, s72, s46
s_addc_u32 s49, s73, 0
global_load_dwordx4 v[112:115], v18, s[48:49]
global_load_dwordx4 v[116:119], v19, s[48:49]
s_xor_b32 s46, s74, 1048576
s_add_u32 s46, s46, 131072
s_add_u32 s48, s72, s46
s_addc_u32 s49, s73, 0
global_load_dwordx4 v[120:123], v18, s[48:49]
global_load_dwordx4 v[124:127], v19, s[48:49]
s_waitcnt vmcnt(18)
ds_write_b128 v20, v[48:51] offset:0
ds_write_b128 v20, v[52:55] offset:1152
s_xor_b32 s46, s74, 1310720
s_add_u32 s46, s46, 0
s_add_u32 s48, s72, s46
s_addc_u32 s49, s73, 0
global_load_dwordx4 v[48:51], v18, s[48:49]
global_load_dwordx4 v[52:55], v19, s[48:49]
s_waitcnt lgkmcnt(0)
s_barrier
s_cmp_eq_u32 s29, 0
s_cbranch_scc0 L_arr_2
s_mul_i32 s36, s28, 6
s_mov_b64 s[34:35], 1
s_lshl_b64 s[34:35], s[34:35], s36
s_add_u32 s35, s35, 0x10000
v_mov_b32 v30, 0
v_mov_b32 v32, s34
v_mov_b32 v33, s35
s_mov_b64 exec, 1
global_atomic_add_x2 v30, v[32:33], s[24:25] sc1
s_mov_b64 exec, -1
L_arr_2:
ds_read_b64_tr_b16 a[0:1], v21 offset:0
ds_read_b64_tr_b16 a[2:3], v21 offset:576
ds_read_b64_tr_b16 a[8:9], v21 offset:32
ds_read_b64_tr_b16 a[10:11], v21 offset:608
s_waitcnt vmcnt(18)
ds_write_b128 v20, v[56:59] offset:9216
ds_write_b128 v20, v[60:63] offset:10368
s_xor_b32 s46, s74, 1310720
s_add_u32 s46, s46, 131072
s_add_u32 s48, s72, s46
s_addc_u32 s49, s73, 0
global_load_dwordx4 v[56:59], v18, s[48:49]
global_load_dwordx4 v[60:63], v19, s[48:49]
s_waitcnt lgkmcnt(0)
s_barrier
ds_read_b64_tr_b16 a[4:5], v21 offset:9216
ds_read_b64_tr_b16 a[6:7], v21 offset:9792
ds_read_b64_tr_b16 a[12:13], v21 offset:9248
ds_read_b64_tr_b16 a[14:15], v21 offset:9824
s_waitcnt vmcnt(18)
ds_write_b128 v20, v[64:67] offset:0
ds_write_b128 v20, v[68:71] offset:1152
s_xor_b32 s46, s74, 1572864
s_add_u32 s46, s46, 0
s_add_u32 s48, s72, s46
s_addc_u32 s49, s73, 0
global_load_dwordx4 v[64:67], v18, s[48:49]
global_load_dwordx4 v[68:71], v19, s[48:49]
s_waitcnt lgkmcnt(0)
s_barrier
ds_read_b64_tr_b16 a[16:17], v21 offset:0
ds_read_b64_tr_b16 a[18:19], v21 offset:576
ds_read_b64_tr_b16 a[24:25], v21 offset:32
ds_read_b64_tr_b16 a[26:27], v21 offset:608
s_waitcnt vmcnt(18)
ds_write_b128 v20, v[72:75] offset:9216
ds_write_b128 v20, v[76:79] offset:10368
s_xor_b32 s46, s74, 1572864
s_add_u32 s46, s46, 131072
s_add_u32 s48, s72, s46
s_addc_u32 s49, s73, 0
global_load_dwordx4 v[72:75], v18, s[48:49]
global_load_dwordx4 v[76:79], v19, s[48:49]
s_waitcnt lgkmcnt(0)
s_barrier
ds_read_b64_tr_b16 a[20:21], v21 offset:9216
ds_read_b64_tr_b16 a[22:23], v21 offset:9792
ds_read_b64_tr_b16 a[28:29], v21 offset:9248
ds_read_b64_tr_b16 a[30:31], v21 offset:9824
s_waitcnt vmcnt(18)
ds_write_b128 v20, v[80:83] offset:0
ds_write_b128 v20, v[84:87] offset:1152
s_xor_b32 s46, s74, 1835008
s_add_u32 s46, s46, 0
s_add_u32 s48, s72, s46
s_addc_u32 s49, s73, 0
global_load_dwordx4 v[80:83], v18, s[48:49]
global_load_dwordx4 v[84:87], v19, s[48:49]
s_waitcnt lgkmcnt(0)
s_barrier
ds_read_b64_tr_b16 a[32:33], v21 offset:0
ds_read_b64_tr_b16 a[34:35], v21 offset:576
ds_read_b64_tr_b16 a[40:41], v21 offset:32
ds_read_b64_tr_b16 a[42:43], v21 offset:608
s_waitcnt vmcnt(18)
ds_write_b128 v20, v[88:91] offset:9216
ds_write_b128 v20, v[92:95] offset:10368
s_xor_b32 s46, s74, 1835008
s_add_u32 s46, s46, 131072
s_add_u32 s48, s72, s46
s_addc_u32 s49, s73, 0
global_load_dwordx4 v[88:91], v18, s[48:49]
global_load_dwordx4 v[92:95], v19, s[48:49]
s_waitcnt lgkmcnt(0)
s_barrier
ds_read_b64_tr_b16 a[36:37], v21 offset:9216
ds_read_b64_tr_b16 a[38:39], v21 offset:9792
ds_read_b64_tr_b16 a[44:45], v21 offset:9248
ds_read_b64_tr_b16 a[46:47], v21 offset:9824
s_waitcnt vmcnt(18)
ds_write_b128 v20, v[96:99] offset:0
ds_write_b128 v20, v[100:103] offset:1152
s_xor_b32 s46, s74, 2097152
s_add_u32 s46, s46, 0
s_add_u32 s48, s72, s46
s_addc_u32 s49, s73, 0
global_load_dwordx4 v[96:99], v18, s[48:49]
global_load_dwordx4 v[100:103], v19, s[48:49]
s_waitcnt lgkmcnt(0)
s_barrier
ds_read_b64_tr_b16 a[48:49], v21 offset:0
ds_read_b64_tr_b16 a[50:51], v21 offset:576
ds_read_b64_tr_b16 a[56:57], v21 offset:32
ds_read_b64_tr_b16 a[58:59], v21 offset:608
s_waitcnt vmcnt(18)
ds_write_b128 v20, v[104:107] offset:9216
ds_write_b128 v20, v[108:111] offset:10368
s_xor_b32 s46, s74, 2097152
s_add_u32 s46, s46, 131072
s_add_u32 s48, s72, s46
s_addc_u32 s49, s73, 0
global_load_dwordx4 v[104:107], v18, s[48:49]
global_load_dwordx4 v[108:111], v19, s[48:49]
s_waitcnt lgkmcnt(0)
s_barrier
ds_read_b64_tr_b16 a[52:53], v21 offset:9216
ds_read_b64_tr_b16 a[54:55], v21 offset:9792
ds_read_b64_tr_b16 a[60:61], v21 offset:9248
ds_read_b64_tr_b16 a[62:63], v21 offset:9824
s_waitcnt vmcnt(18)
ds_write_b128 v20, v[112:115] offset:0
ds_write_b128 v20, v[116:119] offset:1152
s_xor_b32 s46, s74, 2359296
s_add_u32 s46, s46, 0
s_add_u32 s48, s72, s46
s_addc_u32 s49, s73, 0
global_load_dwordx4 v[112:115], v18, s[48:49]
global_load_dwordx4 v[116:119], v19, s[48:49]
s_waitcnt lgkmcnt(0)
s_barrier
ds_read_b64_tr_b16 a[64:65], v21 offset:0
ds_read_b64_tr_b16 a[66:67], v21 offset:576
ds_read_b64_tr_b16 a[72:73], v21 offset:32
ds_read_b64_tr_b16 a[74:75], v21 offset:608
s_waitcnt vmcnt(18)
ds_write_b128 v20, v[120:123] offset:9216
ds_write_b128 v20, v[124:127] offset:10368
s_xor_b32 s46, s74, 2359296
s_add_u32 s46, s46, 131072
s_add_u32 s48, s72, s46
s_addc_u32 s49, s73, 0
global_load_dwordx4 v[120:123], v18, s[48:49]
global_load_dwordx4 v[124:127], v19, s[48:49]
s_waitcnt lgkmcnt(0)
s_barrier
ds_read_b64_tr_b16 a[68:69], v21 offset:9216
ds_read_b64_tr_b16 a[70:71], v21 offset:9792
ds_read_b64_tr_b16 a[76:77], v21 offset:9248
ds_read_b64_tr_b16 a[78:79], v21 offset:9824
s_waitcnt vmcnt(18)
ds_write_b128 v20, v[48:51] offset:0
ds_write_b128 v20, v[52:55] offset:1152
s_xor_b32 s46, s74, 2621440
s_add_u32 s46, s46, 0
s_add_u32 s48, s72, s46
s_addc_u32 s49, s73, 0
global_load_dwordx4 v[48:51], v18, s[48:49]
global_load_dwordx4 v[52:55], v19, s[48:49]
s_waitcnt lgkmcnt(0)
s_barrier
ds_read_b64_tr_b16 a[80:81], v21 offset:0
ds_read_b64_tr_b16 a[82:83], v21 offset:576
ds_read_b64_tr_b16 a[88:89], v21 offset:32
ds_read_b64_tr_b16 a[90:91], v21 offset:608
s_waitcnt vmcnt(18)
ds_write_b128 v20, v[56:59] offset:9216
ds_write_b128 v20, v[60:63] offset:10368
s_xor_b32 s46, s74, 2621440
s_add_u32 s46, s46, 131072
s_add_u32 s48, s72, s46
s_addc_u32 s49, s73, 0
global_load_dwordx4 v[56:59], v18, s[48:49]
global_load_dwordx4 v[60:63], v19, s[48:49]
s_waitcnt lgkmcnt(0)
s_barrier
ds_read_b64_tr_b16 a[84:85], v21 offset:9216
ds_read_b64_tr_b16 a[86:87], v21 offset:9792
ds_read_b64_tr_b16 a[92:93], v21 offset:9248
ds_read_b64_tr_b16 a[94:95], v21 offset:9824
s_waitcnt vmcnt(18)
ds_write_b128 v20, v[64:67] offset:0
ds_write_b128 v20, v[68:71] offset:1152
s_xor_b32 s46, s74, 2883584
s_add_u32 s46, s46, 0
s_add_u32 s48, s72, s46
s_addc_u32 s49, s73, 0
global_load_dwordx4 v[64:67], v18, s[48:49]
global_load_dwordx4 v[68:71], v19, s[48:49]
s_waitcnt lgkmcnt(0)
s_barrier
ds_read_b64_tr_b16 a[96:97], v21 offset:0
ds_read_b64_tr_b16 a[98:99], v21 offset:576
ds_read_b64_tr_b16 a[104:105], v21 offset:32
ds_read_b64_tr_b16 a[106:107], v21 offset:608
s_waitcnt vmcnt(18)
ds_write_b128 v20, v[72:75] offset:9216
ds_write_b128 v20, v[76:79] offset:10368
s_xor_b32 s46, s74, 2883584
s_add_u32 s46, s46, 131072
s_add_u32 s48, s72, s46
s_addc_u32 s49, s73, 0
global_load_dwordx4 v[72:75], v18, s[48:49]
global_load_dwordx4 v[76:79], v19, s[48:49]
s_waitcnt lgkmcnt(0)
s_barrier
ds_read_b64_tr_b16 a[100:101], v21 offset:9216
ds_read_b64_tr_b16 a[102:103], v21 offset:9792
ds_read_b64_tr_b16 a[108:109], v21 offset:9248
ds_read_b64_tr_b16 a[110:111], v21 offset:9824
s_waitcnt vmcnt(18)
ds_write_b128 v20, v[80:83] offset:0
ds_write_b128 v20, v[84:87] offset:1152
s_xor_b32 s46, s74, 3145728
s_add_u32 s46, s46, 0
s_add_u32 s48, s72, s46
s_addc_u32 s49, s73, 0
global_load_dwordx4 v[80:83], v18, s[48:49]
global_load_dwordx4 v[84:87], v19, s[48:49]
s_waitcnt lgkmcnt(0)
s_barrier
ds_read_b64_tr_b16 a[112:113], v21 offset:0
ds_read_b64_tr_b16 a[114:115], v21 offset:576
ds_read_b64_tr_b16 a[120:121], v21 offset:32
ds_read_b64_tr_b16 a[122:123], v21 offset:608
s_waitcnt vmcnt(18)
ds_write_b128 v20, v[88:91] offset:9216
ds_write_b128 v20, v[92:95] offset:10368
s_xor_b32 s46, s74, 3145728
s_add_u32 s46, s46, 131072
s_add_u32 s48, s72, s46
s_addc_u32 s49, s73, 0
global_load_dwordx4 v[88:91], v18, s[48:49]
global_load_dwordx4 v[92:95], v19, s[48:49]
s_waitcnt lgkmcnt(0)
s_barrier
ds_read_b64_tr_b16 a[116:117], v21 offset:9216
ds_read_b64_tr_b16 a[118:119], v21 offset:9792
ds_read_b64_tr_b16 a[124:125], v21 offset:9248
ds_read_b64_tr_b16 a[126:127], v21 offset:9824
s_waitcnt vmcnt(18)
ds_write_b128 v20, v[96:99] offset:0
ds_write_b128 v20, v[100:103] offset:1152
s_xor_b32 s46, s74, 3407872
s_add_u32 s46, s46, 0
s_add_u32 s48, s72, s46
s_addc_u32 s49, s73, 0
global_load_dwordx4 v[96:99], v18, s[48:49]
global_load_dwordx4 v[100:103], v19, s[48:49]
s_waitcnt lgkmcnt(0)
s_barrier
ds_read_b64_tr_b16 a[128:129], v21 offset:0
ds_read_b64_tr_b16 a[130:131], v21 offset:576
ds_read_b64_tr_b16 a[136:137], v21 offset:32
ds_read_b64_tr_b16 a[138:139], v21 offset:608
s_waitcnt vmcnt(18)
ds_write_b128 v20, v[104:107] offset:9216
ds_write_b128 v20, v[108:111] offset:10368
s_xor_b32 s46, s74, 3407872
s_add_u32 s46, s46, 131072
s_add_u32 s48, s72, s46
s_addc_u32 s49, s73, 0
global_load_dwordx4 v[104:107], v18, s[48:49]
global_load_dwordx4 v[108:111], v19, s[48:49]
s_waitcnt lgkmcnt(0)
s_barrier
ds_read_b64_tr_b16 a[132:133], v21 offset:9216
ds_read_b64_tr_b16 a[134:135], v21 offset:9792
ds_read_b64_tr_b16 a[140:141], v21 offset:9248
ds_read_b64_tr_b16 a[142:143], v21 offset:9824
s_waitcnt vmcnt(18)
ds_write_b128 v20, v[112:115] offset:0
ds_write_b128 v20, v[116:119] offset:1152
s_xor_b32 s46, s74, 3670016
s_add_u32 s46, s46, 0
s_add_u32 s48, s72, s46
s_addc_u32 s49, s73, 0
global_load_dwordx4 v[112:115], v18, s[48:49]
global_load_dwordx4 v[116:119], v19, s[48:49]
s_waitcnt lgkmcnt(0)
s_barrier
ds_read_b64_tr_b16 a[144:145], v21 offset:0
ds_read_b64_tr_b16 a[146:147], v21 offset:576
ds_read_b64_tr_b16 a[152:153], v21 offset:32
ds_read_b64_tr_b16 a[154:155], v21 offset:608
s_waitcnt vmcnt(18)
ds_write_b128 v20, v[120:123] offset:9216
ds_write_b128 v20, v[124:127] offset:10368
s_xor_b32 s46, s74, 3670016
s_add_u32 s46, s46, 131072
s_add_u32 s48, s72, s46
s_addc_u32 s49, s73, 0
global_load_dwordx4 v[120:123], v18, s[48:49]
global_load_dwordx4 v[124:127], v19, s[48:49]
s_waitcnt lgkmcnt(0)
s_barrier
ds_read_b64_tr_b16 a[148:149], v21 offset:9216
ds_read_b64_tr_b16 a[150:151], v21 offset:9792
ds_read_b64_tr_b16 a[156:157], v21 offset:9248
ds_read_b64_tr_b16 a[158:159], v21 offset:9824
s_waitcnt vmcnt(18)
ds_write_b128 v20, v[48:51] offset:0
ds_write_b128 v20, v[52:55] offset:1152
s_xor_b32 s46, s74, 3932160
s_add_u32 s46, s46, 0
s_add_u32 s48, s72, s46
s_addc_u32 s49, s73, 0
global_load_dwordx4 v[48:51], v18, s[48:49]
global_load_dwordx4 v[52:55], v19, s[48:49]
s_waitcnt lgkmcnt(0)
s_barrier
ds_read_b64_tr_b16 a[160:161], v21 offset:0
ds_read_b64_tr_b16 a[162:163], v21 offset:576
ds_read_b64_tr_b16 a[168:169], v21 offset:32
ds_read_b64_tr_b16 a[170:171], v21 offset:608
s_waitcnt vmcnt(18)
ds_write_b128 v20, v[56:59] offset:9216
ds_write_b128 v20, v[60:63] offset:10368
s_xor_b32 s46, s74, 3932160
s_add_u32 s46, s46, 131072
s_add_u32 s48, s72, s46
s_addc_u32 s49, s73, 0
global_load_dwordx4 v[56:59], v18, s[48:49]
global_load_dwordx4 v[60:63], v19, s[48:49]
s_waitcnt lgkmcnt(0)
s_barrier
ds_read_b64_tr_b16 a[164:165], v21 offset:9216
ds_read_b64_tr_b16 a[166:167], v21 offset:9792
ds_read_b64_tr_b16 a[172:173], v21 offset:9248
ds_read_b64_tr_b16 a[174:175], v21 offset:9824
s_waitcnt vmcnt(18)
ds_write_b128 v20, v[64:67] offset:0
ds_write_b128 v20, v[68:71] offset:1152
s_lshl_b32 s46, s32, 8
s_add_u32 s46, s46, s74
s_add_u32 s72, s12, s46
s_addc_u32 s73, s13, 0
s_add_u32 s48, s72, 0
s_addc_u32 s49, s73, 0
global_load_dwordx4 v[64:67], v18, s[48:49]
global_load_dwordx4 v[68:71], v19, s[48:49]
s_waitcnt lgkmcnt(0)
s_barrier
ds_read_b64_tr_b16 a[176:177], v21 offset:0
ds_read_b64_tr_b16 a[178:179], v21 offset:576
ds_read_b64_tr_b16 a[184:185], v21 offset:32
ds_read_b64_tr_b16 a[186:187], v21 offset:608
s_waitcnt vmcnt(18)
ds_write_b128 v20, v[72:75] offset:9216
ds_write_b128 v20, v[76:79] offset:10368
s_add_u32 s48, s72, 131072
s_addc_u32 s49, s73, 0
global_load_dwordx4 v[72:75], v18, s[48:49]
global_load_dword v46, v29, s[24:25] sc1
global_load_dwordx4 v[76:79], v19, s[48:49]
s_waitcnt lgkmcnt(0)
s_barrier
ds_read_b64_tr_b16 a[180:181], v21 offset:9216
ds_read_b64_tr_b16 a[182:183], v21 offset:9792
ds_read_b64_tr_b16 a[188:189], v21 offset:9248
ds_read_b64_tr_b16 a[190:191], v21 offset:9824
s_waitcnt vmcnt(19)
ds_write_b128 v20, v[80:83] offset:0
ds_write_b128 v20, v[84:87] offset:1152
s_add_u32 s48, s72, 524288
s_addc_u32 s49, s73, 0
global_load_dwordx4 v[80:83], v18, s[48:49]
global_load_dwordx4 v[84:87], v19, s[48:49]
s_waitcnt lgkmcnt(0)
s_barrier
ds_read_b64_tr_b16 a[192:193], v21 offset:0
ds_read_b64_tr_b16 a[194:195], v21 offset:576
ds_read_b64_tr_b16 a[200:201], v21 offset:32
ds_read_b64_tr_b16 a[202:203], v21 offset:608
s_waitcnt vmcnt(19)
ds_write_b128 v20, v[88:91] offset:9216
ds_write_b128 v20, v[92:95] offset:10368
s_add_u32 s48, s72, 655360
s_addc_u32 s49, s73, 0
global_load_dwordx4 v[88:91], v18, s[48:49]
global_load_dwordx4 v[92:95], v19, s[48:49]
s_waitcnt lgkmcnt(0)
s_barrier
ds_read_b64_tr_b16 a[196:197], v21 offset:9216
ds_read_b64_tr_b16 a[198:199], v21 offset:9792
ds_read_b64_tr_b16 a[204:205], v21 offset:9248
ds_read_b64_tr_b16 a[206:207], v21 offset:9824
s_waitcnt vmcnt(19)
ds_write_b128 v20, v[96:99] offset:0
ds_write_b128 v20, v[100:103] offset:1152
s_add_u32 s48, s72, 1048576
s_addc_u32 s49, s73, 0
global_load_dwordx4 v[96:99], v18, s[48:49]
global_load_dwordx4 v[100:103], v19, s[48:49]
s_waitcnt lgkmcnt(0)
s_barrier
ds_read_b64_tr_b16 a[208:209], v21 offset:0
ds_read_b64_tr_b16 a[210:211], v21 offset:576
ds_read_b64_tr_b16 a[216:217], v21 offset:32
ds_read_b64_tr_b16 a[218:219], v21 offset:608
s_waitcnt vmcnt(19)
ds_write_b128 v20, v[104:107] offset:9216
ds_write_b128 v20, v[108:111] offset:10368
s_add_u32 s48, s72, 1179648
s_addc_u32 s49, s73, 0
global_load_dwordx4 v[104:107], v18, s[48:49]
global_load_dwordx4 v[108:111], v19, s[48:49]
s_waitcnt lgkmcnt(0)
s_barrier
ds_read_b64_tr_b16 a[212:213], v21 offset:9216
ds_read_b64_tr_b16 a[214:215], v21 offset:9792
ds_read_b64_tr_b16 a[220:221], v21 offset:9248
ds_read_b64_tr_b16 a[222:223], v21 offset:9824
s_waitcnt vmcnt(19)
ds_write_b128 v20, v[112:115] offset:0
ds_write_b128 v20, v[116:119] offset:1152
s_add_u32 s48, s72, 1572864
s_addc_u32 s49, s73, 0
global_load_dwordx4 v[112:115], v18, s[48:49]
global_load_dwordx4 v[116:119], v19, s[48:49]
s_waitcnt lgkmcnt(0)
s_barrier
ds_read_b64_tr_b16 a[224:225], v21 offset:0
ds_read_b64_tr_b16 a[226:227], v21 offset:576
ds_read_b64_tr_b16 a[232:233], v21 offset:32
ds_read_b64_tr_b16 a[234:235], v21 offset:608
s_waitcnt vmcnt(19)
ds_write_b128 v20, v[120:123] offset:9216
ds_write_b128 v20, v[124:127] offset:10368
s_add_u32 s48, s72, 1703936
s_addc_u32 s49, s73, 0
global_load_dwordx4 v[120:123], v18, s[48:49]
global_load_dwordx4 v[124:127], v19, s[48:49]
s_waitcnt lgkmcnt(0)
s_barrier
ds_read_b64_tr_b16 a[228:229], v21 offset:9216
ds_read_b64_tr_b16 a[230:231], v21 offset:9792
ds_read_b64_tr_b16 a[236:237], v21 offset:9248
ds_read_b64_tr_b16 a[238:239], v21 offset:9824
s_waitcnt vmcnt(19)
ds_write_b128 v20, v[48:51] offset:0
ds_write_b128 v20, v[52:55] offset:1152
s_add_u32 s48, s72, 2097152
s_addc_u32 s49, s73, 0
global_load_dwordx4 v[48:51], v18, s[48:49]
global_load_dwordx4 v[52:55], v19, s[48:49]
s_waitcnt lgkmcnt(0)
s_barrier
ds_read_b64_tr_b16 a[240:241], v21 offset:0
ds_read_b64_tr_b16 a[242:243], v21 offset:576
ds_read_b64_tr_b16 a[248:249], v21 offset:32
ds_read_b64_tr_b16 a[250:251], v21 offset:608
s_waitcnt vmcnt(19)
ds_write_b128 v20, v[56:59] offset:9216
ds_write_b128 v20, v[60:63] offset:10368
s_add_u32 s48, s72, 2228224
s_addc_u32 s49, s73, 0
global_load_dwordx4 v[56:59], v18, s[48:49]
global_load_dwordx4 v[60:63], v19, s[48:49]
s_waitcnt lgkmcnt(0)
s_barrier
ds_read_b64_tr_b16 a[244:245], v21 offset:9216
ds_read_b64_tr_b16 a[246:247], v21 offset:9792
ds_read_b64_tr_b16 a[252:253], v21 offset:9248
ds_read_b64_tr_b16 a[254:255], v21 offset:9824
s_waitcnt vmcnt(19)
ds_write_b128 v20, v[64:67] offset:0
ds_write_b128 v20, v[68:71] offset:1152
s_add_u32 s48, s72, 2621440
s_addc_u32 s49, s73, 0
global_load_dwordx4 v[64:67], v18, s[48:49]
global_load_dwordx4 v[68:71], v19, s[48:49]
s_waitcnt lgkmcnt(0)
s_barrier
ds_read_b64_tr_b16 v[128:129], v26 offset:0
ds_read_b64_tr_b16 v[130:131], v26 offset:576
ds_read_b64_tr_b16 v[30:31], v22 offset:0
ds_read_b64_tr_b16 v[32:33], v22 offset:576
s_waitcnt lgkmcnt(0)
ds_write_b128 v3, v[30:33] offset:0
s_waitcnt vmcnt(18)
ds_write_b128 v20, v[72:75] offset:9216
ds_write_b128 v20, v[76:79] offset:10368
s_add_u32 s48, s72, 2752512
s_addc_u32 s49, s73, 0
global_load_dwordx4 v[72:75], v18, s[48:49]
global_load_dwordx4 v[76:79], v19, s[48:49]
s_waitcnt lgkmcnt(0)
s_barrier
ds_read_b64_tr_b16 v[132:133], v26 offset:9216
ds_read_b64_tr_b16 v[134:135], v26 offset:9792
ds_read_b64_tr_b16 v[30:31], v22 offset:9216
ds_read_b64_tr_b16 v[32:33], v22 offset:9792
s_waitcnt lgkmcnt(0)
ds_write_b128 v3, v[30:33] offset:1024
s_waitcnt vmcnt(18)
ds_write_b128 v20, v[80:83] offset:0
ds_write_b128 v20, v[84:87] offset:1152
s_add_u32 s48, s72, 3145728
s_addc_u32 s49, s73, 0
global_load_dwordx4 v[80:83], v18, s[48:49]
global_load_dwordx4 v[84:87], v19, s[48:49]
s_waitcnt lgkmcnt(0)
s_barrier
ds_read_b64_tr_b16 v[136:137], v26 offset:0
ds_read_b64_tr_b16 v[138:139], v26 offset:576
ds_read_b64_tr_b16 v[30:31], v22 offset:0
ds_read_b64_tr_b16 v[32:33], v22 offset:576
s_waitcnt lgkmcnt(0)
ds_write_b128 v3, v[30:33] offset:2048
s_waitcnt vmcnt(18)
ds_write_b128 v20, v[88:91] offset:9216
ds_write_b128 v20, v[92:95] offset:10368
s_add_u32 s48, s72, 3276800
s_addc_u32 s49, s73, 0
global_load_dwordx4 v[88:91], v18, s[48:49]
global_load_dwordx4 v[92:95], v19, s[48:49]
s_waitcnt lgkmcnt(0)
s_barrier
ds_read_b64_tr_b16 v[140:141], v26 offset:9216
ds_read_b64_tr_b16 v[142:143], v26 offset:9792
ds_read_b64_tr_b16 v[30:31], v22 offset:9216
ds_read_b64_tr_b16 v[32:33], v22 offset:9792
s_waitcnt lgkmcnt(0)
ds_write_b128 v3, v[30:33] offset:3072
s_waitcnt vmcnt(18)
ds_write_b128 v20, v[96:99] offset:0
ds_write_b128 v20, v[100:103] offset:1152
s_add_u32 s48, s72, 3670016
s_addc_u32 s49, s73, 0
global_load_dwordx4 v[96:99], v18, s[48:49]
global_load_dwordx4 v[100:103], v19, s[48:49]
s_waitcnt lgkmcnt(0)
s_barrier
ds_read_b64_tr_b16 v[144:145], v26 offset:0
ds_read_b64_tr_b16 v[146:147], v26 offset:576
ds_read_b64_tr_b16 v[30:31], v22 offset:0
ds_read_b64_tr_b16 v[32:33], v22 offset:576
s_waitcnt lgkmcnt(0)
ds_write_b128 v3, v[30:33] offset:4096
s_waitcnt vmcnt(18)
ds_write_b128 v20, v[104:107] offset:9216
ds_write_b128 v20, v[108:111] offset:10368
s_add_u32 s48, s72, 3801088
s_addc_u32 s49, s73, 0
global_load_dwordx4 v[104:107], v18, s[48:49]
global_load_dwordx4 v[108:111], v19, s[48:49]
s_waitcnt lgkmcnt(0)
s_barrier
ds_read_b64_tr_b16 v[148:149], v26 offset:9216
ds_read_b64_tr_b16 v[150:151], v26 offset:9792
ds_read_b64_tr_b16 v[30:31], v22 offset:9216
ds_read_b64_tr_b16 v[32:33], v22 offset:9792
s_waitcnt lgkmcnt(0)
ds_write_b128 v3, v[30:33] offset:5120
s_waitcnt vmcnt(18)
ds_write_b128 v20, v[112:115] offset:0
ds_write_b128 v20, v[116:119] offset:1152
s_lshl_b32 s46, s32, 17
s_add_u32 s72, s14, s46
s_addc_u32 s73, s15, 0
s_add_u32 s46, s29, 0
s_and_b32 s46, s46, 3
s_lshl_b32 s46, s46, 15
s_add_u32 s48, s72, s46
s_addc_u32 s49, s73, 0
global_load_dwordx4 v[112:115], v24, s[48:49]
s_add_u32 s48, s48, 4096
s_addc_u32 s49, s49, 0
global_load_dwordx4 v[116:119], v24, s[48:49]
s_waitcnt lgkmcnt(0)
s_barrier
ds_read_b64_tr_b16 v[152:153], v26 offset:0
ds_read_b64_tr_b16 v[154:155], v26 offset:576
ds_read_b64_tr_b16 v[30:31], v22 offset:0
ds_read_b64_tr_b16 v[32:33], v22 offset:576
s_waitcnt lgkmcnt(0)
ds_write_b128 v3, v[30:33] offset:6144
s_waitcnt vmcnt(18)
ds_write_b128 v20, v[120:123] offset:9216
ds_write_b128 v20, v[124:127] offset:10368
s_add_u32 s48, s48, 12288
s_addc_u32 s49, s49, 0
global_load_dwordx4 v[120:123], v24, s[48:49]
s_add_u32 s48, s48, 4096
s_addc_u32 s49, s49, 0
global_load_dwordx4 v[124:127], v24, s[48:49]
s_waitcnt lgkmcnt(0)
s_barrier
ds_read_b64_tr_b16 v[156:157], v26 offset:9216
ds_read_b64_tr_b16 v[158:159], v26 offset:9792
ds_read_b64_tr_b16 v[30:31], v22 offset:9216
ds_read_b64_tr_b16 v[32:33], v22 offset:9792
s_waitcnt lgkmcnt(0)
ds_write_b128 v3, v[30:33] offset:7168
s_waitcnt vmcnt(18)
ds_write_b128 v20, v[48:51] offset:0
ds_write_b128 v20, v[52:55] offset:1152
s_sub_u32 s48, s48, 12288
s_subb_u32 s49, s49, 0
global_load_dwordx4 v[48:51], v24, s[48:49]
s_add_u32 s48, s48, 4096
s_addc_u32 s49, s49, 0
global_load_dwordx4 v[52:55], v24, s[48:49]
s_waitcnt lgkmcnt(0)
s_barrier
ds_read_b64_tr_b16 v[160:161], v26 offset:0
ds_read_b64_tr_b16 v[162:163], v26 offset:576
ds_read_b64_tr_b16 v[30:31], v22 offset:0
ds_read_b64_tr_b16 v[32:33], v22 offset:576
s_waitcnt lgkmcnt(0)
ds_write_b128 v3, v[30:33] offset:8192
s_waitcnt vmcnt(18)
ds_write_b128 v20, v[56:59] offset:9216
ds_write_b128 v20, v[60:63] offset:10368
s_add_u32 s48, s48, 12288
s_addc_u32 s49, s49, 0
global_load_dwordx4 v[56:59], v24, s[48:49]
s_add_u32 s48, s48, 4096
s_addc_u32 s49, s49, 0
global_load_dwordx4 v[60:63], v24, s[48:49]
s_waitcnt lgkmcnt(0)
s_barrier
ds_read_b64_tr_b16 v[164:165], v26 offset:9216
ds_read_b64_tr_b16 v[166:167], v26 offset:9792
ds_read_b64_tr_b16 v[30:31], v22 offset:9216
ds_read_b64_tr_b16 v[32:33], v22 offset:9792
s_waitcnt lgkmcnt(0)
ds_write_b128 v3, v[30:33] offset:9216
s_waitcnt vmcnt(18)
ds_write_b128 v20, v[64:67] offset:0
ds_write_b128 v20, v[68:71] offset:1152
s_add_u32 s46, s29, 1
s_and_b32 s46, s46, 3
s_lshl_b32 s46, s46, 15
s_add_u32 s48, s72, s46
s_addc_u32 s49, s73, 0
global_load_dwordx4 v[64:67], v24, s[48:49]
s_add_u32 s48, s48, 4096
s_addc_u32 s49, s49, 0
global_load_dwordx4 v[68:71], v24, s[48:49]
s_waitcnt lgkmcnt(0)
s_barrier
ds_read_b64_tr_b16 v[168:169], v26 offset:0
ds_read_b64_tr_b16 v[170:171], v26 offset:576
ds_read_b64_tr_b16 v[30:31], v22 offset:0
ds_read_b64_tr_b16 v[32:33], v22 offset:576
s_waitcnt lgkmcnt(0)
ds_write_b128 v3, v[30:33] offset:10240
s_waitcnt vmcnt(18)
ds_write_b128 v20, v[72:75] offset:9216
ds_write_b128 v20, v[76:79] offset:10368
s_add_u32 s48, s48, 12288
s_addc_u32 s49, s49, 0
global_load_dwordx4 v[72:75], v24, s[48:49]
s_add_u32 s48, s48, 4096
s_addc_u32 s49, s49, 0
global_load_dwordx4 v[76:79], v24, s[48:49]
s_waitcnt lgkmcnt(0)
s_barrier
ds_read_b64_tr_b16 v[172:173], v26 offset:9216
ds_read_b64_tr_b16 v[174:175], v26 offset:9792
ds_read_b64_tr_b16 v[30:31], v22 offset:9216
ds_read_b64_tr_b16 v[32:33], v22 offset:9792
s_waitcnt lgkmcnt(0)
ds_write_b128 v3, v[30:33] offset:11264
s_waitcnt vmcnt(18)
v_readlane_b32 s34, v46, 0
v_readlane_b32 s35, v46, 1
v_readlane_b32 s36, v46, 32
v_readlane_b32 s37, v46, 48
s_lshl_b32 s36, s36, 8
s_add_u32 s36, s36, s37
s_lshr_b32 s37, s35, 16
s_lshl_b32 s37, s37, 16
s_add_u32 s36, s36, s37
s_cmp_eq_u32 s36, 2121856
s_cbranch_scc0 L_c_nosb
s_mul_i32 s36, s28, 6
s_lshr_b64 s[34:35], s[34:35], s36
s_and_b32 s34, s34, 63
s_cmp_eq_u32 s34, 32
s_cselect_b32 s31, 0, 1
s_mov_b32 s40, 1
L_c_nosb:
ds_write_b128 v20, v[80:83] offset:0
ds_write_b128 v20, v[84:87] offset:1152
s_sub_u32 s48, s48, 12288
s_subb_u32 s49, s49, 0
global_load_dwordx4 v[80:83], v24, s[48:49]
s_add_u32 s48, s48, 4096
s_addc_u32 s49, s49, 0
global_load_dwordx4 v[84:87], v24, s[48:49]
s_waitcnt lgkmcnt(0)
s_barrier
ds_read_b64_tr_b16 v[176:177], v26 offset:0
ds_read_b64_tr_b16 v[178:179], v26 offset:576
ds_read_b64_tr_b16 v[30:31], v22 offset:0
ds_read_b64_tr_b16 v[32:33], v22 offset:576
s_waitcnt lgkmcnt(0)
ds_write_b128 v3, v[30:33] offset:12288
s_waitcnt vmcnt(18)
ds_write_b128 v20, v[88:91] offset:9216
ds_write_b128 v20, v[92:95] offset:10368
s_add_u32 s48, s48, 12288
s_addc_u32 s49, s49, 0
global_load_dwordx4 v[88:91], v24, s[48:49]
s_add_u32 s48, s48, 4096
s_addc_u32 s49, s49, 0
global_load_dwordx4 v[92:95], v24, s[48:49]
s_lshl_b32 s44, s32, 7
s_add_u32 s44, s44, 0
s_add_u32 s46, s26, s44
s_addc_u32 s47, s27, 0
global_load_dword v47, v29, s[46:47] sc1
s_waitcnt lgkmcnt(0)
s_barrier
ds_read_b64_tr_b16 v[180:181], v26 offset:9216
ds_read_b64_tr_b16 v[182:183], v26 offset:9792
ds_read_b64_tr_b16 v[30:31], v22 offset:9216
ds_read_b64_tr_b16 v[32:33], v22 offset:9792
s_waitcnt lgkmcnt(0)
ds_write_b128 v3, v[30:33] offset:13312
s_waitcnt vmcnt(19)
ds_write_b128 v20, v[96:99] offset:0
ds_write_b128 v20, v[100:103] offset:1152
s_add_u32 s46, s29, 2
s_and_b32 s46, s46, 3
s_lshl_b32 s46, s46, 15
s_add_u32 s48, s72, s46
s_addc_u32 s49, s73, 0
global_load_dwordx4 v[96:99], v24, s[48:49]
s_add_u32 s48, s48, 4096
s_addc_u32 s49, s49, 0
global_load_dwordx4 v[100:103], v24, s[48:49]
s_waitcnt lgkmcnt(0)
s_barrier
ds_read_b64_tr_b16 v[184:185], v26 offset:0
ds_read_b64_tr_b16 v[186:187], v26 offset:576
ds_read_b64_tr_b16 v[30:31], v22 offset:0
ds_read_b64_tr_b16 v[32:33], v22 offset:576
s_waitcnt lgkmcnt(0)
ds_write_b128 v3, v[30:33] offset:14336
s_waitcnt vmcnt(19)
ds_write_b128 v20, v[104:107] offset:9216
ds_write_b128 v20, v[108:111] offset:10368
s_add_u32 s48, s48, 12288
s_addc_u32 s49, s49, 0
global_load_dwordx4 v[104:107], v24, s[48:49]
s_add_u32 s48, s48, 4096
s_addc_u32 s49, s49, 0
global_load_dwordx4 v[108:111], v24, s[48:49]
s_waitcnt lgkmcnt(0)
s_barrier
ds_read_b64_tr_b16 v[188:189], v26 offset:9216
ds_read_b64_tr_b16 v[190:191], v26 offset:9792
ds_read_b64_tr_b16 v[30:31], v22 offset:9216
ds_read_b64_tr_b16 v[32:33], v22 offset:9792
s_waitcnt lgkmcnt(0)
ds_write_b128 v3, v[30:33] offset:15360
s_waitcnt lgkmcnt(0)
s_barrier
s_waitcnt vmcnt(17)
ds_write_b128 v25, v[112:115] offset:0
ds_write_b128 v25, v[116:119] offset:1152
ds_write_b128 v25, v[120:123] offset:2304
ds_write_b128 v25, v[124:127] offset:3456
s_sub_u32 s48, s48, 12288
s_subb_u32 s49, s49, 0
global_load_dwordx4 v[112:115], v24, s[48:49]
s_add_u32 s48, s48, 4096
s_addc_u32 s49, s49, 0
global_load_dwordx4 v[116:119], v24, s[48:49]
s_add_u32 s48, s48, 12288
s_addc_u32 s49, s49, 0
global_load_dwordx4 v[120:123], v24, s[48:49]
s_add_u32 s48, s48, 4096
s_addc_u32 s49, s49, 0
global_load_dwordx4 v[124:127], v24, s[48:49]
s_waitcnt lgkmcnt(0)
ds_read_b64_tr_b16 v[192:193], v23 offset:0
ds_read_b64_tr_b16 v[194:195], v23 offset:576
ds_read_b64_tr_b16 v[200:201], v23 offset:32
ds_read_b64_tr_b16 v[202:203], v23 offset:608
ds_read_b64_tr_b16 v[208:209], v23 offset:128
ds_read_b64_tr_b16 v[210:211], v23 offset:704
ds_read_b64_tr_b16 v[216:217], v23 offset:160
ds_read_b64_tr_b16 v[218:219], v23 offset:736
s_waitcnt lgkmcnt(0)
s_waitcnt vmcnt(17)
ds_write_b128 v25, v[48:51] offset:0
ds_write_b128 v25, v[52:55] offset:1152
ds_write_b128 v25, v[56:59] offset:2304
ds_write_b128 v25, v[60:63] offset:3456
s_add_u32 s46, s29, 3
s_and_b32 s46, s46, 3
s_lshl_b32 s46, s46, 15
s_add_u32 s48, s72, s46
s_addc_u32 s49, s73, 0
global_load_dwordx4 v[48:51], v24, s[48:49]
s_add_u32 s48, s48, 4096
s_addc_u32 s49, s49, 0
global_load_dwordx4 v[52:55], v24, s[48:49]
s_add_u32 s48, s48, 12288
s_addc_u32 s49, s49, 0
global_load_dwordx4 v[56:59], v24, s[48:49]
s_add_u32 s48, s48, 4096
s_addc_u32 s49, s49, 0
global_load_dwordx4 v[60:63], v24, s[48:49]
s_waitcnt lgkmcnt(0)
ds_read_b64_tr_b16 v[196:197], v23 offset:0
ds_read_b64_tr_b16 v[198:199], v23 offset:576
ds_read_b64_tr_b16 v[204:205], v23 offset:32
ds_read_b64_tr_b16 v[206:207], v23 offset:608
ds_read_b64_tr_b16 v[212:213], v23 offset:128
ds_read_b64_tr_b16 v[214:215], v23 offset:704
ds_read_b64_tr_b16 v[220:221], v23 offset:160
ds_read_b64_tr_b16 v[222:223], v23 offset:736
s_waitcnt lgkmcnt(0)
s_waitcnt vmcnt(17)
ds_write_b128 v25, v[64:67] offset:0
ds_write_b128 v25, v[68:71] offset:1152
ds_write_b128 v25, v[72:75] offset:2304
ds_write_b128 v25, v[76:79] offset:3456
s_sub_u32 s48, s48, 12288
s_subb_u32 s49, s49, 0
global_load_dwordx4 v[64:67], v24, s[48:49]
s_add_u32 s48, s48, 4096
s_addc_u32 s49, s49, 0
global_load_dwordx4 v[68:71], v24, s[48:49]
s_add_u32 s48, s48, 12288
s_addc_u32 s49, s49, 0
global_load_dwordx4 v[72:75], v24, s[48:49]
s_add_u32 s48, s48, 4096
s_addc_u32 s49, s49, 0
global_load_dwordx4 v[76:79], v24, s[48:49]
s_waitcnt lgkmcnt(0)
ds_read_b64_tr_b16 v[224:225], v23 offset:0
ds_read_b64_tr_b16 v[226:227], v23 offset:576
ds_read_b64_tr_b16 v[232:233], v23 offset:32
ds_read_b64_tr_b16 v[234:235], v23 offset:608
ds_read_b64_tr_b16 v[240:241], v23 offset:128
ds_read_b64_tr_b16 v[242:243], v23 offset:704
ds_read_b64_tr_b16 v[248:249], v23 offset:160
ds_read_b64_tr_b16 v[250:251], v23 offset:736
s_waitcnt lgkmcnt(0)
s_waitcnt vmcnt(17)
ds_write_b128 v25, v[80:83] offset:0
ds_write_b128 v25, v[84:87] offset:1152
ds_write_b128 v25, v[88:91] offset:2304
ds_write_b128 v25, v[92:95] offset:3456
s_waitcnt lgkmcnt(0)
ds_read_b64_tr_b16 v[228:229], v23 offset:0
ds_read_b64_tr_b16 v[230:231], v23 offset:576
ds_read_b64_tr_b16 v[236:237], v23 offset:32
ds_read_b64_tr_b16 v[238:239], v23 offset:608
ds_read_b64_tr_b16 v[244:245], v23 offset:128
ds_read_b64_tr_b16 v[246:247], v23 offset:704
ds_read_b64_tr_b16 v[252:253], v23 offset:160
ds_read_b64_tr_b16 v[254:255], v23 offset:736
s_waitcnt lgkmcnt(0)
s_lshl_b32 s44, s29, 11
s_add_u32 s46, s6, s44
s_addc_u32 s47, s7, 0
global_load_dwordx4 v[80:83], v28, s[46:47] offset:0
global_load_dwordx4 v[84:87], v28, s[46:47] offset:1024
s_waitcnt vmcnt(18)
s_mov_b32 s50, 0
s_cmp_eq_u32 s40, 1
s_cbranch_scc0 L_c_late
v_readlane_b32 s44, v47, 0
v_readlane_b32 s45, v47, 1
v_readlane_b32 s52, v47, 2
s_mul_i32 s44, s44, 3
s_mul_i32 s45, s45, 3
s_mul_i32 s52, s52, 3
s_add_u32 s45, s45, 1
s_add_u32 s52, s52, 2
s_min_u32 s44, s44, s45
s_min_u32 s50, s44, s52
s_cmp_lt_u32 2, s50
s_cbranch_scc0 L_c_late
s_mov_b32 s40, 2
s_lshl_b32 s44, s32, 13
s_lshl_b32 s45, s29, 11
s_add_u32 s44, s44, s45
s_add_u32 s44, s44, 1048576
s_add_u32 s46, s26, s44
s_addc_u32 s47, s27, 0
global_load_dwordx4 v[88:91], v28, s[46:47] sc1
global_load_dwordx4 v[92:95], v28, s[46:47] offset:1024 sc1
L_c_late:
s_waitcnt vmcnt(14)
ds_write_b128 v25, v[96:99] offset:0
ds_write_b128 v25, v[100:103] offset:1152
ds_write_b128 v25, v[104:107] offset:2304
ds_write_b128 v25, v[108:111] offset:3456
s_waitcnt lgkmcnt(0)
ds_read_b64_tr_b16 v[30:31], v23 offset:0
ds_read_b64_tr_b16 v[32:33], v23 offset:576
ds_read_b64_tr_b16 v[34:35], v23 offset:32
ds_read_b64_tr_b16 v[36:37], v23 offset:608
ds_read_b64_tr_b16 v[38:39], v23 offset:128
ds_read_b64_tr_b16 v[40:41], v23 offset:704
ds_read_b64_tr_b16 v[42:43], v23 offset:160
ds_read_b64_tr_b16 v[44:45], v23 offset:736
s_waitcnt lgkmcnt(0)
ds_write_b128 v3, v[30:33] offset:16384
ds_write_b128 v3, v[34:37] offset:18432
ds_write_b128 v3, v[38:41] offset:20480
ds_write_b128 v3, v[42:45] offset:22528
s_waitcnt lgkmcnt(0)
s_waitcnt vmcnt(10)
ds_write_b128 v25, v[112:115] offset:0
ds_write_b128 v25, v[116:119] offset:1152
ds_write_b128 v25, v[120:123] offset:2304
ds_write_b128 v25, v[124:127] offset:3456
s_waitcnt lgkmcnt(0)
ds_read_b64_tr_b16 v[30:31], v23 offset:0
ds_read_b64_tr_b16 v[32:33], v23 offset:576
ds_read_b64_tr_b16 v[34:35], v23 offset:32
ds_read_b64_tr_b16 v[36:37], v23 offset:608
ds_read_b64_tr_b16 v[38:39], v23 offset:128
ds_read_b64_tr_b16 v[40:41], v23 offset:704
ds_read_b64_tr_b16 v[42:43], v23 offset:160
ds_read_b64_tr_b16 v[44:45], v23 offset:736
s_waitcnt lgkmcnt(0)
ds_write_b128 v3, v[30:33] offset:17408
ds_write_b128 v3, v[34:37] offset:19456
ds_write_b128 v3, v[38:41] offset:21504
ds_write_b128 v3, v[42:45] offset:23552
s_waitcnt lgkmcnt(0)
s_waitcnt vmcnt(6)
ds_write_b128 v25, v[48:51] offset:0
ds_write_b128 v25, v[52:55] offset:1152
ds_write_b128 v25, v[56:59] offset:2304
ds_write_b128 v25, v[60:63] offset:3456
s_waitcnt lgkmcnt(0)
ds_read_b64_tr_b16 v[30:31], v23 offset:0
ds_read_b64_tr_b16 v[32:33], v23 offset:576
ds_read_b64_tr_b16 v[34:35], v23 offset:32
ds_read_b64_tr_b16 v[36:37], v23 offset:608
ds_read_b64_tr_b16 v[38:39], v23 offset:128
ds_read_b64_tr_b16 v[40:41], v23 offset:704
ds_read_b64_tr_b16 v[42:43], v23 offset:160
ds_read_b64_tr_b16 v[44:45], v23 offset:736
s_waitcnt lgkmcnt(0)
ds_write_b128 v3, v[30:33] offset:24576
ds_write_b128 v3, v[34:37] offset:26624
ds_write_b128 v3, v[38:41] offset:28672
ds_write_b128 v3, v[42:45] offset:30720
s_waitcnt lgkmcnt(0)
s_waitcnt vmcnt(2)
ds_write_b128 v25, v[64:67] offset:0
ds_write_b128 v25, v[68:71] offset:1152
ds_write_b128 v25, v[72:75] offset:2304
ds_write_b128 v25, v[76:79] offset:3456
s_waitcnt lgkmcnt(0)
ds_read_b64_tr_b16 v[30:31], v23 offset:0
ds_read_b64_tr_b16 v[32:33], v23 offset:576
ds_read_b64_tr_b16 v[34:35], v23 offset:32
ds_read_b64_tr_b16 v[36:37], v23 offset:608
ds_read_b64_tr_b16 v[38:39], v23 offset:128
ds_read_b64_tr_b16 v[40:41], v23 offset:704
ds_read_b64_tr_b16 v[42:43], v23 offset:160
ds_read_b64_tr_b16 v[44:45], v23 offset:736
s_waitcnt lgkmcnt(0)
ds_write_b128 v3, v[30:33] offset:25600
ds_write_b128 v3, v[34:37] offset:27648
ds_write_b128 v3, v[38:41] offset:29696
ds_write_b128 v3, v[42:45] offset:31744
s_waitcnt lgkmcnt(0)
s_waitcnt vmcnt(0) lgkmcnt(0)
s_barrier
v_lshrrev_b32 v29, 2, v0
v_mul_u32_u24 v29, 512, v29
v_and_b32 v46, 3, v0
v_lshlrev_b32 v46, 7, v46
v_add_u32 v29, v29, v46
s_lshl_b32 s44, s29, 5
s_add_u32 s44, s44, 147456
v_add_u32 v29, s44, v29
ds_write_b128 v29, v[80:83] offset:0
ds_write_b128 v29, v[84:87] offset:16
s_cmp_eq_u32 s40, 2
s_cbranch_scc0 L_c_nok0
s_lshl_b32 s44, s29, 11
s_add_u32 s44, s44, 131072
v_add_u32 v29, s44, v28
ds_write_b128 v29, v[88:91] offset:0
ds_write_b128 v29, v[92:95] offset:1024
L_c_nok0:
s_cmp_eq_u32 s40, 0
s_cbranch_scc0 L_c_sbok
s_mov_b32 s43, 0
v_lshlrev_b32 v62, 2, v0
L_sb_poll_chain:
global_load_dword v63, v62, s[24:25] sc1
s_add_u32 s43, s43, 1
s_waitcnt vmcnt(0)
v_readlane_b32 s34, v63, 0
v_readlane_b32 s35, v63, 1
v_readlane_b32 s36, v63, 32
v_readlane_b32 s37, v63, 48
s_lshl_b32 s36, s36, 8
s_add_u32 s36, s36, s37
s_lshr_b32 s37, s35, 16
s_lshl_b32 s37, s37, 16
s_add_u32 s36, s36, s37
s_cmp_eq_u32 s36, 2121856
s_cbranch_scc1 L_sb_done_chain
s_cmp_lt_u32 s43, 400000
s_cbranch_scc1 L_sb_poll_chain
L_sb_done_chain:
s_mul_i32 s36, s28, 6
s_lshr_b64 s[34:35], s[34:35], s36
s_and_b32 s34, s34, 63
s_cmp_eq_u32 s34, 32
s_cselect_b32 s31, 0, 1
L_c_sbok:
v_lshlrev_b32 v0, 4, v0
s_mov_b32 s54, 0
s_mov_b32 s55, 0
s_mov_b32 s56, 0
s_mov_b32 s57, 8704
s_add_u32 s64, s26, 65536
s_addc_u32 s65, s27, 0
s_add_u32 s66, s64, 33280
s_addc_u32 s67, s65, 0
s_add_u32 s70, s26, 34603008
s_addc_u32 s71, s27, 0
s_add_u32 s72, s26, 38797312
s_addc_u32 s73, s27, 0
s_mul_i32 s44, s32, 8320
s_lshl_b32 s45, s29, 11
s_add_u32 s44, s44, s45
s_add_u32 s34, s64, s44
s_addc_u32 s35, s65, 0
s_add_u32 s74, s34, 524288
s_addc_u32 s75, s35, 0
s_lshl_b32 s44, s32, 13
s_add_u32 s44, s44, s45
s_add_u32 s44, s44, 1048576
s_add_u32 s96, s26, s44
s_addc_u32 s97, s27, 0
s_add_u32 s48, s96, 16777216
s_addc_u32 s49, s97, 0
s_add_u32 s36, s26, 917504
s_addc_u32 s37, s27, 0
s_mov_b32 s68, s36
s_mov_b32 s69, s37
s_mov_b32 s78, s36
s_mov_b32 s79, s37
s_mov_b32 s80, s36
s_mov_b32 s81, s37
s_mov_b32 s82, s36
s_mov_b32 s83, s37
s_mov_b32 s46, s36
s_mov_b32 s47, s37
s_sub_u32 s44, s29, 1
s_and_b32 s44, s44, 1
s_mul_i32 s59, s44, 4224
s_lshl_b32 s46, s32, 2
s_and_b32 s45, s32, 1
s_lshl_b32 s45, s45, 7
s_cmp_eq_u32 s29, 0
s_cselect_b32 s45, s46, s45
s_add_u32 s45, s45, 20480
s_add_u32 s84, s26, s45
s_addc_u32 s85, s27, 0
s_lshl_b32 s45, s32, 7
s_add_u32 s45, s45, 4096
s_add_u32 s86, s26, s45
s_addc_u32 s87, s27, 0
s_lshl_b32 s46, s32, 2
s_and_b32 s45, s32, 7
s_lshl_b32 s45, s45, 7
s_cmp_eq_u32 s29, 3
s_cselect_b32 s45, s46, s45
s_add_u32 s45, s45, 16384
s_add_u32 s40, s26, s45
s_addc_u32 s41, s27, 0
s_mov_b32 s88, 0x3e0293ee
s_mov_b32 s89, 0x3e0293ee
s_mov_b32 s58, 0
s_mov_b32 s53, 0
s_mov_b32 s38, 0
s_mov_b32 s39, 0
s_mov_b32 s101, 0
s_mov_b32 s58, 2
s_cmp_eq_u32 s40, 2
s_cbranch_scc1 L_c_k0ok
s_cmp_lt_u32 s58, s50
s_cbranch_scc0 L_kvpolli
L_kvrdyi:
s_lshl_b32 s44, s29, 11
s_add_u32 m0, s44, 131072
s_nop 0
global_load_lds_dwordx4 v0, s[96:97] offset:0 sc1
global_load_lds_dwordx4 v0, s[96:97] offset:1024 sc1
L_c_k0ok:
s_add_u32 s96, s96, 0x40000
s_addc_u32 s97, s97, 0
s_cmp_eq_u32 s29, 9
s_cbranch_scc0 L_c_nopf
s_lshl_b32 s44, s32, 13
s_add_u32 s44, s44, 1572864
s_add_u32 s78, s26, s44
s_addc_u32 s79, s27, 0
s_add_u32 s80, s78, 16777216
s_addc_u32 s81, s79, 0
v_lshlrev_b32 v17, 3, v0
L_c_nopf:
s_branch L_c_nomem0
s_and_b32 s44, s29, 3
s_cmp_eq_u32 s44, 0
s_cbranch_scc1 L_c_nomem0
s_cmp_eq_u32 s44, 3
s_cbranch_scc1 L_c_nomem0
s_sub_u32 s44, s29, 1
s_lshl_b32 s44, s44, 12
s_add_u32 s68, s6, s44
s_addc_u32 s69, s7, 0
s_add_u32 s44, s59, 147456
s_add_u32 m0, s44, 0
s_nop 0
global_load_lds_dwordx4 v0, s[68:69] offset:0
s_add_u32 m0, s44, 32
s_nop 0
global_load_lds_dwordx4 v0, s[68:69] offset:1024
s_add_u32 m0, s44, 64
s_nop 0
global_load_lds_dwordx4 v0, s[68:69] offset:2048
s_add_u32 m0, s44, 96
s_nop 0
global_load_lds_dwordx4 v0, s[68:69] offset:3072
L_c_nomem0:
s_lshl_b32 s44, s29, 11
s_add_u32 s59, s44, 131072
s_mov_b32 s42, 0x3f803f80
s_mov_b32 s43, 0x3f803f80
v_mov_b64 v[18:19], 0
v_mov_b64 v[20:21], 0
v_mov_b64 v[22:23], 0
v_mov_b64 v[24:25], 0
v_mov_b64 v[26:27], 0
v_mov_b64 v[28:29], 0
s_waitcnt vmcnt(0) lgkmcnt(0)
s_barrier
s_mul_i32 s44, s29, 2048
v_add_u32 v62, s44, v1
s_lshl_b32 s44, s29, 12
v_add_u32 v63, s44, v3
ds_read_b128 v[104:107], v62 offset:0
ds_read_b128 v[108:111], v62 offset:1024
ds_read_b128 v[112:115], v63 offset:0
ds_read_b128 v[116:119], v63 offset:1024
ds_read_b128 v[120:123], v63 offset:2048
ds_read_b128 v[124:127], v63 offset:3072
ds_read_b128 v[30:33], v7 offset:0
ds_read_b128 v[34:37], v7 offset:1024
ds_read_b128 v[38:41], v7 offset:2048
ds_read_b128 v[42:45], v7 offset:3072
ds_read_b128 v[46:49], v7 offset:4096
ds_read_b128 v[50:53], v7 offset:5120
ds_read_b128 v[54:57], v7 offset:6144
ds_read_b128 v[58:61], v7 offset:7168
s_waitcnt lgkmcnt(0)
s_lshl_b32 s44, s31, 2
s_add_u32 s44, s44, s29
s_cmp_eq_u32 s44, 0
s_cbranch_scc1 L_pre00
s_lshl_b32 s44, s31, 2
s_add_u32 s44, s44, s29
s_cmp_eq_u32 s44, 1
s_cbranch_scc1 L_pre01
s_lshl_b32 s44, s31, 2
s_add_u32 s44, s44, s29
s_cmp_eq_u32 s44, 2
s_cbranch_scc1 L_pre02
s_lshl_b32 s44, s31, 2
s_add_u32 s44, s44, s29
s_cmp_eq_u32 s44, 3
s_cbranch_scc1 L_pre03
s_lshl_b32 s44, s31, 2
s_add_u32 s44, s44, s29
s_cmp_eq_u32 s44, 4
s_cbranch_scc1 L_pre10
s_lshl_b32 s44, s31, 2
s_add_u32 s44, s44, s29
s_cmp_eq_u32 s44, 5
s_cbranch_scc1 L_pre11
s_lshl_b32 s44, s31, 2
s_add_u32 s44, s44, s29
s_cmp_eq_u32 s44, 6
s_cbranch_scc1 L_pre12
s_branch L_pre13
.p2align 6
s_nop 0
s_nop 0
s_nop 0
s_nop 0
s_nop 0
s_nop 0
s_nop 0
s_nop 0
s_nop 0
s_nop 0
s_nop 0
s_nop 0
L_gat00:
s_barrier
global_load_dwordx4 v[104:107], v17, s[68:69] offset:0 sc1
global_load_dwordx4 v[108:111], v17, s[68:69] offset:1024 sc1
ds_read_b128 v[30:33], v7 offset:0
ds_read_b128 v[34:37], v7 offset:1024
ds_read_b128 v[38:41], v7 offset:2048
ds_read_b128 v[42:45], v7 offset:3072
ds_read_b128 v[46:49], v7 offset:4096
ds_read_b128 v[50:53], v7 offset:5120
ds_read_b128 v[54:57], v7 offset:6144
ds_read_b128 v[58:61], v7 offset:7168
s_mov_b32 s45, 0
s_waitcnt vmcnt(1)
ds_write_b128 v1, v[104:107] offset:0
v_max_u32 v62, v104, v106
s_waitcnt vmcnt(0)
ds_write_b128 v1, v[108:111] offset:1024
v_max3_u32 v62, v62, v108, v110
v_cmp_eq_u32 vcc, -1, v62
s_cbranch_vccnz L_gret00
L_gok00:
s_mov_b64 exec, s[60:61]
global_store_dwordx2 v12, v[100:101], s[82:83]
s_mov_b64 exec, -1
L_pre00:
v_smfmac_f32_16x16x64_bf16 v[18:21], v[104:107], a[0:7], v2
v_smfmac_f32_16x16x64_bf16 v[22:25], v[104:107], a[8:15], v2
v_smfmac_f32_16x16x64_bf16 v[18:21], v[108:111], a[32:39], v2
s_waitcnt lgkmcnt(0)
L_step00:
s_barrier
ds_read_b128 v[96:99], v1 offset:2048
ds_read_b128 v[100:103], v1 offset:3072
v_smfmac_f32_16x16x64_bf16 v[26:29], v[104:107], v[112:119], v2
ds_read_b128 v[112:115], v3 offset:4096
global_load_lds_dwordx4 v0, s[48:49] sc1
v_smfmac_f32_16x16x64_bf16 v[26:29], v[108:111], v[120:127], v2
ds_read_b128 v[116:119], v3 offset:5120
v_smfmac_f32_16x16x64_bf16 v[22:25], v[108:111], a[40:47], v2
ds_read_b128 v[120:123], v3 offset:6144
global_load_lds_dwordx4 v0, s[48:49] offset:1024 sc1
s_waitcnt lgkmcnt(4)
v_smfmac_f32_16x16x64_bf16 v[18:21], v[96:99], a[64:71], v2
ds_read_b128 v[124:127], v3 offset:7168
s_xor_b32 m0, s59, 0x2000
v_smfmac_f32_16x16x64_bf16 v[22:25], v[96:99], a[72:79], v2
ds_read_b128 v[104:107], v1 offset:4096
global_load_lds_dwordx4 v0, s[96:97] sc1
s_waitcnt lgkmcnt(3)
v_smfmac_f32_16x16x64_bf16 v[26:29], v[96:99], v[112:119], v2
ds_read_b128 v[108:111], v1 offset:5120
v_smfmac_f32_16x16x64_bf16 v[18:21], v[100:103], a[96:103], v2
ds_read_b128 v[96:99], v1 offset:6144
global_load_lds_dwordx4 v0, s[96:97] offset:1024 sc1
v_smfmac_f32_16x16x64_bf16 v[22:25], v[100:103], a[104:111], v2
ds_read_b128 v[112:115], v3 offset:8192
s_waitcnt lgkmcnt(4)
v_smfmac_f32_16x16x64_bf16 v[26:29], v[100:103], v[120:127], v2
ds_read_b128 v[116:119], v3 offset:9216
s_waitcnt lgkmcnt(4)
v_smfmac_f32_16x16x64_bf16 v[18:21], v[104:107], a[128:135], v2
ds_read_b128 v[100:103], v1 offset:7168
v_smfmac_f32_16x16x64_bf16 v[22:25], v[104:107], a[136:143], v2
ds_read_b128 v[120:123], v3 offset:10240
v_mov_b32 v63, -1
s_waitcnt lgkmcnt(5)
v_smfmac_f32_16x16x64_bf16 v[18:21], v[108:111], a[160:167], v2
ds_read_b128 v[124:127], v3 offset:11264
v_smfmac_f32_16x16x64_bf16 v[22:25], v[108:111], a[168:175], v2
ds_read_b128 v[64:67], v13 offset:512
global_store_dword v0, v63, s[74:75]
s_waitcnt lgkmcnt(6)
v_smfmac_f32_16x16x64_bf16 v[18:21], v[96:99], a[192:199], v2
ds_read_b128 v[68:71], v13 offset:1536
v_smfmac_f32_16x16x64_bf16 v[22:25], v[96:99], a[200:207], v2
ds_read_b128 v[72:75], v13 offset:2560
global_store_dword v0, v63, s[74:75] offset:1024
s_waitcnt lgkmcnt(5)
v_smfmac_f32_16x16x64_bf16 v[18:21], v[100:103], a[224:231], v2
ds_read_b128 v[76:79], v13 offset:3584
v_smfmac_f32_16x16x64_bf16 v[22:25], v[100:103], a[232:239], v2
ds_read_b128 v[80:83], v13 offset:4608
s_waitcnt lgkmcnt(4)
v_smfmac_f32_16x16x64_bf16 v[18:21], v[64:67], a[16:23], v2
ds_read_b128 v[84:87], v13 offset:5632
v_smfmac_f32_16x16x64_bf16 v[22:25], v[64:67], a[24:31], v2
ds_read_b128 v[88:91], v13 offset:6656
s_waitcnt lgkmcnt(5)
v_smfmac_f32_16x16x64_bf16 v[18:21], v[68:71], a[48:55], v2
ds_read_b128 v[92:95], v13 offset:7680
v_smfmac_f32_16x16x64_bf16 v[22:25], v[68:71], a[56:63], v2
s_waitcnt lgkmcnt(5)
v_smfmac_f32_16x16x64_bf16 v[18:21], v[72:75], a[80:87], v2
v_smfmac_f32_16x16x64_bf16 v[22:25], v[72:75], a[88:95], v2
s_waitcnt lgkmcnt(4)
v_smfmac_f32_16x16x64_bf16 v[18:21], v[76:79], a[112:119], v2
v_smfmac_f32_16x16x64_bf16 v[22:25], v[76:79], a[120:127], v2
s_waitcnt lgkmcnt(3)
v_smfmac_f32_16x16x64_bf16 v[18:21], v[80:83], a[144:151], v2
v_smfmac_f32_16x16x64_bf16 v[22:25], v[80:83], a[152:159], v2
s_waitcnt lgkmcnt(2)
v_smfmac_f32_16x16x64_bf16 v[18:21], v[84:87], a[176:183], v2
v_smfmac_f32_16x16x64_bf16 v[22:25], v[84:87], a[184:191], v2
s_waitcnt lgkmcnt(1)
v_smfmac_f32_16x16x64_bf16 v[18:21], v[88:91], a[208:215], v2
v_smfmac_f32_16x16x64_bf16 v[22:25], v[88:91], a[216:223], v2
s_waitcnt lgkmcnt(0)
v_smfmac_f32_16x16x64_bf16 v[18:21], v[92:95], a[240:247], v2
v_smfmac_f32_16x16x64_bf16 v[22:25], v[92:95], a[248:255], v2
v_smfmac_f32_16x16x64_bf16 v[26:29], v[80:83], v[160:167], v2
v_cvt_pk_bf16_f32 v18, v18, v19
v_cvt_pk_bf16_f32 v19, v20, v21
ds_write_b64 v4, v[18:19]
s_nop 0
v_cvt_pk_bf16_f32 v20, v22, v23
v_cvt_pk_bf16_f32 v21, v24, v25
ds_write_b64 v4, v[20:21] offset:32
v_smfmac_f32_16x16x64_bf16 v[26:29], v[84:87], v[168:175], v2
ds_read_b128 v[80:83], v3 offset:12288
v_smfmac_f32_16x16x64_bf16 v[26:29], v[88:91], v[176:183], v2
ds_read_b128 v[84:87], v3 offset:13312
v_smfmac_f32_16x16x64_bf16 v[26:29], v[92:95], v[184:191], v2
ds_read_b128 v[88:91], v3 offset:14336
v_smfmac_f32_16x16x64_bf16 v[26:29], v[64:67], v[128:135], v2
ds_read_b128 v[92:95], v3 offset:15360
v_smfmac_f32_16x16x64_bf16 v[26:29], v[68:71], v[136:143], v2
v_mov_b32 v22, v16
v_mov_b32 v23, v16
v_smfmac_f32_16x16x64_bf16 v[26:29], v[72:75], v[144:151], v2
v_mov_b32 v24, v16
v_mov_b32 v25, v16
v_smfmac_f32_16x16x64_bf16 v[26:29], v[76:79], v[152:159], v2
s_waitcnt lgkmcnt(4)
s_barrier
ds_read_b64_tr_b16 v[64:65], v5 offset:0
ds_read_b64_tr_b16 v[66:67], v5 offset:32
ds_read_b64_tr_b16 v[68:69], v5 offset:1536
ds_read_b64_tr_b16 v[70:71], v5 offset:1568
v_smfmac_f32_16x16x64_bf16 v[26:29], v[104:107], v[112:119], v2
ds_read_b64_tr_b16 v[72:73], v5 offset:3072
v_smfmac_f32_16x16x64_bf16 v[26:29], v[108:111], v[120:127], v2
ds_read_b64_tr_b16 v[74:75], v5 offset:3104
s_waitcnt lgkmcnt(8)
v_smfmac_f32_16x16x64_bf16 v[26:29], v[96:99], v[80:87], v2
ds_read_b64_tr_b16 v[76:77], v5 offset:4608
s_waitcnt lgkmcnt(7)
v_smfmac_f32_16x16x64_bf16 v[26:29], v[100:103], v[88:95], v2
ds_read_b64_tr_b16 v[78:79], v5 offset:4640
s_waitcnt lgkmcnt(6)
v_mfma_f32_16x16x32_bf16 v[22:25], v[64:67], v[64:67], v[22:25]
s_waitcnt lgkmcnt(4)
v_mfma_f32_16x16x32_bf16 v[22:25], v[68:71], v[68:71], v[22:25]
s_waitcnt lgkmcnt(2)
v_mfma_f32_16x16x32_bf16 v[22:25], v[72:75], v[72:75], v[22:25]
ds_read_b128 v[104:107], v3 offset:18432
s_waitcnt lgkmcnt(1)
v_mfma_f32_16x16x32_bf16 v[22:25], v[76:79], v[76:79], v[22:25]
ds_read_b128 v[108:111], v3 offset:19456
ds_read_b64_tr_b16 v[18:19], v6
v_mfma_f32_16x16x32_bf16 v[112:115], v[30:33], v[64:67], 0
v_cvt_pk_bf16_f32 v124, v26, v27
v_cvt_pk_bf16_f32 v125, v28, v29
v_mfma_f32_16x16x32_bf16 v[112:115], v[38:41], v[68:71], v[112:115]
v_cvt_pk_bf16_f32 v126, v26, v27
v_cvt_pk_bf16_f32 v127, v28, v29
v_mfma_f32_16x16x32_bf16 v[112:115], v[46:49], v[72:75], v[112:115]
ds_read_b128 v[88:91], v3 offset:26624
global_store_dwordx2 v15, v[124:125], s[72:73] sc1
v_mfma_f32_16x16x32_bf16 v[112:115], v[54:57], v[76:79], v[112:115]
ds_read_b128 v[92:95], v3 offset:27648
v_max3_f32 v62, v22, v23, v24
v_mfma_f32_16x16x32_bf16 v[116:119], v[34:37], v[64:67], 0
v_permlane32_swap_b32 v124, v126
v_permlane32_swap_b32 v125, v127
v_mfma_f32_16x16x32_bf16 v[116:119], v[42:45], v[68:71], v[116:119]
s_waitcnt lgkmcnt(2)
global_store_dwordx2 v14, v[18:19], s[70:71] sc1
v_mfma_f32_16x16x32_bf16 v[116:119], v[50:53], v[72:75], v[116:119]
v_max3_f32 v62, v62, v25, v112
v_max3_f32 v63, v113, v114, v115
v_mfma_f32_16x16x32_bf16 v[116:119], v[58:61], v[76:79], v[116:119]
v_max_f32 v62, v62, v63
s_cmp_eq_u32 s54, 63
s_cbranch_scc1 L_chain_end
v_mov_b64 v[26:27], s[42:43]
v_mov_b64 v[30:31], 0
v_mov_b64 v[32:33], 0
s_nop 1
v_max3_f32 v63, v116, v117, v118
v_max3_f32 v62, v62, v63, v119
v_mov_b32 v63, v62
v_mov_b64 v[34:35], 0
v_mov_b64 v[36:37], 0
v_permlane32_swap_b32 v62, v63
v_max_f32 v62, v62, v63
v_mov_b32 v63, v62
v_mov_b64 v[38:39], 0
v_mov_b64 v[28:29], s[42:43]
v_permlane16_swap_b32 v62, v63
v_max_f32 v62, v62, v63
v_mul_f32 v62, s88, v62
v_pk_fma_f32 v[112:113], v[112:113], s[88:89], v[62:63] op_sel_hi:[1,1,0] neg_lo:[0,0,1] neg_hi:[0,0,1]
v_pk_fma_f32 v[114:115], v[114:115], s[88:89], v[62:63] op_sel_hi:[1,1,0] neg_lo:[0,0,1] neg_hi:[0,0,1]
v_pk_fma_f32 v[116:117], v[116:117], s[88:89], v[62:63] op_sel_hi:[1,1,0] neg_lo:[0,0,1] neg_hi:[0,0,1]
v_pk_fma_f32 v[118:119], v[118:119], s[88:89], v[62:63] op_sel_hi:[1,1,0] neg_lo:[0,0,1] neg_hi:[0,0,1]
v_pk_fma_f32 v[22:23], v[22:23], s[88:89], v[62:63] op_sel_hi:[1,1,0] neg_lo:[0,0,1] neg_hi:[0,0,1]
v_pk_fma_f32 v[24:25], v[24:25], s[88:89], v[62:63] op_sel_hi:[1,1,0] neg_lo:[0,0,1] neg_hi:[0,0,1]
v_exp_f32 v112, v112
v_exp_f32 v113, v113
v_exp_f32 v114, v114
v_exp_f32 v115, v115
s_waitcnt vmcnt(6)
ds_read_b128 v[72:75], v8 offset:0
ds_read_b128 v[76:79], v8 offset:1024
v_exp_f32 v116, v116
v_exp_f32 v117, v117
v_cvt_pk_bf16_f32 v64, v112, v113
v_cvt_pk_bf16_f32 v65, v114, v115
v_exp_f32 v118, v118
v_exp_f32 v119, v119
v_cvt_pk_bf16_f32 v66, v116, v117
v_cvt_pk_bf16_f32 v67, v118, v119
s_waitcnt lgkmcnt(0)
v_exp_f32 v22, v22
v_mfma_f32_16x16x32_bf16 v[112:115], v[26:29], v[64:67], 0
v_exp_f32 v23, v23
v_mfma_f32_16x16x32_bf16 v[116:119], v[72:75], v[64:67], 0
v_exp_f32 v24, v24
v_mfma_f32_16x16x32_bf16 v[120:123], v[76:79], v[64:67], 0
v_exp_f32 v25, v25
v_cvt_pk_bf16_f32 v68, v22, v23
v_cvt_pk_bf16_f32 v69, v24, v25
s_nop 1
v_mfma_f32_16x16x16_bf16 v[112:115], v[26:27], v[68:69], v[112:115]
v_mfma_f32_16x16x16_bf16 v[116:119], v[124:125], v[68:69], v[116:119]
v_mfma_f32_16x16x16_bf16 v[120:123], v[126:127], v[68:69], v[120:123]
v_rcp_f32 v112, v112
v_mov_b64 v[40:41], 0
v_mov_b64 v[42:43], 0
v_mov_b64 v[44:45], 0
v_pk_mul_f32 v[116:117], v[116:117], v[112:113] op_sel_hi:[1,0]
v_pk_mul_f32 v[118:119], v[118:119], v[112:113] op_sel_hi:[1,0]
v_cvt_pk_bf16_f32 v124, v116, v117
v_cvt_pk_bf16_f32 v125, v118, v119
v_pk_mul_f32 v[120:121], v[120:121], v[112:113] op_sel_hi:[1,0]
v_pk_mul_f32 v[122:123], v[122:123], v[112:113] op_sel_hi:[1,0]
v_cvt_pk_bf16_f32 v126, v120, v121
v_cvt_pk_bf16_f32 v127, v122, v123
ds_write_b128 v9, v[124:127]
v_lshrrev_b32 v23, 2, v0
v_min_u32 v23, 124, v23
v_mov_b32_dpp v124, v124 row_shr:8 row_mask:0xf bank_mask:0xc
v_mov_b32_dpp v125, v125 row_shr:8 row_mask:0xf bank_mask:0xc
v_mov_b32_dpp v126, v126 row_shr:8 row_mask:0xf bank_mask:0xc
v_mov_b32_dpp v127, v127 row_shr:8 row_mask:0xf bank_mask:0xc
s_waitcnt vmcnt(2)
s_waitcnt lgkmcnt(0)
s_barrier
ds_read_b128 v[112:115], v10 offset:16
ds_read_b128 v[116:119], v10 offset:32
ds_read_b128 v[120:123], v10 offset:48
v_smfmac_f32_16x16x64_bf16 v[30:33], v[124:127], v[192:199], v2
ds_read_b128 v[96:99], v3 offset:16384
ds_read_b128 v[100:103], v3 offset:17408
v_smfmac_f32_16x16x64_bf16 v[34:37], v[124:127], v[200:207], v2
ds_read_b128 v[80:83], v3 offset:24576
ds_read_b128 v[84:87], v3 offset:25600
v_smfmac_f32_16x16x64_bf16 v[38:41], v[124:127], v[208:215], v2
ds_read_b128 v[46:49], v3 offset:20480
v_smfmac_f32_16x16x64_bf16 v[42:45], v[124:127], v[216:223], v2
ds_read_b128 v[50:53], v3 offset:21504
s_waitcnt lgkmcnt(8)
v_smfmac_f32_16x16x64_bf16 v[30:33], v[112:115], v[224:231], v2
global_load_dword v18, v23, s[40:41] sc1
ds_read_b128 v[64:67], v3 offset:28672
s_waitcnt lgkmcnt(8)
s_waitcnt lgkmcnt(5)
v_smfmac_f32_16x16x64_bf16 v[30:33], v[116:119], v[96:103], v2
ds_read_b128 v[68:71], v3 offset:29696
s_waitcnt lgkmcnt(4)
v_smfmac_f32_16x16x64_bf16 v[30:33], v[120:123], v[80:87], v2
ds_read_b128 v[54:57], v3 offset:22528
v_smfmac_f32_16x16x64_bf16 v[34:37], v[112:115], v[232:239], v2
global_load_dword v19, v23, s[40:41] sc1
ds_read_b128 v[58:61], v3 offset:23552
v_smfmac_f32_16x16x64_bf16 v[34:37], v[116:119], v[104:111], v2
ds_read_b128 v[72:75], v3 offset:30720
v_cvt_pk_bf16_f32 v96, v30, v31
v_cvt_pk_bf16_f32 v97, v32, v33
v_smfmac_f32_16x16x64_bf16 v[34:37], v[120:123], v[88:95], v2
ds_read_b128 v[76:79], v3 offset:31744
v_smfmac_f32_16x16x64_bf16 v[38:41], v[112:115], v[240:247], v2
global_load_dword v20, v23, s[40:41] sc1
s_waitcnt lgkmcnt(6)
v_smfmac_f32_16x16x64_bf16 v[38:41], v[116:119], v[46:53], v2
v_cvt_pk_bf16_f32 v98, v34, v35
v_cvt_pk_bf16_f32 v99, v36, v37
global_store_dwordx4 v11, v[96:99], s[64:65]
s_waitcnt lgkmcnt(4)
v_smfmac_f32_16x16x64_bf16 v[38:41], v[120:123], v[64:71], v2
v_smfmac_f32_16x16x64_bf16 v[42:45], v[112:115], v[248:255], v2
global_load_dword v21, v23, s[40:41] sc1
s_waitcnt lgkmcnt(2)
v_smfmac_f32_16x16x64_bf16 v[42:45], v[116:119], v[54:61], v2
v_cvt_pk_bf16_f32 v100, v38, v39
v_cvt_pk_bf16_f32 v101, v40, v41
s_waitcnt lgkmcnt(0)
v_smfmac_f32_16x16x64_bf16 v[42:45], v[120:123], v[72:79], v2
v_add_u32 v14, 0x10000, v14
v_add_u32 v15, 0x10000, v15
v_xor_b32 v7, 0x2000, v7
v_xor_b32 v8, 0x2000, v8
s_nop 3
v_cvt_pk_bf16_f32 v102, v42, v43
v_cvt_pk_bf16_f32 v103, v44, v45
global_store_dwordx4 v11, v[100:103], s[66:67]
v_and_b32 v63, 0xf0, v0
v_add_u32 v63, 162048, v63
ds_read_b128 v[100:103], v63
s_add_u32 s74, s34, s55
s_addc_u32 s75, s35, 0
s_add_u32 s78, s74, 4096
s_addc_u32 s79, s75, 0
s_add_u32 s44, s54, 1
global_load_dword v22, v23, s[40:41] sc1
s_nop 7
s_nop 7
s_nop 7
s_waitcnt vmcnt(6)
v_cmp_gt_u32 vcc, s44, v18
s_cbranch_vccz L_ogo00
global_load_dword v18, v23, s[40:41] sc1
s_nop 7
s_waitcnt vmcnt(6)
v_cmp_gt_u32 vcc, s44, v19
s_cbranch_vccz L_ogo00
global_load_dword v19, v23, s[40:41] sc1
s_nop 7
s_waitcnt vmcnt(6)
v_cmp_gt_u32 vcc, s44, v20
s_cbranch_vccz L_ogo00
global_load_dword v20, v23, s[40:41] sc1
s_nop 7
s_waitcnt vmcnt(5)
v_cmp_gt_u32 vcc, s44, v21
s_cbranch_vccz L_ogo00
global_load_dword v21, v23, s[40:41] sc1
s_nop 7
s_waitcnt vmcnt(4)
v_cmp_gt_u32 vcc, s44, v22
s_cbranch_vccz L_ogo00
global_load_dword v22, v23, s[40:41] sc1
s_nop 7
s_mov_b32 s45, 0
L_opoll00:
s_waitcnt vmcnt(4)
v_cmp_gt_u32 vcc, s44, v18
s_cbranch_vccz L_or00
global_load_dword v18, v23, s[40:41] sc1
s_nop 7
s_waitcnt vmcnt(4)
v_cmp_gt_u32 vcc, s44, v19
s_cbranch_vccz L_or00
global_load_dword v19, v23, s[40:41] sc1
s_nop 7
s_waitcnt vmcnt(4)
v_cmp_gt_u32 vcc, s44, v20
s_cbranch_vccz L_or00
global_load_dword v20, v23, s[40:41] sc1
s_nop 7
s_waitcnt vmcnt(4)
v_cmp_gt_u32 vcc, s44, v21
s_cbranch_vccz L_or00
global_load_dword v21, v23, s[40:41] sc1
s_nop 7
s_waitcnt vmcnt(4)
v_cmp_gt_u32 vcc, s44, v22
s_cbranch_vccz L_or00
global_load_dword v22, v23, s[40:41] sc1
s_nop 7
s_add_u32 s45, s45, 1
s_cmp_lt_u32 s45, 20000
s_cbranch_scc1 L_opoll00
L_or00:
s_branch L_ogo00
.p2align 6
s_nop 0
s_nop 0
s_nop 0
s_nop 0
L_ogo00:
global_load_dwordx4 v[64:67], v0, s[74:75] offset:0 sc1
global_load_dwordx4 v[68:71], v0, s[74:75] offset:1024 sc1
global_load_dwordx4 v[72:75], v0, s[74:75] offset:2048 sc1
global_load_dwordx4 v[76:79], v0, s[74:75] offset:3072 sc1
global_load_dwordx4 v[80:83], v0, s[78:79] offset:0 sc1
global_load_dwordx4 v[84:87], v0, s[78:79] offset:1024 sc1
global_load_dwordx4 v[88:91], v0, s[78:79] offset:2048 sc1
global_load_dwordx4 v[92:95], v0, s[78:79] offset:3072 sc1
s_add_u32 s80, s36, s57
s_addc_u32 s81, s37, 0
s_add_u32 s82, s36, s56
s_addc_u32 s83, s37, 0
s_add_u32 s68, s36, s57
s_addc_u32 s69, s37, 0
s_add_u32 s68, s68, 0
s_addc_u32 s69, s69, 0
ds_read_b128 v[112:115], v3 offset:0
ds_read_b128 v[116:119], v3 offset:1024
ds_read_b128 v[120:123], v3 offset:2048
ds_read_b128 v[124:127], v3 offset:3072
v_xor_b32 v11, 524288, v11
s_xor_b32 s55, s55, 524288
s_xor_b32 s59, s59, 0x2000
s_mov_b32 s56, s57
s_add_u32 s57, s57, 8704
s_cmp_eq_u32 s57, 26112
s_cselect_b32 s57, 0, s57
s_add_u32 s54, s54, 1
s_add_u32 s96, s96, 0x40000
s_addc_u32 s97, s97, 0
s_add_u32 s48, s48, 0x40000
s_addc_u32 s49, s49, 0
s_waitcnt lgkmcnt(0)
s_waitcnt vmcnt(7)
v_mfma_f32_16x16x32_bf16 v[96:99], v[64:67], v[100:103], 0
s_waitcnt vmcnt(6)
v_mfma_f32_16x16x32_bf16 v[96:99], v[68:71], v[100:103], v[96:99]
v_max_u32 v62, v64, v68
s_waitcnt vmcnt(5)
v_mfma_f32_16x16x32_bf16 v[96:99], v[72:75], v[100:103], v[96:99]
s_waitcnt vmcnt(4)
v_mfma_f32_16x16x32_bf16 v[96:99], v[76:79], v[100:103], v[96:99]
v_max3_u32 v62, v62, v72, v76
s_waitcnt vmcnt(3)
v_mfma_f32_16x16x32_bf16 v[96:99], v[80:83], v[100:103], v[96:99]
s_waitcnt vmcnt(2)
v_mfma_f32_16x16x32_bf16 v[96:99], v[84:87], v[100:103], v[96:99]
v_max3_u32 v62, v62, v80, v84
s_waitcnt vmcnt(1)
v_mfma_f32_16x16x32_bf16 v[96:99], v[88:91], v[100:103], v[96:99]
s_waitcnt vmcnt(0)
v_mfma_f32_16x16x32_bf16 v[96:99], v[92:95], v[100:103], v[96:99]
v_max3_u32 v62, v62, v88, v92
v_cmp_eq_u32 vcc, -1, v62
s_cbranch_vccnz L_rret00
L_rok00:
s_nop 4
v_cvt_pk_bf16_f32 v96, v96, v97
v_cvt_pk_bf16_f32 v97, v98, v99
s_mov_b64 exec, s[60:61]
global_store_dwordx2 v12, v[96:97], s[80:81]
s_mov_b64 exec, -1
v_mov_b64 v[18:19], 0
v_mov_b64 v[20:21], 0
v_mov_b64 v[22:23], 0
v_mov_b64 v[24:25], 0
v_mov_b64 v[26:27], 0
v_mov_b64 v[28:29], 0
v_mov_b64 v[100:101], -1
v_mov_b64 v[102:103], -1
s_nop 7
s_nop 7
s_nop 7
s_nop 7
s_nop 3
s_branch L_gat00
L_gret00:
global_load_dwordx4 v[104:107], v17, s[68:69] offset:0 sc1
global_load_dwordx4 v[108:111], v17, s[68:69] offset:1024 sc1
s_add_u32 s45, s45, 1
s_add_u32 s38, s38, 1
s_waitcnt vmcnt(1)
ds_write_b128 v1, v[104:107] offset:0
v_max_u32 v62, v104, v106
s_waitcnt vmcnt(0)
ds_write_b128 v1, v[108:111] offset:1024
v_max3_u32 v62, v62, v108, v110
v_cmp_eq_u32 vcc, -1, v62
s_cbranch_vccz L_gok00
s_cmp_lt_u32 s45, 20000
s_cbranch_scc1 L_gret00
s_branch L_gok00
L_rret00:
s_mov_b32 s45, 0
L_rret200:
global_load_dwordx4 v[64:67], v0, s[74:75] offset:0 sc1
global_load_dwordx4 v[68:71], v0, s[74:75] offset:1024 sc1
global_load_dwordx4 v[72:75], v0, s[74:75] offset:2048 sc1
global_load_dwordx4 v[76:79], v0, s[74:75] offset:3072 sc1
global_load_dwordx4 v[80:83], v0, s[78:79] offset:0 sc1
global_load_dwordx4 v[84:87], v0, s[78:79] offset:1024 sc1
global_load_dwordx4 v[88:91], v0, s[78:79] offset:2048 sc1
global_load_dwordx4 v[92:95], v0, s[78:79] offset:3072 sc1
s_add_u32 s45, s45, 1
s_add_u32 s39, s39, 1
s_waitcnt vmcnt(7)
v_mfma_f32_16x16x32_bf16 v[96:99], v[64:67], v[100:103], 0
s_waitcnt vmcnt(6)
v_mfma_f32_16x16x32_bf16 v[96:99], v[68:71], v[100:103], v[96:99]
v_max_u32 v62, v64, v68
s_waitcnt vmcnt(5)
v_mfma_f32_16x16x32_bf16 v[96:99], v[72:75], v[100:103], v[96:99]
s_waitcnt vmcnt(4)
v_mfma_f32_16x16x32_bf16 v[96:99], v[76:79], v[100:103], v[96:99]
v_max3_u32 v62, v62, v72, v76
s_waitcnt vmcnt(3)
v_mfma_f32_16x16x32_bf16 v[96:99], v[80:83], v[100:103], v[96:99]
s_waitcnt vmcnt(2)
v_mfma_f32_16x16x32_bf16 v[96:99], v[84:87], v[100:103], v[96:99]
v_max3_u32 v62, v62, v80, v84
s_waitcnt vmcnt(1)
v_mfma_f32_16x16x32_bf16 v[96:99], v[88:91], v[100:103], v[96:99]
s_waitcnt vmcnt(0)
v_mfma_f32_16x16x32_bf16 v[96:99], v[92:95], v[100:103], v[96:99]
v_max3_u32 v62, v62, v88, v92
v_cmp_eq_u32 vcc, -1, v62
s_cbranch_vccz L_rok00
s_cmp_lt_u32 s45, 20000
s_cbranch_scc1 L_rret200
s_branch L_rok00
.p2align 6
s_nop 0
s_nop 0
s_nop 0
s_nop 0
s_nop 0
s_nop 0
s_nop 0
s_nop 0
s_nop 0
s_nop 0
s_nop 0
s_nop 0
L_gat01:
s_barrier
global_load_dwordx4 v[104:107], v17, s[68:69] offset:0 sc1
global_load_dwordx4 v[108:111], v17, s[68:69] offset:1024 sc1
ds_read_b128 v[30:33], v7 offset:0
ds_read_b128 v[34:37], v7 offset:1024
ds_read_b128 v[38:41], v7 offset:2048
ds_read_b128 v[42:45], v7 offset:3072
ds_read_b128 v[46:49], v7 offset:4096
ds_read_b128 v[50:53], v7 offset:5120
ds_read_b128 v[54:57], v7 offset:6144
ds_read_b128 v[58:61], v7 offset:7168
s_mov_b32 s45, 0
s_waitcnt vmcnt(1)
ds_write_b128 v1, v[104:107] offset:2048
v_max_u32 v62, v104, v106
s_waitcnt vmcnt(0)
ds_write_b128 v1, v[108:111] offset:3072
v_max3_u32 v62, v62, v108, v110
v_cmp_eq_u32 vcc, -1, v62
s_cbranch_vccnz L_gret01
L_gok01:
L_pre01:
v_smfmac_f32_16x16x64_bf16 v[18:21], v[104:107], a[64:71], v2
v_smfmac_f32_16x16x64_bf16 v[22:25], v[104:107], a[72:79], v2
v_smfmac_f32_16x16x64_bf16 v[18:21], v[108:111], a[96:103], v2
s_waitcnt lgkmcnt(0)
L_step01:
s_barrier
ds_read_b128 v[96:99], v1 offset:4096
ds_read_b128 v[100:103], v1 offset:5120
v_smfmac_f32_16x16x64_bf16 v[26:29], v[104:107], v[112:119], v2
ds_read_b128 v[112:115], v3 offset:8192
global_load_lds_dwordx4 v0, s[48:49] sc1
v_smfmac_f32_16x16x64_bf16 v[26:29], v[108:111], v[120:127], v2
ds_read_b128 v[116:119], v3 offset:9216
v_smfmac_f32_16x16x64_bf16 v[22:25], v[108:111], a[104:111], v2
ds_read_b128 v[120:123], v3 offset:10240
global_load_lds_dwordx4 v0, s[48:49] offset:1024 sc1
s_waitcnt lgkmcnt(4)
v_smfmac_f32_16x16x64_bf16 v[18:21], v[96:99], a[128:135], v2
ds_read_b128 v[124:127], v3 offset:11264
s_xor_b32 m0, s59, 0x2000
v_smfmac_f32_16x16x64_bf16 v[22:25], v[96:99], a[136:143], v2
ds_read_b128 v[104:107], v1 offset:6144
global_load_lds_dwordx4 v0, s[96:97] sc1
s_waitcnt lgkmcnt(3)
v_smfmac_f32_16x16x64_bf16 v[26:29], v[96:99], v[112:119], v2
ds_read_b128 v[108:111], v1 offset:7168
v_smfmac_f32_16x16x64_bf16 v[18:21], v[100:103], a[160:167], v2
ds_read_b128 v[96:99], v1 offset:0
global_load_lds_dwordx4 v0, s[96:97] offset:1024 sc1
v_smfmac_f32_16x16x64_bf16 v[22:25], v[100:103], a[168:175], v2
ds_read_b128 v[112:115], v3 offset:12288
s_waitcnt lgkmcnt(4)
v_smfmac_f32_16x16x64_bf16 v[26:29], v[100:103], v[120:127], v2
ds_read_b128 v[116:119], v3 offset:13312
s_waitcnt lgkmcnt(4)
v_smfmac_f32_16x16x64_bf16 v[18:21], v[104:107], a[192:199], v2
ds_read_b128 v[100:103], v1 offset:1024
v_smfmac_f32_16x16x64_bf16 v[22:25], v[104:107], a[200:207], v2
ds_read_b128 v[120:123], v3 offset:14336
v_mov_b32 v63, -1
s_waitcnt lgkmcnt(5)
v_smfmac_f32_16x16x64_bf16 v[18:21], v[108:111], a[224:231], v2
ds_read_b128 v[124:127], v3 offset:15360
v_smfmac_f32_16x16x64_bf16 v[22:25], v[108:111], a[232:239], v2
ds_read_b128 v[64:67], v13 offset:512
global_store_dword v0, v63, s[74:75]
s_waitcnt lgkmcnt(6)
v_smfmac_f32_16x16x64_bf16 v[18:21], v[96:99], a[0:7], v2
ds_read_b128 v[68:71], v13 offset:1536
v_smfmac_f32_16x16x64_bf16 v[22:25], v[96:99], a[8:15], v2
ds_read_b128 v[72:75], v13 offset:2560
global_store_dword v0, v63, s[74:75] offset:1024
s_waitcnt lgkmcnt(5)
v_smfmac_f32_16x16x64_bf16 v[18:21], v[100:103], a[32:39], v2
ds_read_b128 v[76:79], v13 offset:3584
v_smfmac_f32_16x16x64_bf16 v[22:25], v[100:103], a[40:47], v2
ds_read_b128 v[80:83], v13 offset:4608
s_waitcnt lgkmcnt(4)
v_smfmac_f32_16x16x64_bf16 v[18:21], v[64:67], a[16:23], v2
ds_read_b128 v[84:87], v13 offset:5632
v_smfmac_f32_16x16x64_bf16 v[22:25], v[64:67], a[24:31], v2
ds_read_b128 v[88:91], v13 offset:6656
s_waitcnt lgkmcnt(5)
v_smfmac_f32_16x16x64_bf16 v[18:21], v[68:71], a[48:55], v2
ds_read_b128 v[92:95], v13 offset:7680
v_smfmac_f32_16x16x64_bf16 v[22:25], v[68:71], a[56:63], v2
s_waitcnt lgkmcnt(5)
v_smfmac_f32_16x16x64_bf16 v[18:21], v[72:75], a[80:87], v2
v_smfmac_f32_16x16x64_bf16 v[22:25], v[72:75], a[88:95], v2
s_waitcnt lgkmcnt(4)
v_smfmac_f32_16x16x64_bf16 v[18:21], v[76:79], a[112:119], v2
v_smfmac_f32_16x16x64_bf16 v[22:25], v[76:79], a[120:127], v2
s_waitcnt lgkmcnt(3)
v_smfmac_f32_16x16x64_bf16 v[18:21], v[80:83], a[144:151], v2
v_smfmac_f32_16x16x64_bf16 v[22:25], v[80:83], a[152:159], v2
s_waitcnt lgkmcnt(2)
v_smfmac_f32_16x16x64_bf16 v[18:21], v[84:87], a[176:183], v2
v_smfmac_f32_16x16x64_bf16 v[22:25], v[84:87], a[184:191], v2
s_waitcnt lgkmcnt(1)
v_smfmac_f32_16x16x64_bf16 v[18:21], v[88:91], a[208:215], v2
v_smfmac_f32_16x16x64_bf16 v[22:25], v[88:91], a[216:223], v2
s_waitcnt lgkmcnt(0)
v_smfmac_f32_16x16x64_bf16 v[18:21], v[92:95], a[240:247], v2
v_smfmac_f32_16x16x64_bf16 v[22:25], v[92:95], a[248:255], v2
v_smfmac_f32_16x16x64_bf16 v[26:29], v[80:83], v[160:167], v2
v_cvt_pk_bf16_f32 v18, v18, v19
v_cvt_pk_bf16_f32 v19, v20, v21
ds_write_b64 v4, v[18:19]
s_nop 0
v_cvt_pk_bf16_f32 v20, v22, v23
v_cvt_pk_bf16_f32 v21, v24, v25
ds_write_b64 v4, v[20:21] offset:32
v_smfmac_f32_16x16x64_bf16 v[26:29], v[84:87], v[168:175], v2
ds_read_b128 v[80:83], v3 offset:0
v_smfmac_f32_16x16x64_bf16 v[26:29], v[88:91], v[176:183], v2
ds_read_b128 v[84:87], v3 offset:1024
v_smfmac_f32_16x16x64_bf16 v[26:29], v[92:95], v[184:191], v2
ds_read_b128 v[88:91], v3 offset:2048
v_smfmac_f32_16x16x64_bf16 v[26:29], v[64:67], v[128:135], v2
ds_read_b128 v[92:95], v3 offset:3072
v_smfmac_f32_16x16x64_bf16 v[26:29], v[68:71], v[136:143], v2
v_mov_b32 v22, v16
v_mov_b32 v23, v16
v_smfmac_f32_16x16x64_bf16 v[26:29], v[72:75], v[144:151], v2
v_mov_b32 v24, v16
v_mov_b32 v25, v16
v_smfmac_f32_16x16x64_bf16 v[26:29], v[76:79], v[152:159], v2
s_waitcnt lgkmcnt(4)
s_barrier
ds_read_b64_tr_b16 v[64:65], v5 offset:0
ds_read_b64_tr_b16 v[66:67], v5 offset:32
ds_read_b64_tr_b16 v[68:69], v5 offset:1536
ds_read_b64_tr_b16 v[70:71], v5 offset:1568
v_smfmac_f32_16x16x64_bf16 v[26:29], v[104:107], v[112:119], v2
ds_read_b64_tr_b16 v[72:73], v5 offset:3072
v_smfmac_f32_16x16x64_bf16 v[26:29], v[108:111], v[120:127], v2
ds_read_b64_tr_b16 v[74:75], v5 offset:3104
s_waitcnt lgkmcnt(8)
v_smfmac_f32_16x16x64_bf16 v[26:29], v[96:99], v[80:87], v2
ds_read_b64_tr_b16 v[76:77], v5 offset:4608
s_waitcnt lgkmcnt(7)
v_smfmac_f32_16x16x64_bf16 v[26:29], v[100:103], v[88:95], v2
ds_read_b64_tr_b16 v[78:79], v5 offset:4640
s_waitcnt lgkmcnt(6)
v_mfma_f32_16x16x32_bf16 v[22:25], v[64:67], v[64:67], v[22:25]
s_waitcnt lgkmcnt(4)
v_mfma_f32_16x16x32_bf16 v[22:25], v[68:71], v[68:71], v[22:25]
s_waitcnt lgkmcnt(2)
v_mfma_f32_16x16x32_bf16 v[22:25], v[72:75], v[72:75], v[22:25]
ds_read_b128 v[104:107], v3 offset:18432
s_waitcnt lgkmcnt(1)
v_mfma_f32_16x16x32_bf16 v[22:25], v[76:79], v[76:79], v[22:25]
ds_read_b128 v[108:111], v3 offset:19456
ds_read_b64_tr_b16 v[18:19], v6
v_mfma_f32_16x16x32_bf16 v[112:115], v[30:33], v[64:67], 0
v_cvt_pk_bf16_f32 v124, v26, v27
v_cvt_pk_bf16_f32 v125, v28, v29
v_mfma_f32_16x16x32_bf16 v[112:115], v[38:41], v[68:71], v[112:115]
v_cvt_pk_bf16_f32 v126, v26, v27
v_cvt_pk_bf16_f32 v127, v28, v29
v_mfma_f32_16x16x32_bf16 v[112:115], v[46:49], v[72:75], v[112:115]
ds_read_b128 v[88:91], v3 offset:26624
global_store_dwordx2 v15, v[124:125], s[72:73] sc1
v_mfma_f32_16x16x32_bf16 v[112:115], v[54:57], v[76:79], v[112:115]
ds_read_b128 v[92:95], v3 offset:27648
v_max3_f32 v62, v22, v23, v24
v_mfma_f32_16x16x32_bf16 v[116:119], v[34:37], v[64:67], 0
v_permlane32_swap_b32 v124, v126
v_permlane32_swap_b32 v125, v127
v_mfma_f32_16x16x32_bf16 v[116:119], v[42:45], v[68:71], v[116:119]
s_waitcnt lgkmcnt(2)
global_store_dwordx2 v14, v[18:19], s[70:71] sc1
v_mfma_f32_16x16x32_bf16 v[116:119], v[50:53], v[72:75], v[116:119]
v_max3_f32 v62, v62, v25, v112
v_max3_f32 v63, v113, v114, v115
v_mfma_f32_16x16x32_bf16 v[116:119], v[58:61], v[76:79], v[116:119]
v_max_f32 v62, v62, v63
s_cmp_eq_u32 s54, 63
s_cbranch_scc1 L_chain_end
v_mov_b64 v[26:27], s[42:43]
v_mov_b64 v[30:31], 0
v_mov_b64 v[32:33], 0
s_nop 1
v_max3_f32 v63, v116, v117, v118
v_max3_f32 v62, v62, v63, v119
v_mov_b32 v63, v62
v_mov_b64 v[34:35], 0
v_mov_b64 v[36:37], 0
v_permlane32_swap_b32 v62, v63
v_max_f32 v62, v62, v63
v_mov_b32 v63, v62
v_mov_b64 v[38:39], 0
v_mov_b64 v[28:29], s[42:43]
v_permlane16_swap_b32 v62, v63
v_max_f32 v62, v62, v63
v_mul_f32 v62, s88, v62
v_pk_fma_f32 v[112:113], v[112:113], s[88:89], v[62:63] op_sel_hi:[1,1,0] neg_lo:[0,0,1] neg_hi:[0,0,1]
v_pk_fma_f32 v[114:115], v[114:115], s[88:89], v[62:63] op_sel_hi:[1,1,0] neg_lo:[0,0,1] neg_hi:[0,0,1]
v_pk_fma_f32 v[116:117], v[116:117], s[88:89], v[62:63] op_sel_hi:[1,1,0] neg_lo:[0,0,1] neg_hi:[0,0,1]
v_pk_fma_f32 v[118:119], v[118:119], s[88:89], v[62:63] op_sel_hi:[1,1,0] neg_lo:[0,0,1] neg_hi:[0,0,1]
v_pk_fma_f32 v[22:23], v[22:23], s[88:89], v[62:63] op_sel_hi:[1,1,0] neg_lo:[0,0,1] neg_hi:[0,0,1]
v_pk_fma_f32 v[24:25], v[24:25], s[88:89], v[62:63] op_sel_hi:[1,1,0] neg_lo:[0,0,1] neg_hi:[0,0,1]
v_exp_f32 v112, v112
v_exp_f32 v113, v113
v_exp_f32 v114, v114
v_exp_f32 v115, v115
s_waitcnt vmcnt(6)
ds_read_b128 v[72:75], v8 offset:0
ds_read_b128 v[76:79], v8 offset:1024
v_exp_f32 v116, v116
v_exp_f32 v117, v117
v_cvt_pk_bf16_f32 v64, v112, v113
v_cvt_pk_bf16_f32 v65, v114, v115
v_exp_f32 v118, v118
v_exp_f32 v119, v119
v_cvt_pk_bf16_f32 v66, v116, v117
v_cvt_pk_bf16_f32 v67, v118, v119
s_waitcnt lgkmcnt(0)
v_exp_f32 v22, v22
v_mfma_f32_16x16x32_bf16 v[112:115], v[26:29], v[64:67], 0
v_exp_f32 v23, v23
v_mfma_f32_16x16x32_bf16 v[116:119], v[72:75], v[64:67], 0
v_exp_f32 v24, v24
v_mfma_f32_16x16x32_bf16 v[120:123], v[76:79], v[64:67], 0
v_exp_f32 v25, v25
v_cvt_pk_bf16_f32 v68, v22, v23
v_cvt_pk_bf16_f32 v69, v24, v25
s_nop 1
v_mfma_f32_16x16x16_bf16 v[112:115], v[26:27], v[68:69], v[112:115]
v_mfma_f32_16x16x16_bf16 v[116:119], v[124:125], v[68:69], v[116:119]
v_mfma_f32_16x16x16_bf16 v[120:123], v[126:127], v[68:69], v[120:123]
v_rcp_f32 v112, v112
v_mov_b64 v[40:41], 0
v_mov_b64 v[42:43], 0
v_mov_b64 v[44:45], 0
v_pk_mul_f32 v[116:117], v[116:117], v[112:113] op_sel_hi:[1,0]
v_pk_mul_f32 v[118:119], v[118:119], v[112:113] op_sel_hi:[1,0]
v_cvt_pk_bf16_f32 v124, v116, v117
v_cvt_pk_bf16_f32 v125, v118, v119
v_pk_mul_f32 v[120:121], v[120:121], v[112:113] op_sel_hi:[1,0]
v_pk_mul_f32 v[122:123], v[122:123], v[112:113] op_sel_hi:[1,0]
v_cvt_pk_bf16_f32 v126, v120, v121
v_cvt_pk_bf16_f32 v127, v122, v123
ds_write_b128 v9, v[124:127]
v_mov_b32_dpp v124, v124 row_shr:8 row_mask:0xf bank_mask:0xc
v_mov_b32_dpp v125, v125 row_shr:8 row_mask:0xf bank_mask:0xc
v_mov_b32_dpp v126, v126 row_shr:8 row_mask:0xf bank_mask:0xc
v_mov_b32_dpp v127, v127 row_shr:8 row_mask:0xf bank_mask:0xc
s_waitcnt vmcnt(2)
s_waitcnt lgkmcnt(0)
s_barrier
ds_read_b128 v[112:115], v10 offset:32
ds_read_b128 v[116:119], v10 offset:48
ds_read_b128 v[120:123], v10 offset:0
v_smfmac_f32_16x16x64_bf16 v[30:33], v[124:127], v[192:199], v2
ds_read_b128 v[96:99], v3 offset:16384
ds_read_b128 v[100:103], v3 offset:17408
v_smfmac_f32_16x16x64_bf16 v[34:37], v[124:127], v[200:207], v2
ds_read_b128 v[80:83], v3 offset:24576
ds_read_b128 v[84:87], v3 offset:25600
v_smfmac_f32_16x16x64_bf16 v[38:41], v[124:127], v[208:215], v2
ds_read_b128 v[46:49], v3 offset:20480
v_smfmac_f32_16x16x64_bf16 v[42:45], v[124:127], v[216:223], v2
ds_read_b128 v[50:53], v3 offset:21504
s_waitcnt lgkmcnt(8)
v_smfmac_f32_16x16x64_bf16 v[30:33], v[112:115], v[224:231], v2
ds_read_b128 v[64:67], v3 offset:28672
s_waitcnt lgkmcnt(8)
s_waitcnt lgkmcnt(5)
v_smfmac_f32_16x16x64_bf16 v[30:33], v[116:119], v[96:103], v2
ds_read_b128 v[68:71], v3 offset:29696
s_waitcnt lgkmcnt(4)
v_smfmac_f32_16x16x64_bf16 v[30:33], v[120:123], v[80:87], v2
ds_read_b128 v[54:57], v3 offset:22528
v_smfmac_f32_16x16x64_bf16 v[34:37], v[112:115], v[232:239], v2
ds_read_b128 v[58:61], v3 offset:23552
v_smfmac_f32_16x16x64_bf16 v[34:37], v[116:119], v[104:111], v2
ds_read_b128 v[72:75], v3 offset:30720
v_cvt_pk_bf16_f32 v96, v30, v31
v_cvt_pk_bf16_f32 v97, v32, v33
v_smfmac_f32_16x16x64_bf16 v[34:37], v[120:123], v[88:95], v2
ds_read_b128 v[76:79], v3 offset:31744
v_smfmac_f32_16x16x64_bf16 v[38:41], v[112:115], v[240:247], v2
s_waitcnt lgkmcnt(6)
v_smfmac_f32_16x16x64_bf16 v[38:41], v[116:119], v[46:53], v2
v_cvt_pk_bf16_f32 v98, v34, v35
v_cvt_pk_bf16_f32 v99, v36, v37
global_store_dwordx4 v11, v[96:99], s[64:65]
s_waitcnt lgkmcnt(4)
v_smfmac_f32_16x16x64_bf16 v[38:41], v[120:123], v[64:71], v2
v_smfmac_f32_16x16x64_bf16 v[42:45], v[112:115], v[248:255], v2
s_waitcnt lgkmcnt(2)
v_smfmac_f32_16x16x64_bf16 v[42:45], v[116:119], v[54:61], v2
v_cvt_pk_bf16_f32 v100, v38, v39
v_cvt_pk_bf16_f32 v101, v40, v41
s_waitcnt lgkmcnt(0)
v_smfmac_f32_16x16x64_bf16 v[42:45], v[120:123], v[72:79], v2
v_add_u32 v14, 0x10000, v14
v_add_u32 v15, 0x10000, v15
v_xor_b32 v7, 0x2000, v7
v_xor_b32 v8, 0x2000, v8
v_mov_b64 v[18:19], 0
v_mov_b64 v[20:21], 0
v_mov_b64 v[22:23], 0
v_mov_b64 v[24:25], 0
v_cvt_pk_bf16_f32 v102, v42, v43
v_cvt_pk_bf16_f32 v103, v44, v45
global_store_dwordx4 v11, v[100:103], s[66:67]
ds_read_b128 v[112:115], v3 offset:4096
ds_read_b128 v[116:119], v3 offset:5120
ds_read_b128 v[120:123], v3 offset:6144
ds_read_b128 v[124:127], v3 offset:7168
s_add_u32 s68, s36, s57
s_addc_u32 s69, s37, 0
s_add_u32 s68, s68, 2048
s_addc_u32 s69, s69, 0
s_add_u32 s74, s34, s55
s_addc_u32 s75, s35, 0
v_xor_b32 v11, 524288, v11
s_xor_b32 s55, s55, 524288
s_xor_b32 s59, s59, 0x2000
s_mov_b32 s56, s57
s_add_u32 s57, s57, 8704
s_cmp_eq_u32 s57, 26112
s_cselect_b32 s57, 0, s57
s_add_u32 s54, s54, 1
s_add_u32 s96, s96, 0x40000
s_addc_u32 s97, s97, 0
s_add_u32 s48, s48, 0x40000
s_addc_u32 s49, s49, 0
v_mov_b64 v[26:27], 0
v_mov_b64 v[28:29], 0
v_mov_b64 v[100:101], -1
v_mov_b64 v[102:103], -1
s_waitcnt vmcnt(0) lgkmcnt(0)
s_branch L_gat01
L_gret01:
global_load_dwordx4 v[104:107], v17, s[68:69] offset:0 sc1
global_load_dwordx4 v[108:111], v17, s[68:69] offset:1024 sc1
s_add_u32 s45, s45, 1
s_add_u32 s38, s38, 1
s_waitcnt vmcnt(1)
ds_write_b128 v1, v[104:107] offset:2048
v_max_u32 v62, v104, v106
s_waitcnt vmcnt(0)
ds_write_b128 v1, v[108:111] offset:3072
v_max3_u32 v62, v62, v108, v110
v_cmp_eq_u32 vcc, -1, v62
s_cbranch_vccz L_gok01
s_cmp_lt_u32 s45, 20000
s_cbranch_scc1 L_gret01
s_branch L_gok01
.p2align 6
s_nop 0
s_nop 0
L_gat02:
s_barrier
global_load_dwordx4 v[104:107], v17, s[68:69] offset:0 sc1
global_load_dwordx4 v[108:111], v17, s[68:69] offset:1024 sc1
ds_read_b128 v[30:33], v7 offset:0
ds_read_b128 v[34:37], v7 offset:1024
ds_read_b128 v[38:41], v7 offset:2048
ds_read_b128 v[42:45], v7 offset:3072
ds_read_b128 v[46:49], v7 offset:4096
ds_read_b128 v[50:53], v7 offset:5120
ds_read_b128 v[54:57], v7 offset:6144
ds_read_b128 v[58:61], v7 offset:7168
s_mov_b32 s45, 0
s_waitcnt vmcnt(1)
ds_write_b128 v1, v[104:107] offset:4096
v_max_u32 v62, v104, v106
s_waitcnt vmcnt(0)
ds_write_b128 v1, v[108:111] offset:5120
v_max3_u32 v62, v62, v108, v110
v_cmp_eq_u32 vcc, -1, v62
s_cbranch_vccnz L_gret02
L_gok02:
L_pre02:
v_smfmac_f32_16x16x64_bf16 v[18:21], v[104:107], a[128:135], v2
v_smfmac_f32_16x16x64_bf16 v[22:25], v[104:107], a[136:143], v2
v_smfmac_f32_16x16x64_bf16 v[18:21], v[108:111], a[160:167], v2
s_waitcnt lgkmcnt(0)
L_step02:
s_barrier
ds_read_b128 v[96:99], v1 offset:6144
ds_read_b128 v[100:103], v1 offset:7168
v_smfmac_f32_16x16x64_bf16 v[26:29], v[104:107], v[112:119], v2
ds_read_b128 v[112:115], v3 offset:12288
global_load_lds_dwordx4 v0, s[48:49] sc1
v_smfmac_f32_16x16x64_bf16 v[26:29], v[108:111], v[120:127], v2
ds_read_b128 v[116:119], v3 offset:13312
v_smfmac_f32_16x16x64_bf16 v[22:25], v[108:111], a[168:175], v2
ds_read_b128 v[120:123], v3 offset:14336
global_load_lds_dwordx4 v0, s[48:49] offset:1024 sc1
s_waitcnt lgkmcnt(4)
v_smfmac_f32_16x16x64_bf16 v[18:21], v[96:99], a[192:199], v2
ds_read_b128 v[124:127], v3 offset:15360
s_xor_b32 m0, s59, 0x2000
v_smfmac_f32_16x16x64_bf16 v[22:25], v[96:99], a[200:207], v2
ds_read_b128 v[104:107], v1 offset:0
global_load_lds_dwordx4 v0, s[96:97] sc1
s_waitcnt lgkmcnt(3)
v_smfmac_f32_16x16x64_bf16 v[26:29], v[96:99], v[112:119], v2
ds_read_b128 v[108:111], v1 offset:1024
v_smfmac_f32_16x16x64_bf16 v[18:21], v[100:103], a[224:231], v2
ds_read_b128 v[96:99], v1 offset:2048
global_load_lds_dwordx4 v0, s[96:97] offset:1024 sc1
v_smfmac_f32_16x16x64_bf16 v[22:25], v[100:103], a[232:239], v2
ds_read_b128 v[112:115], v3 offset:0
s_waitcnt lgkmcnt(4)
v_smfmac_f32_16x16x64_bf16 v[26:29], v[100:103], v[120:127], v2
ds_read_b128 v[116:119], v3 offset:1024
s_waitcnt lgkmcnt(4)
v_smfmac_f32_16x16x64_bf16 v[18:21], v[104:107], a[0:7], v2
ds_read_b128 v[100:103], v1 offset:3072
v_smfmac_f32_16x16x64_bf16 v[22:25], v[104:107], a[8:15], v2
ds_read_b128 v[120:123], v3 offset:2048
v_mov_b32 v63, -1
s_waitcnt lgkmcnt(5)
v_smfmac_f32_16x16x64_bf16 v[18:21], v[108:111], a[32:39], v2
ds_read_b128 v[124:127], v3 offset:3072
v_smfmac_f32_16x16x64_bf16 v[22:25], v[108:111], a[40:47], v2
ds_read_b128 v[64:67], v13 offset:512
global_store_dword v0, v63, s[74:75]
s_waitcnt lgkmcnt(6)
v_smfmac_f32_16x16x64_bf16 v[18:21], v[96:99], a[64:71], v2
ds_read_b128 v[68:71], v13 offset:1536
v_smfmac_f32_16x16x64_bf16 v[22:25], v[96:99], a[72:79], v2
ds_read_b128 v[72:75], v13 offset:2560
global_store_dword v0, v63, s[74:75] offset:1024
s_waitcnt lgkmcnt(5)
v_smfmac_f32_16x16x64_bf16 v[18:21], v[100:103], a[96:103], v2
ds_read_b128 v[76:79], v13 offset:3584
v_smfmac_f32_16x16x64_bf16 v[22:25], v[100:103], a[104:111], v2
ds_read_b128 v[80:83], v13 offset:4608
s_waitcnt lgkmcnt(4)
v_smfmac_f32_16x16x64_bf16 v[18:21], v[64:67], a[16:23], v2
ds_read_b128 v[84:87], v13 offset:5632
v_smfmac_f32_16x16x64_bf16 v[22:25], v[64:67], a[24:31], v2
ds_read_b128 v[88:91], v13 offset:6656
s_waitcnt lgkmcnt(5)
v_smfmac_f32_16x16x64_bf16 v[18:21], v[68:71], a[48:55], v2
ds_read_b128 v[92:95], v13 offset:7680
v_smfmac_f32_16x16x64_bf16 v[22:25], v[68:71], a[56:63], v2
s_waitcnt lgkmcnt(5)
v_smfmac_f32_16x16x64_bf16 v[18:21], v[72:75], a[80:87], v2
v_smfmac_f32_16x16x64_bf16 v[22:25], v[72:75], a[88:95], v2
s_waitcnt lgkmcnt(4)
v_smfmac_f32_16x16x64_bf16 v[18:21], v[76:79], a[112:119], v2
v_smfmac_f32_16x16x64_bf16 v[22:25], v[76:79], a[120:127], v2
s_waitcnt lgkmcnt(3)
v_smfmac_f32_16x16x64_bf16 v[18:21], v[80:83], a[144:151], v2
v_smfmac_f32_16x16x64_bf16 v[22:25], v[80:83], a[152:159], v2
s_waitcnt lgkmcnt(2)
v_smfmac_f32_16x16x64_bf16 v[18:21], v[84:87], a[176:183], v2
v_smfmac_f32_16x16x64_bf16 v[22:25], v[84:87], a[184:191], v2
s_waitcnt lgkmcnt(1)
v_smfmac_f32_16x16x64_bf16 v[18:21], v[88:91], a[208:215], v2
v_smfmac_f32_16x16x64_bf16 v[22:25], v[88:91], a[216:223], v2
s_waitcnt lgkmcnt(0)
v_smfmac_f32_16x16x64_bf16 v[18:21], v[92:95], a[240:247], v2
v_smfmac_f32_16x16x64_bf16 v[22:25], v[92:95], a[248:255], v2
v_smfmac_f32_16x16x64_bf16 v[26:29], v[80:83], v[160:167], v2
v_cvt_pk_bf16_f32 v18, v18, v19
v_cvt_pk_bf16_f32 v19, v20, v21
ds_write_b64 v4, v[18:19]
s_nop 0
v_cvt_pk_bf16_f32 v20, v22, v23
v_cvt_pk_bf16_f32 v21, v24, v25
ds_write_b64 v4, v[20:21] offset:32
v_smfmac_f32_16x16x64_bf16 v[26:29], v[84:87], v[168:175], v2
ds_read_b128 v[80:83], v3 offset:4096
v_smfmac_f32_16x16x64_bf16 v[26:29], v[88:91], v[176:183], v2
ds_read_b128 v[84:87], v3 offset:5120
v_smfmac_f32_16x16x64_bf16 v[26:29], v[92:95], v[184:191], v2
ds_read_b128 v[88:91], v3 offset:6144
v_smfmac_f32_16x16x64_bf16 v[26:29], v[64:67], v[128:135], v2
ds_read_b128 v[92:95], v3 offset:7168
v_smfmac_f32_16x16x64_bf16 v[26:29], v[68:71], v[136:143], v2
v_mov_b32 v22, v16
v_mov_b32 v23, v16
v_smfmac_f32_16x16x64_bf16 v[26:29], v[72:75], v[144:151], v2
v_mov_b32 v24, v16
v_mov_b32 v25, v16
v_smfmac_f32_16x16x64_bf16 v[26:29], v[76:79], v[152:159], v2
s_waitcnt lgkmcnt(4)
s_barrier
ds_read_b64_tr_b16 v[64:65], v5 offset:0
ds_read_b64_tr_b16 v[66:67], v5 offset:32
ds_read_b64_tr_b16 v[68:69], v5 offset:1536
ds_read_b64_tr_b16 v[70:71], v5 offset:1568
v_smfmac_f32_16x16x64_bf16 v[26:29], v[104:107], v[112:119], v2
ds_read_b64_tr_b16 v[72:73], v5 offset:3072
v_smfmac_f32_16x16x64_bf16 v[26:29], v[108:111], v[120:127], v2
ds_read_b64_tr_b16 v[74:75], v5 offset:3104
s_waitcnt lgkmcnt(8)
v_smfmac_f32_16x16x64_bf16 v[26:29], v[96:99], v[80:87], v2
ds_read_b64_tr_b16 v[76:77], v5 offset:4608
s_waitcnt lgkmcnt(7)
v_smfmac_f32_16x16x64_bf16 v[26:29], v[100:103], v[88:95], v2
ds_read_b64_tr_b16 v[78:79], v5 offset:4640
s_waitcnt lgkmcnt(6)
v_mfma_f32_16x16x32_bf16 v[22:25], v[64:67], v[64:67], v[22:25]
s_waitcnt lgkmcnt(4)
v_mfma_f32_16x16x32_bf16 v[22:25], v[68:71], v[68:71], v[22:25]
s_waitcnt lgkmcnt(2)
v_mfma_f32_16x16x32_bf16 v[22:25], v[72:75], v[72:75], v[22:25]
ds_read_b128 v[104:107], v3 offset:18432
s_waitcnt lgkmcnt(1)
v_mfma_f32_16x16x32_bf16 v[22:25], v[76:79], v[76:79], v[22:25]
ds_read_b128 v[108:111], v3 offset:19456
ds_read_b64_tr_b16 v[18:19], v6
v_mfma_f32_16x16x32_bf16 v[112:115], v[30:33], v[64:67], 0
v_cvt_pk_bf16_f32 v124, v26, v27
v_cvt_pk_bf16_f32 v125, v28, v29
v_mfma_f32_16x16x32_bf16 v[112:115], v[38:41], v[68:71], v[112:115]
v_cvt_pk_bf16_f32 v126, v26, v27
v_cvt_pk_bf16_f32 v127, v28, v29
v_mfma_f32_16x16x32_bf16 v[112:115], v[46:49], v[72:75], v[112:115]
ds_read_b128 v[88:91], v3 offset:26624
global_store_dwordx2 v15, v[124:125], s[72:73] sc1
v_mfma_f32_16x16x32_bf16 v[112:115], v[54:57], v[76:79], v[112:115]
ds_read_b128 v[92:95], v3 offset:27648
v_max3_f32 v62, v22, v23, v24
v_mfma_f32_16x16x32_bf16 v[116:119], v[34:37], v[64:67], 0
v_permlane32_swap_b32 v124, v126
v_permlane32_swap_b32 v125, v127
v_mfma_f32_16x16x32_bf16 v[116:119], v[42:45], v[68:71], v[116:119]
s_waitcnt lgkmcnt(2)
global_store_dwordx2 v14, v[18:19], s[70:71] sc1
v_mfma_f32_16x16x32_bf16 v[116:119], v[50:53], v[72:75], v[116:119]
v_max3_f32 v62, v62, v25, v112
v_max3_f32 v63, v113, v114, v115
v_mfma_f32_16x16x32_bf16 v[116:119], v[58:61], v[76:79], v[116:119]
v_max_f32 v62, v62, v63
s_cmp_eq_u32 s54, 63
s_cbranch_scc1 L_chain_end
v_mov_b64 v[26:27], s[42:43]
v_mov_b64 v[30:31], 0
v_mov_b64 v[32:33], 0
s_nop 1
v_max3_f32 v63, v116, v117, v118
v_max3_f32 v62, v62, v63, v119
v_mov_b32 v63, v62
v_mov_b64 v[34:35], 0
v_mov_b64 v[36:37], 0
v_permlane32_swap_b32 v62, v63
v_max_f32 v62, v62, v63
v_mov_b32 v63, v62
v_mov_b64 v[38:39], 0
v_mov_b64 v[28:29], s[42:43]
v_permlane16_swap_b32 v62, v63
v_max_f32 v62, v62, v63
v_mul_f32 v62, s88, v62
v_pk_fma_f32 v[112:113], v[112:113], s[88:89], v[62:63] op_sel_hi:[1,1,0] neg_lo:[0,0,1] neg_hi:[0,0,1]
v_pk_fma_f32 v[114:115], v[114:115], s[88:89], v[62:63] op_sel_hi:[1,1,0] neg_lo:[0,0,1] neg_hi:[0,0,1]
v_pk_fma_f32 v[116:117], v[116:117], s[88:89], v[62:63] op_sel_hi:[1,1,0] neg_lo:[0,0,1] neg_hi:[0,0,1]
v_pk_fma_f32 v[118:119], v[118:119], s[88:89], v[62:63] op_sel_hi:[1,1,0] neg_lo:[0,0,1] neg_hi:[0,0,1]
v_pk_fma_f32 v[22:23], v[22:23], s[88:89], v[62:63] op_sel_hi:[1,1,0] neg_lo:[0,0,1] neg_hi:[0,0,1]
v_pk_fma_f32 v[24:25], v[24:25], s[88:89], v[62:63] op_sel_hi:[1,1,0] neg_lo:[0,0,1] neg_hi:[0,0,1]
v_exp_f32 v112, v112
v_exp_f32 v113, v113
v_exp_f32 v114, v114
v_exp_f32 v115, v115
s_waitcnt vmcnt(6)
ds_read_b128 v[72:75], v8 offset:0
ds_read_b128 v[76:79], v8 offset:1024
v_exp_f32 v116, v116
v_exp_f32 v117, v117
v_cvt_pk_bf16_f32 v64, v112, v113
v_cvt_pk_bf16_f32 v65, v114, v115
v_exp_f32 v118, v118
v_exp_f32 v119, v119
v_cvt_pk_bf16_f32 v66, v116, v117
v_cvt_pk_bf16_f32 v67, v118, v119
s_waitcnt lgkmcnt(0)
v_exp_f32 v22, v22
v_mfma_f32_16x16x32_bf16 v[112:115], v[26:29], v[64:67], 0
v_exp_f32 v23, v23
v_mfma_f32_16x16x32_bf16 v[116:119], v[72:75], v[64:67], 0
v_exp_f32 v24, v24
v_mfma_f32_16x16x32_bf16 v[120:123], v[76:79], v[64:67], 0
v_exp_f32 v25, v25
v_cvt_pk_bf16_f32 v68, v22, v23
v_cvt_pk_bf16_f32 v69, v24, v25
s_nop 1
v_mfma_f32_16x16x16_bf16 v[112:115], v[26:27], v[68:69], v[112:115]
v_mfma_f32_16x16x16_bf16 v[116:119], v[124:125], v[68:69], v[116:119]
v_mfma_f32_16x16x16_bf16 v[120:123], v[126:127], v[68:69], v[120:123]
v_rcp_f32 v112, v112
v_mov_b64 v[40:41], 0
v_mov_b64 v[42:43], 0
v_mov_b64 v[44:45], 0
v_pk_mul_f32 v[116:117], v[116:117], v[112:113] op_sel_hi:[1,0]
v_pk_mul_f32 v[118:119], v[118:119], v[112:113] op_sel_hi:[1,0]
v_cvt_pk_bf16_f32 v124, v116, v117
v_cvt_pk_bf16_f32 v125, v118, v119
v_pk_mul_f32 v[120:121], v[120:121], v[112:113] op_sel_hi:[1,0]
v_pk_mul_f32 v[122:123], v[122:123], v[112:113] op_sel_hi:[1,0]
v_cvt_pk_bf16_f32 v126, v120, v121
v_cvt_pk_bf16_f32 v127, v122, v123
ds_write_b128 v9, v[124:127]
v_mov_b32_dpp v124, v124 row_shr:8 row_mask:0xf bank_mask:0xc
v_mov_b32_dpp v125, v125 row_shr:8 row_mask:0xf bank_mask:0xc
v_mov_b32_dpp v126, v126 row_shr:8 row_mask:0xf bank_mask:0xc
v_mov_b32_dpp v127, v127 row_shr:8 row_mask:0xf bank_mask:0xc
s_waitcnt vmcnt(2)
s_waitcnt lgkmcnt(0)
s_barrier
ds_read_b128 v[112:115], v10 offset:48
ds_read_b128 v[116:119], v10 offset:0
ds_read_b128 v[120:123], v10 offset:16
v_smfmac_f32_16x16x64_bf16 v[30:33], v[124:127], v[192:199], v2
ds_read_b128 v[96:99], v3 offset:16384
ds_read_b128 v[100:103], v3 offset:17408
v_smfmac_f32_16x16x64_bf16 v[34:37], v[124:127], v[200:207], v2
ds_read_b128 v[80:83], v3 offset:24576
ds_read_b128 v[84:87], v3 offset:25600
v_smfmac_f32_16x16x64_bf16 v[38:41], v[124:127], v[208:215], v2
ds_read_b128 v[46:49], v3 offset:20480
v_smfmac_f32_16x16x64_bf16 v[42:45], v[124:127], v[216:223], v2
ds_read_b128 v[50:53], v3 offset:21504
s_waitcnt lgkmcnt(8)
v_smfmac_f32_16x16x64_bf16 v[30:33], v[112:115], v[224:231], v2
ds_read_b128 v[64:67], v3 offset:28672
s_waitcnt lgkmcnt(8)
s_waitcnt lgkmcnt(5)
v_smfmac_f32_16x16x64_bf16 v[30:33], v[116:119], v[96:103], v2
ds_read_b128 v[68:71], v3 offset:29696
s_waitcnt lgkmcnt(4)
v_smfmac_f32_16x16x64_bf16 v[30:33], v[120:123], v[80:87], v2
ds_read_b128 v[54:57], v3 offset:22528
v_smfmac_f32_16x16x64_bf16 v[34:37], v[112:115], v[232:239], v2
ds_read_b128 v[58:61], v3 offset:23552
v_smfmac_f32_16x16x64_bf16 v[34:37], v[116:119], v[104:111], v2
ds_read_b128 v[72:75], v3 offset:30720
v_cvt_pk_bf16_f32 v96, v30, v31
v_cvt_pk_bf16_f32 v97, v32, v33
v_smfmac_f32_16x16x64_bf16 v[34:37], v[120:123], v[88:95], v2
ds_read_b128 v[76:79], v3 offset:31744
v_smfmac_f32_16x16x64_bf16 v[38:41], v[112:115], v[240:247], v2
s_waitcnt lgkmcnt(6)
v_smfmac_f32_16x16x64_bf16 v[38:41], v[116:119], v[46:53], v2
v_cvt_pk_bf16_f32 v98, v34, v35
v_cvt_pk_bf16_f32 v99, v36, v37
global_store_dwordx4 v11, v[96:99], s[64:65]
s_waitcnt lgkmcnt(4)
v_smfmac_f32_16x16x64_bf16 v[38:41], v[120:123], v[64:71], v2
v_smfmac_f32_16x16x64_bf16 v[42:45], v[112:115], v[248:255], v2
s_waitcnt lgkmcnt(2)
v_smfmac_f32_16x16x64_bf16 v[42:45], v[116:119], v[54:61], v2
v_cvt_pk_bf16_f32 v100, v38, v39
v_cvt_pk_bf16_f32 v101, v40, v41
s_waitcnt lgkmcnt(0)
v_smfmac_f32_16x16x64_bf16 v[42:45], v[120:123], v[72:79], v2
v_add_u32 v14, 0x10000, v14
v_add_u32 v15, 0x10000, v15
v_xor_b32 v7, 0x2000, v7
v_xor_b32 v8, 0x2000, v8
v_mov_b64 v[18:19], 0
v_mov_b64 v[20:21], 0
v_mov_b64 v[22:23], 0
v_mov_b64 v[24:25], 0
v_cvt_pk_bf16_f32 v102, v42, v43
v_cvt_pk_bf16_f32 v103, v44, v45
global_store_dwordx4 v11, v[100:103], s[66:67]
ds_read_b128 v[112:115], v3 offset:8192
ds_read_b128 v[116:119], v3 offset:9216
ds_read_b128 v[120:123], v3 offset:10240
ds_read_b128 v[124:127], v3 offset:11264
s_add_u32 s68, s36, s57
s_addc_u32 s69, s37, 0
s_add_u32 s68, s68, 4096
s_addc_u32 s69, s69, 0
s_add_u32 s74, s34, s55
s_addc_u32 s75, s35, 0
v_xor_b32 v11, 524288, v11
s_xor_b32 s55, s55, 524288
s_xor_b32 s59, s59, 0x2000
s_mov_b32 s56, s57
s_add_u32 s57, s57, 8704
s_cmp_eq_u32 s57, 26112
s_cselect_b32 s57, 0, s57
s_add_u32 s54, s54, 1
s_add_u32 s96, s96, 0x40000
s_addc_u32 s97, s97, 0
s_add_u32 s48, s48, 0x40000
s_addc_u32 s49, s49, 0
s_add_u32 s58, s54, 2
s_min_u32 s58, s58, 63
s_add_u32 s78, s78, 0x40000
s_addc_u32 s79, s79, 0
s_add_u32 s80, s80, 0x40000
s_addc_u32 s81, s81, 0
v_mov_b64 v[26:27], 0
v_mov_b64 v[28:29], 0
v_mov_b64 v[100:101], -1
v_mov_b64 v[102:103], -1
s_cmp_lt_u32 s58, s50
s_cbranch_scc0 L_kvpolls02
L_kvrdys02:
s_waitcnt vmcnt(0) lgkmcnt(0)
s_branch L_gat02
L_gret02:
global_load_dwordx4 v[104:107], v17, s[68:69] offset:0 sc1
global_load_dwordx4 v[108:111], v17, s[68:69] offset:1024 sc1
s_add_u32 s45, s45, 1
s_add_u32 s38, s38, 1
s_waitcnt vmcnt(1)
ds_write_b128 v1, v[104:107] offset:4096
v_max_u32 v62, v104, v106
s_waitcnt vmcnt(0)
ds_write_b128 v1, v[108:111] offset:5120
v_max3_u32 v62, v62, v108, v110
v_cmp_eq_u32 vcc, -1, v62
s_cbranch_vccz L_gok02
s_cmp_lt_u32 s45, 20000
s_cbranch_scc1 L_gret02
s_branch L_gok02
L_kvpolls02:
s_lshl_b32 s44, s32, 7
s_add_u32 s44, s44, 0
s_add_u32 s46, s26, s44
s_addc_u32 s47, s27, 0
v_lshrrev_b32 v63, 2, v0
s_mov_b32 s51, 0
L_kvps02:
global_load_dword v62, v63, s[46:47] sc1
s_add_u32 s51, s51, 1
s_waitcnt vmcnt(0)
v_readlane_b32 s44, v62, 0
v_readlane_b32 s45, v62, 1
v_readlane_b32 s52, v62, 2
s_mul_i32 s44, s44, 3
s_mul_i32 s45, s45, 3
s_mul_i32 s52, s52, 3
s_add_u32 s45, s45, 1
s_add_u32 s52, s52, 2
s_min_u32 s44, s44, s45
s_min_u32 s50, s44, s52
s_cmp_lt_u32 s58, s50
s_cbranch_scc1 L_kvrdys02
s_cmp_lt_u32 s51, 300000
s_cbranch_scc1 L_kvps02
s_branch L_kvrdys02
.p2align 6
s_nop 0
s_nop 0
s_nop 0
s_nop 0
s_nop 0
s_nop 0
s_nop 0
s_nop 0
s_nop 0
s_nop 0
s_nop 0
s_nop 0
s_nop 0
s_nop 0
s_nop 0
L_gat03:
s_barrier
global_load_dwordx4 v[104:107], v17, s[68:69] offset:0 sc1
global_load_dwordx4 v[108:111], v17, s[68:69] offset:1024 sc1
ds_read_b128 v[30:33], v7 offset:0
ds_read_b128 v[34:37], v7 offset:1024
ds_read_b128 v[38:41], v7 offset:2048
ds_read_b128 v[42:45], v7 offset:3072
ds_read_b128 v[46:49], v7 offset:4096
ds_read_b128 v[50:53], v7 offset:5120
ds_read_b128 v[54:57], v7 offset:6144
ds_read_b128 v[58:61], v7 offset:7168
s_mov_b32 s45, 0
s_waitcnt vmcnt(1)
ds_write_b128 v1, v[104:107] offset:6144
v_max_u32 v62, v104, v106
s_waitcnt vmcnt(0)
ds_write_b128 v1, v[108:111] offset:7168
v_max3_u32 v62, v62, v108, v110
v_cmp_eq_u32 vcc, -1, v62
s_cbranch_vccnz L_gret03
L_gok03:
v_mov_b32 v63, s54
global_store_dword v18, v63, s[86:87] sc1
L_pre03:
v_smfmac_f32_16x16x64_bf16 v[18:21], v[104:107], a[192:199], v2
v_smfmac_f32_16x16x64_bf16 v[22:25], v[104:107], a[200:207], v2
v_smfmac_f32_16x16x64_bf16 v[18:21], v[108:111], a[224:231], v2
s_waitcnt lgkmcnt(0)
L_step03:
s_barrier
ds_read_b128 v[96:99], v1 offset:0
ds_read_b128 v[100:103], v1 offset:1024
v_smfmac_f32_16x16x64_bf16 v[26:29], v[104:107], v[112:119], v2
ds_read_b128 v[112:115], v3 offset:0
global_load_lds_dwordx4 v0, s[48:49] sc1
v_smfmac_f32_16x16x64_bf16 v[26:29], v[108:111], v[120:127], v2
ds_read_b128 v[116:119], v3 offset:1024
v_smfmac_f32_16x16x64_bf16 v[22:25], v[108:111], a[232:239], v2
ds_read_b128 v[120:123], v3 offset:2048
global_load_lds_dwordx4 v0, s[48:49] offset:1024 sc1
s_waitcnt lgkmcnt(4)
v_smfmac_f32_16x16x64_bf16 v[18:21], v[96:99], a[0:7], v2
ds_read_b128 v[124:127], v3 offset:3072
s_xor_b32 m0, s59, 0x2000
v_smfmac_f32_16x16x64_bf16 v[22:25], v[96:99], a[8:15], v2
ds_read_b128 v[104:107], v1 offset:2048
global_load_lds_dwordx4 v0, s[96:97] sc1
s_waitcnt lgkmcnt(3)
v_smfmac_f32_16x16x64_bf16 v[26:29], v[96:99], v[112:119], v2
ds_read_b128 v[108:111], v1 offset:3072
v_smfmac_f32_16x16x64_bf16 v[18:21], v[100:103], a[32:39], v2
ds_read_b128 v[96:99], v1 offset:4096
global_load_lds_dwordx4 v0, s[96:97] offset:1024 sc1
v_smfmac_f32_16x16x64_bf16 v[22:25], v[100:103], a[40:47], v2
ds_read_b128 v[112:115], v3 offset:4096
s_waitcnt lgkmcnt(4)
v_smfmac_f32_16x16x64_bf16 v[26:29], v[100:103], v[120:127], v2
ds_read_b128 v[116:119], v3 offset:5120
s_waitcnt lgkmcnt(4)
v_smfmac_f32_16x16x64_bf16 v[18:21], v[104:107], a[64:71], v2
ds_read_b128 v[100:103], v1 offset:5120
v_smfmac_f32_16x16x64_bf16 v[22:25], v[104:107], a[72:79], v2
ds_read_b128 v[120:123], v3 offset:6144
v_mov_b32 v63, -1
s_waitcnt lgkmcnt(5)
v_smfmac_f32_16x16x64_bf16 v[18:21], v[108:111], a[96:103], v2
ds_read_b128 v[124:127], v3 offset:7168
v_smfmac_f32_16x16x64_bf16 v[22:25], v[108:111], a[104:111], v2
ds_read_b128 v[64:67], v13 offset:512
global_store_dword v0, v63, s[74:75]
s_waitcnt lgkmcnt(6)
v_smfmac_f32_16x16x64_bf16 v[18:21], v[96:99], a[128:135], v2
ds_read_b128 v[68:71], v13 offset:1536
v_smfmac_f32_16x16x64_bf16 v[22:25], v[96:99], a[136:143], v2
ds_read_b128 v[72:75], v13 offset:2560
global_store_dword v0, v63, s[74:75] offset:1024
s_waitcnt lgkmcnt(5)
v_smfmac_f32_16x16x64_bf16 v[18:21], v[100:103], a[160:167], v2
ds_read_b128 v[76:79], v13 offset:3584
v_smfmac_f32_16x16x64_bf16 v[22:25], v[100:103], a[168:175], v2
ds_read_b128 v[80:83], v13 offset:4608
s_waitcnt lgkmcnt(4)
v_smfmac_f32_16x16x64_bf16 v[18:21], v[64:67], a[16:23], v2
ds_read_b128 v[84:87], v13 offset:5632
v_smfmac_f32_16x16x64_bf16 v[22:25], v[64:67], a[24:31], v2
ds_read_b128 v[88:91], v13 offset:6656
s_waitcnt lgkmcnt(5)
v_smfmac_f32_16x16x64_bf16 v[18:21], v[68:71], a[48:55], v2
ds_read_b128 v[92:95], v13 offset:7680
v_smfmac_f32_16x16x64_bf16 v[22:25], v[68:71], a[56:63], v2
s_waitcnt lgkmcnt(5)
v_smfmac_f32_16x16x64_bf16 v[18:21], v[72:75], a[80:87], v2
v_smfmac_f32_16x16x64_bf16 v[22:25], v[72:75], a[88:95], v2
s_waitcnt lgkmcnt(4)
v_smfmac_f32_16x16x64_bf16 v[18:21], v[76:79], a[112:119], v2
v_smfmac_f32_16x16x64_bf16 v[22:25], v[76:79], a[120:127], v2
s_waitcnt lgkmcnt(3)
v_smfmac_f32_16x16x64_bf16 v[18:21], v[80:83], a[144:151], v2
v_smfmac_f32_16x16x64_bf16 v[22:25], v[80:83], a[152:159], v2
s_waitcnt lgkmcnt(2)
v_smfmac_f32_16x16x64_bf16 v[18:21], v[84:87], a[176:183], v2
v_smfmac_f32_16x16x64_bf16 v[22:25], v[84:87], a[184:191], v2
s_waitcnt lgkmcnt(1)
v_smfmac_f32_16x16x64_bf16 v[18:21], v[88:91], a[208:215], v2
v_smfmac_f32_16x16x64_bf16 v[22:25], v[88:91], a[216:223], v2
s_waitcnt lgkmcnt(0)
v_smfmac_f32_16x16x64_bf16 v[18:21], v[92:95], a[240:247], v2
v_smfmac_f32_16x16x64_bf16 v[22:25], v[92:95], a[248:255], v2
v_smfmac_f32_16x16x64_bf16 v[26:29], v[80:83], v[160:167], v2
v_cvt_pk_bf16_f32 v18, v18, v19
v_cvt_pk_bf16_f32 v19, v20, v21
ds_write_b64 v4, v[18:19]
s_nop 0
v_cvt_pk_bf16_f32 v20, v22, v23
v_cvt_pk_bf16_f32 v21, v24, v25
ds_write_b64 v4, v[20:21] offset:32
v_smfmac_f32_16x16x64_bf16 v[26:29], v[84:87], v[168:175], v2
ds_read_b128 v[80:83], v3 offset:8192
v_smfmac_f32_16x16x64_bf16 v[26:29], v[88:91], v[176:183], v2
ds_read_b128 v[84:87], v3 offset:9216
v_smfmac_f32_16x16x64_bf16 v[26:29], v[92:95], v[184:191], v2
ds_read_b128 v[88:91], v3 offset:10240
v_smfmac_f32_16x16x64_bf16 v[26:29], v[64:67], v[128:135], v2
ds_read_b128 v[92:95], v3 offset:11264
v_smfmac_f32_16x16x64_bf16 v[26:29], v[68:71], v[136:143], v2
v_mov_b32 v22, v16
v_mov_b32 v23, v16
v_smfmac_f32_16x16x64_bf16 v[26:29], v[72:75], v[144:151], v2
v_mov_b32 v24, v16
v_mov_b32 v25, v16
v_smfmac_f32_16x16x64_bf16 v[26:29], v[76:79], v[152:159], v2
s_waitcnt lgkmcnt(4)
s_barrier
ds_read_b64_tr_b16 v[64:65], v5 offset:0
ds_read_b64_tr_b16 v[66:67], v5 offset:32
ds_read_b64_tr_b16 v[68:69], v5 offset:1536
ds_read_b64_tr_b16 v[70:71], v5 offset:1568
v_smfmac_f32_16x16x64_bf16 v[26:29], v[104:107], v[112:119], v2
ds_read_b64_tr_b16 v[72:73], v5 offset:3072
v_smfmac_f32_16x16x64_bf16 v[26:29], v[108:111], v[120:127], v2
ds_read_b64_tr_b16 v[74:75], v5 offset:3104
s_waitcnt lgkmcnt(8)
v_smfmac_f32_16x16x64_bf16 v[26:29], v[96:99], v[80:87], v2
ds_read_b64_tr_b16 v[76:77], v5 offset:4608
s_waitcnt lgkmcnt(7)
v_smfmac_f32_16x16x64_bf16 v[26:29], v[100:103], v[88:95], v2
ds_read_b64_tr_b16 v[78:79], v5 offset:4640
s_waitcnt lgkmcnt(6)
v_mfma_f32_16x16x32_bf16 v[22:25], v[64:67], v[64:67], v[22:25]
s_waitcnt lgkmcnt(4)
v_mfma_f32_16x16x32_bf16 v[22:25], v[68:71], v[68:71], v[22:25]
s_waitcnt lgkmcnt(2)
v_mfma_f32_16x16x32_bf16 v[22:25], v[72:75], v[72:75], v[22:25]
ds_read_b128 v[104:107], v3 offset:18432
s_waitcnt lgkmcnt(1)
v_mfma_f32_16x16x32_bf16 v[22:25], v[76:79], v[76:79], v[22:25]
ds_read_b128 v[108:111], v3 offset:19456
ds_read_b64_tr_b16 v[18:19], v6
v_mfma_f32_16x16x32_bf16 v[112:115], v[30:33], v[64:67], 0
v_cvt_pk_bf16_f32 v124, v26, v27
v_cvt_pk_bf16_f32 v125, v28, v29
v_mfma_f32_16x16x32_bf16 v[112:115], v[38:41], v[68:71], v[112:115]
v_cvt_pk_bf16_f32 v126, v26, v27
v_cvt_pk_bf16_f32 v127, v28, v29
v_mfma_f32_16x16x32_bf16 v[112:115], v[46:49], v[72:75], v[112:115]
ds_read_b128 v[88:91], v3 offset:26624
global_store_dwordx2 v15, v[124:125], s[72:73] sc1
v_mfma_f32_16x16x32_bf16 v[112:115], v[54:57], v[76:79], v[112:115]
ds_read_b128 v[92:95], v3 offset:27648
v_max3_f32 v62, v22, v23, v24
v_mfma_f32_16x16x32_bf16 v[116:119], v[34:37], v[64:67], 0
v_permlane32_swap_b32 v124, v126
v_permlane32_swap_b32 v125, v127
v_mfma_f32_16x16x32_bf16 v[116:119], v[42:45], v[68:71], v[116:119]
s_waitcnt lgkmcnt(2)
global_store_dwordx2 v14, v[18:19], s[70:71] sc1
v_mfma_f32_16x16x32_bf16 v[116:119], v[50:53], v[72:75], v[116:119]
v_max3_f32 v62, v62, v25, v112
v_max3_f32 v63, v113, v114, v115
v_mfma_f32_16x16x32_bf16 v[116:119], v[58:61], v[76:79], v[116:119]
v_max_f32 v62, v62, v63
s_cmp_eq_u32 s54, 63
s_cbranch_scc1 L_chain_end
v_mov_b64 v[26:27], s[42:43]
v_mov_b64 v[30:31], 0
v_mov_b64 v[32:33], 0
s_nop 1
v_max3_f32 v63, v116, v117, v118
v_max3_f32 v62, v62, v63, v119
v_mov_b32 v63, v62
v_mov_b64 v[34:35], 0
v_mov_b64 v[36:37], 0
v_permlane32_swap_b32 v62, v63
v_max_f32 v62, v62, v63
v_mov_b32 v63, v62
v_mov_b64 v[38:39], 0
v_mov_b64 v[28:29], s[42:43]
v_permlane16_swap_b32 v62, v63
v_max_f32 v62, v62, v63
v_mul_f32 v62, s88, v62
v_pk_fma_f32 v[112:113], v[112:113], s[88:89], v[62:63] op_sel_hi:[1,1,0] neg_lo:[0,0,1] neg_hi:[0,0,1]
v_pk_fma_f32 v[114:115], v[114:115], s[88:89], v[62:63] op_sel_hi:[1,1,0] neg_lo:[0,0,1] neg_hi:[0,0,1]
v_pk_fma_f32 v[116:117], v[116:117], s[88:89], v[62:63] op_sel_hi:[1,1,0] neg_lo:[0,0,1] neg_hi:[0,0,1]
v_pk_fma_f32 v[118:119], v[118:119], s[88:89], v[62:63] op_sel_hi:[1,1,0] neg_lo:[0,0,1] neg_hi:[0,0,1]
v_pk_fma_f32 v[22:23], v[22:23], s[88:89], v[62:63] op_sel_hi:[1,1,0] neg_lo:[0,0,1] neg_hi:[0,0,1]
v_pk_fma_f32 v[24:25], v[24:25], s[88:89], v[62:63] op_sel_hi:[1,1,0] neg_lo:[0,0,1] neg_hi:[0,0,1]
v_exp_f32 v112, v112
v_exp_f32 v113, v113
v_exp_f32 v114, v114
v_exp_f32 v115, v115
s_waitcnt vmcnt(6)
ds_read_b128 v[72:75], v8 offset:0
ds_read_b128 v[76:79], v8 offset:1024
v_exp_f32 v116, v116
v_exp_f32 v117, v117
v_cvt_pk_bf16_f32 v64, v112, v113
v_cvt_pk_bf16_f32 v65, v114, v115
v_exp_f32 v118, v118
v_exp_f32 v119, v119
v_cvt_pk_bf16_f32 v66, v116, v117
v_cvt_pk_bf16_f32 v67, v118, v119
s_waitcnt lgkmcnt(0)
v_exp_f32 v22, v22
v_mfma_f32_16x16x32_bf16 v[112:115], v[26:29], v[64:67], 0
v_exp_f32 v23, v23
v_mfma_f32_16x16x32_bf16 v[116:119], v[72:75], v[64:67], 0
v_exp_f32 v24, v24
v_mfma_f32_16x16x32_bf16 v[120:123], v[76:79], v[64:67], 0
v_exp_f32 v25, v25
v_cvt_pk_bf16_f32 v68, v22, v23
v_cvt_pk_bf16_f32 v69, v24, v25
s_nop 1
v_mfma_f32_16x16x16_bf16 v[112:115], v[26:27], v[68:69], v[112:115]
v_mfma_f32_16x16x16_bf16 v[116:119], v[124:125], v[68:69], v[116:119]
v_mfma_f32_16x16x16_bf16 v[120:123], v[126:127], v[68:69], v[120:123]
v_rcp_f32 v112, v112
v_mov_b64 v[40:41], 0
v_mov_b64 v[42:43], 0
v_mov_b64 v[44:45], 0
v_pk_mul_f32 v[116:117], v[116:117], v[112:113] op_sel_hi:[1,0]
v_pk_mul_f32 v[118:119], v[118:119], v[112:113] op_sel_hi:[1,0]
v_cvt_pk_bf16_f32 v124, v116, v117
v_cvt_pk_bf16_f32 v125, v118, v119
v_pk_mul_f32 v[120:121], v[120:121], v[112:113] op_sel_hi:[1,0]
v_pk_mul_f32 v[122:123], v[122:123], v[112:113] op_sel_hi:[1,0]
v_cvt_pk_bf16_f32 v126, v120, v121
v_cvt_pk_bf16_f32 v127, v122, v123
ds_write_b128 v9, v[124:127]
v_lshlrev_b32 v63, 3, v0
v_and_b32 v63, 896, v63
s_add_u32 s44, s54, 1
v_mov_b32 v62, s44
v_mov_b32_dpp v124, v124 row_shr:8 row_mask:0xf bank_mask:0xc
v_mov_b32_dpp v125, v125 row_shr:8 row_mask:0xf bank_mask:0xc
v_mov_b32_dpp v126, v126 row_shr:8 row_mask:0xf bank_mask:0xc
v_mov_b32_dpp v127, v127 row_shr:8 row_mask:0xf bank_mask:0xc
s_waitcnt vmcnt(2)
s_waitcnt lgkmcnt(0)
s_barrier
ds_read_b128 v[112:115], v10 offset:0
ds_read_b128 v[116:119], v10 offset:16
ds_read_b128 v[120:123], v10 offset:32
s_mov_b64 exec, 0xff
global_store_dword v63, v62, s[40:41]
s_mov_b64 exec, -1
v_smfmac_f32_16x16x64_bf16 v[30:33], v[124:127], v[192:199], v2
ds_read_b128 v[96:99], v3 offset:16384
ds_read_b128 v[100:103], v3 offset:17408
v_smfmac_f32_16x16x64_bf16 v[34:37], v[124:127], v[200:207], v2
ds_read_b128 v[80:83], v3 offset:24576
ds_read_b128 v[84:87], v3 offset:25600
v_smfmac_f32_16x16x64_bf16 v[38:41], v[124:127], v[208:215], v2
ds_read_b128 v[46:49], v3 offset:20480
v_smfmac_f32_16x16x64_bf16 v[42:45], v[124:127], v[216:223], v2
ds_read_b128 v[50:53], v3 offset:21504
s_waitcnt lgkmcnt(8)
v_smfmac_f32_16x16x64_bf16 v[30:33], v[112:115], v[224:231], v2
ds_read_b128 v[64:67], v3 offset:28672
s_waitcnt lgkmcnt(8)
s_waitcnt lgkmcnt(5)
v_smfmac_f32_16x16x64_bf16 v[30:33], v[116:119], v[96:103], v2
ds_read_b128 v[68:71], v3 offset:29696
s_waitcnt lgkmcnt(4)
v_smfmac_f32_16x16x64_bf16 v[30:33], v[120:123], v[80:87], v2
ds_read_b128 v[54:57], v3 offset:22528
v_smfmac_f32_16x16x64_bf16 v[34:37], v[112:115], v[232:239], v2
ds_read_b128 v[58:61], v3 offset:23552
v_smfmac_f32_16x16x64_bf16 v[34:37], v[116:119], v[104:111], v2
ds_read_b128 v[72:75], v3 offset:30720
v_cvt_pk_bf16_f32 v96, v30, v31
v_cvt_pk_bf16_f32 v97, v32, v33
v_smfmac_f32_16x16x64_bf16 v[34:37], v[120:123], v[88:95], v2
ds_read_b128 v[76:79], v3 offset:31744
v_smfmac_f32_16x16x64_bf16 v[38:41], v[112:115], v[240:247], v2
s_waitcnt lgkmcnt(6)
v_smfmac_f32_16x16x64_bf16 v[38:41], v[116:119], v[46:53], v2
v_cvt_pk_bf16_f32 v98, v34, v35
v_cvt_pk_bf16_f32 v99, v36, v37
global_store_dwordx4 v11, v[96:99], s[64:65]
s_waitcnt lgkmcnt(4)
v_smfmac_f32_16x16x64_bf16 v[38:41], v[120:123], v[64:71], v2
v_smfmac_f32_16x16x64_bf16 v[42:45], v[112:115], v[248:255], v2
s_waitcnt lgkmcnt(2)
v_smfmac_f32_16x16x64_bf16 v[42:45], v[116:119], v[54:61], v2
v_cvt_pk_bf16_f32 v100, v38, v39
v_cvt_pk_bf16_f32 v101, v40, v41
s_waitcnt lgkmcnt(0)
v_smfmac_f32_16x16x64_bf16 v[42:45], v[120:123], v[72:79], v2
v_add_u32 v14, 0x10000, v14
v_add_u32 v15, 0x10000, v15
v_xor_b32 v7, 0x2000, v7
v_xor_b32 v8, 0x2000, v8
v_mov_b64 v[18:19], 0
v_mov_b64 v[20:21], 0
v_mov_b64 v[22:23], 0
v_mov_b64 v[24:25], 0
v_cvt_pk_bf16_f32 v102, v42, v43
v_cvt_pk_bf16_f32 v103, v44, v45
global_store_dwordx4 v11, v[100:103], s[66:67]
ds_read_b128 v[112:115], v3 offset:12288
ds_read_b128 v[116:119], v3 offset:13312
ds_read_b128 v[120:123], v3 offset:14336
ds_read_b128 v[124:127], v3 offset:15360
s_add_u32 s68, s36, s57
s_addc_u32 s69, s37, 0
s_add_u32 s68, s68, 6144
s_addc_u32 s69, s69, 0
s_add_u32 s74, s34, s55
s_addc_u32 s75, s35, 0
v_xor_b32 v11, 524288, v11
s_xor_b32 s55, s55, 524288
s_xor_b32 s59, s59, 0x2000
s_mov_b32 s56, s57
s_add_u32 s57, s57, 8704
s_cmp_eq_u32 s57, 26112
s_cselect_b32 s57, 0, s57
s_add_u32 s54, s54, 1
s_add_u32 s96, s96, 0x40000
s_addc_u32 s97, s97, 0
s_add_u32 s48, s48, 0x40000
s_addc_u32 s49, s49, 0
v_mov_b64 v[26:27], 0
v_mov_b64 v[28:29], 0
v_mov_b64 v[100:101], -1
v_mov_b64 v[102:103], -1
s_waitcnt vmcnt(0) lgkmcnt(0)
s_branch L_gat03
L_gret03:
global_load_dwordx4 v[104:107], v17, s[68:69] offset:0 sc1
global_load_dwordx4 v[108:111], v17, s[68:69] offset:1024 sc1
s_add_u32 s45, s45, 1
s_add_u32 s38, s38, 1
s_waitcnt vmcnt(1)
ds_write_b128 v1, v[104:107] offset:6144
v_max_u32 v62, v104, v106
s_waitcnt vmcnt(0)
ds_write_b128 v1, v[108:111] offset:7168
v_max3_u32 v62, v62, v108, v110
v_cmp_eq_u32 vcc, -1, v62
s_cbranch_vccz L_gok03
s_cmp_lt_u32 s45, 20000
s_cbranch_scc1 L_gret03
s_branch L_gok03
L_gat10:
s_barrier
global_load_dwordx4 v[104:107], v17, s[68:69] offset:0 sc1
global_load_dwordx4 v[108:111], v17, s[68:69] offset:1024 sc1
ds_read_b128 v[30:33], v7 offset:0
ds_read_b128 v[34:37], v7 offset:1024
ds_read_b128 v[38:41], v7 offset:2048
ds_read_b128 v[42:45], v7 offset:3072
ds_read_b128 v[46:49], v7 offset:4096
ds_read_b128 v[50:53], v7 offset:5120
ds_read_b128 v[54:57], v7 offset:6144
ds_read_b128 v[58:61], v7 offset:7168
s_mov_b32 s45, 0
s_waitcnt vmcnt(1)
ds_write_b128 v1, v[104:107] offset:0
v_max_u32 v62, v104, v106
s_waitcnt vmcnt(0)
ds_write_b128 v1, v[108:111] offset:1024
v_max3_u32 v62, v62, v108, v110
v_cmp_eq_u32 vcc, -1, v62
s_cbranch_vccnz L_gret10
L_gok10:
s_mov_b64 exec, s[60:61]
global_store_dwordx2 v12, v[100:101], s[82:83] sc1
s_mov_b64 exec, -1
L_pre10:
v_smfmac_f32_16x16x64_bf16 v[18:21], v[104:107], a[0:7], v2
v_smfmac_f32_16x16x64_bf16 v[22:25], v[104:107], a[8:15], v2
v_smfmac_f32_16x16x64_bf16 v[18:21], v[108:111], a[32:39], v2
s_waitcnt lgkmcnt(0)
L_step10:
s_barrier
ds_read_b128 v[96:99], v1 offset:2048
ds_read_b128 v[100:103], v1 offset:3072
v_smfmac_f32_16x16x64_bf16 v[26:29], v[104:107], v[112:119], v2
ds_read_b128 v[112:115], v3 offset:4096
global_load_lds_dwordx4 v0, s[48:49] sc1
v_smfmac_f32_16x16x64_bf16 v[26:29], v[108:111], v[120:127], v2
ds_read_b128 v[116:119], v3 offset:5120
v_smfmac_f32_16x16x64_bf16 v[22:25], v[108:111], a[40:47], v2
ds_read_b128 v[120:123], v3 offset:6144
global_load_lds_dwordx4 v0, s[48:49] offset:1024 sc1
s_waitcnt lgkmcnt(4)
v_smfmac_f32_16x16x64_bf16 v[18:21], v[96:99], a[64:71], v2
ds_read_b128 v[124:127], v3 offset:7168
s_xor_b32 m0, s59, 0x2000
v_smfmac_f32_16x16x64_bf16 v[22:25], v[96:99], a[72:79], v2
ds_read_b128 v[104:107], v1 offset:4096
global_load_lds_dwordx4 v0, s[96:97] sc1
s_waitcnt lgkmcnt(3)
v_smfmac_f32_16x16x64_bf16 v[26:29], v[96:99], v[112:119], v2
ds_read_b128 v[108:111], v1 offset:5120
v_smfmac_f32_16x16x64_bf16 v[18:21], v[100:103], a[96:103], v2
ds_read_b128 v[96:99], v1 offset:6144
global_load_lds_dwordx4 v0, s[96:97] offset:1024 sc1
v_smfmac_f32_16x16x64_bf16 v[22:25], v[100:103], a[104:111], v2
ds_read_b128 v[112:115], v3 offset:8192
s_waitcnt lgkmcnt(4)
v_smfmac_f32_16x16x64_bf16 v[26:29], v[100:103], v[120:127], v2
ds_read_b128 v[116:119], v3 offset:9216
s_waitcnt lgkmcnt(4)
v_smfmac_f32_16x16x64_bf16 v[18:21], v[104:107], a[128:135], v2
ds_read_b128 v[100:103], v1 offset:7168
v_smfmac_f32_16x16x64_bf16 v[22:25], v[104:107], a[136:143], v2
ds_read_b128 v[120:123], v3 offset:10240
v_mov_b32 v63, -1
s_waitcnt lgkmcnt(5)
v_smfmac_f32_16x16x64_bf16 v[18:21], v[108:111], a[160:167], v2
ds_read_b128 v[124:127], v3 offset:11264
v_smfmac_f32_16x16x64_bf16 v[22:25], v[108:111], a[168:175], v2
ds_read_b128 v[64:67], v13 offset:512
global_store_dword v0, v63, s[74:75] sc1
s_waitcnt lgkmcnt(6)
v_smfmac_f32_16x16x64_bf16 v[18:21], v[96:99], a[192:199], v2
ds_read_b128 v[68:71], v13 offset:1536
v_smfmac_f32_16x16x64_bf16 v[22:25], v[96:99], a[200:207], v2
ds_read_b128 v[72:75], v13 offset:2560
global_store_dword v0, v63, s[74:75] offset:1024 sc1
s_waitcnt lgkmcnt(5)
v_smfmac_f32_16x16x64_bf16 v[18:21], v[100:103], a[224:231], v2
ds_read_b128 v[76:79], v13 offset:3584
v_smfmac_f32_16x16x64_bf16 v[22:25], v[100:103], a[232:239], v2
ds_read_b128 v[80:83], v13 offset:4608
s_waitcnt lgkmcnt(4)
v_smfmac_f32_16x16x64_bf16 v[18:21], v[64:67], a[16:23], v2
ds_read_b128 v[84:87], v13 offset:5632
v_smfmac_f32_16x16x64_bf16 v[22:25], v[64:67], a[24:31], v2
ds_read_b128 v[88:91], v13 offset:6656
s_waitcnt lgkmcnt(5)
v_smfmac_f32_16x16x64_bf16 v[18:21], v[68:71], a[48:55], v2
ds_read_b128 v[92:95], v13 offset:7680
v_smfmac_f32_16x16x64_bf16 v[22:25], v[68:71], a[56:63], v2
s_waitcnt lgkmcnt(5)
v_smfmac_f32_16x16x64_bf16 v[18:21], v[72:75], a[80:87], v2
v_smfmac_f32_16x16x64_bf16 v[22:25], v[72:75], a[88:95], v2
s_waitcnt lgkmcnt(4)
v_smfmac_f32_16x16x64_bf16 v[18:21], v[76:79], a[112:119], v2
v_smfmac_f32_16x16x64_bf16 v[22:25], v[76:79], a[120:127], v2
s_waitcnt lgkmcnt(3)
v_smfmac_f32_16x16x64_bf16 v[18:21], v[80:83], a[144:151], v2
v_smfmac_f32_16x16x64_bf16 v[22:25], v[80:83], a[152:159], v2
s_waitcnt lgkmcnt(2)
v_smfmac_f32_16x16x64_bf16 v[18:21], v[84:87], a[176:183], v2
v_smfmac_f32_16x16x64_bf16 v[22:25], v[84:87], a[184:191], v2
s_waitcnt lgkmcnt(1)
v_smfmac_f32_16x16x64_bf16 v[18:21], v[88:91], a[208:215], v2
v_smfmac_f32_16x16x64_bf16 v[22:25], v[88:91], a[216:223], v2
s_waitcnt lgkmcnt(0)
v_smfmac_f32_16x16x64_bf16 v[18:21], v[92:95], a[240:247], v2
v_smfmac_f32_16x16x64_bf16 v[22:25], v[92:95], a[248:255], v2
v_smfmac_f32_16x16x64_bf16 v[26:29], v[80:83], v[160:167], v2
v_cvt_pk_bf16_f32 v18, v18, v19
v_cvt_pk_bf16_f32 v19, v20, v21
ds_write_b64 v4, v[18:19]
s_nop 0
v_cvt_pk_bf16_f32 v20, v22, v23
v_cvt_pk_bf16_f32 v21, v24, v25
ds_write_b64 v4, v[20:21] offset:32
v_smfmac_f32_16x16x64_bf16 v[26:29], v[84:87], v[168:175], v2
ds_read_b128 v[80:83], v3 offset:12288
v_smfmac_f32_16x16x64_bf16 v[26:29], v[88:91], v[176:183], v2
ds_read_b128 v[84:87], v3 offset:13312
v_smfmac_f32_16x16x64_bf16 v[26:29], v[92:95], v[184:191], v2
ds_read_b128 v[88:91], v3 offset:14336
v_smfmac_f32_16x16x64_bf16 v[26:29], v[64:67], v[128:135], v2
ds_read_b128 v[92:95], v3 offset:15360
v_smfmac_f32_16x16x64_bf16 v[26:29], v[68:71], v[136:143], v2
v_mov_b32 v22, v16
v_mov_b32 v23, v16
v_smfmac_f32_16x16x64_bf16 v[26:29], v[72:75], v[144:151], v2
v_mov_b32 v24, v16
v_mov_b32 v25, v16
v_smfmac_f32_16x16x64_bf16 v[26:29], v[76:79], v[152:159], v2
s_waitcnt lgkmcnt(4)
s_barrier
ds_read_b64_tr_b16 v[64:65], v5 offset:0
ds_read_b64_tr_b16 v[66:67], v5 offset:32
ds_read_b64_tr_b16 v[68:69], v5 offset:1536
ds_read_b64_tr_b16 v[70:71], v5 offset:1568
v_smfmac_f32_16x16x64_bf16 v[26:29], v[104:107], v[112:119], v2
ds_read_b64_tr_b16 v[72:73], v5 offset:3072
v_smfmac_f32_16x16x64_bf16 v[26:29], v[108:111], v[120:127], v2
ds_read_b64_tr_b16 v[74:75], v5 offset:3104
s_waitcnt lgkmcnt(8)
v_smfmac_f32_16x16x64_bf16 v[26:29], v[96:99], v[80:87], v2
ds_read_b64_tr_b16 v[76:77], v5 offset:4608
s_waitcnt lgkmcnt(7)
v_smfmac_f32_16x16x64_bf16 v[26:29], v[100:103], v[88:95], v2
ds_read_b64_tr_b16 v[78:79], v5 offset:4640
s_waitcnt lgkmcnt(6)
v_mfma_f32_16x16x32_bf16 v[22:25], v[64:67], v[64:67], v[22:25]
s_waitcnt lgkmcnt(4)
v_mfma_f32_16x16x32_bf16 v[22:25], v[68:71], v[68:71], v[22:25]
s_waitcnt lgkmcnt(2)
v_mfma_f32_16x16x32_bf16 v[22:25], v[72:75], v[72:75], v[22:25]
ds_read_b128 v[104:107], v3 offset:18432
s_waitcnt lgkmcnt(1)
v_mfma_f32_16x16x32_bf16 v[22:25], v[76:79], v[76:79], v[22:25]
ds_read_b128 v[108:111], v3 offset:19456
ds_read_b64_tr_b16 v[18:19], v6
v_mfma_f32_16x16x32_bf16 v[112:115], v[30:33], v[64:67], 0
v_cvt_pk_bf16_f32 v124, v26, v27
v_cvt_pk_bf16_f32 v125, v28, v29
v_mfma_f32_16x16x32_bf16 v[112:115], v[38:41], v[68:71], v[112:115]
v_cvt_pk_bf16_f32 v126, v26, v27
v_cvt_pk_bf16_f32 v127, v28, v29
v_mfma_f32_16x16x32_bf16 v[112:115], v[46:49], v[72:75], v[112:115]
ds_read_b128 v[88:91], v3 offset:26624
global_store_dwordx2 v15, v[124:125], s[72:73] sc1
v_mfma_f32_16x16x32_bf16 v[112:115], v[54:57], v[76:79], v[112:115]
ds_read_b128 v[92:95], v3 offset:27648
v_max3_f32 v62, v22, v23, v24
v_mfma_f32_16x16x32_bf16 v[116:119], v[34:37], v[64:67], 0
v_permlane32_swap_b32 v124, v126
v_permlane32_swap_b32 v125, v127
v_mfma_f32_16x16x32_bf16 v[116:119], v[42:45], v[68:71], v[116:119]
s_waitcnt lgkmcnt(2)
global_store_dwordx2 v14, v[18:19], s[70:71] sc1
v_mfma_f32_16x16x32_bf16 v[116:119], v[50:53], v[72:75], v[116:119]
v_max3_f32 v62, v62, v25, v112
v_max3_f32 v63, v113, v114, v115
v_mfma_f32_16x16x32_bf16 v[116:119], v[58:61], v[76:79], v[116:119]
v_max_f32 v62, v62, v63
s_cmp_eq_u32 s54, 63
s_cbranch_scc1 L_chain_end
v_mov_b64 v[26:27], s[42:43]
v_mov_b64 v[30:31], 0
v_mov_b64 v[32:33], 0
s_nop 1
v_max3_f32 v63, v116, v117, v118
v_max3_f32 v62, v62, v63, v119
v_mov_b32 v63, v62
v_mov_b64 v[34:35], 0
v_mov_b64 v[36:37], 0
v_permlane32_swap_b32 v62, v63
v_max_f32 v62, v62, v63
v_mov_b32 v63, v62
v_mov_b64 v[38:39], 0
v_mov_b64 v[28:29], s[42:43]
v_permlane16_swap_b32 v62, v63
v_max_f32 v62, v62, v63
v_mul_f32 v62, s88, v62
v_pk_fma_f32 v[112:113], v[112:113], s[88:89], v[62:63] op_sel_hi:[1,1,0] neg_lo:[0,0,1] neg_hi:[0,0,1]
v_pk_fma_f32 v[114:115], v[114:115], s[88:89], v[62:63] op_sel_hi:[1,1,0] neg_lo:[0,0,1] neg_hi:[0,0,1]
v_pk_fma_f32 v[116:117], v[116:117], s[88:89], v[62:63] op_sel_hi:[1,1,0] neg_lo:[0,0,1] neg_hi:[0,0,1]
v_pk_fma_f32 v[118:119], v[118:119], s[88:89], v[62:63] op_sel_hi:[1,1,0] neg_lo:[0,0,1] neg_hi:[0,0,1]
v_pk_fma_f32 v[22:23], v[22:23], s[88:89], v[62:63] op_sel_hi:[1,1,0] neg_lo:[0,0,1] neg_hi:[0,0,1]
v_pk_fma_f32 v[24:25], v[24:25], s[88:89], v[62:63] op_sel_hi:[1,1,0] neg_lo:[0,0,1] neg_hi:[0,0,1]
v_exp_f32 v112, v112
v_exp_f32 v113, v113
v_exp_f32 v114, v114
v_exp_f32 v115, v115
s_waitcnt vmcnt(6)
ds_read_b128 v[72:75], v8 offset:0
ds_read_b128 v[76:79], v8 offset:1024
v_exp_f32 v116, v116
v_exp_f32 v117, v117
v_cvt_pk_bf16_f32 v64, v112, v113
v_cvt_pk_bf16_f32 v65, v114, v115
v_exp_f32 v118, v118
v_exp_f32 v119, v119
v_cvt_pk_bf16_f32 v66, v116, v117
v_cvt_pk_bf16_f32 v67, v118, v119
s_waitcnt lgkmcnt(0)
v_exp_f32 v22, v22
v_mfma_f32_16x16x32_bf16 v[112:115], v[26:29], v[64:67], 0
v_exp_f32 v23, v23
v_mfma_f32_16x16x32_bf16 v[116:119], v[72:75], v[64:67], 0
v_exp_f32 v24, v24
v_mfma_f32_16x16x32_bf16 v[120:123], v[76:79], v[64:67], 0
v_exp_f32 v25, v25
v_cvt_pk_bf16_f32 v68, v22, v23
v_cvt_pk_bf16_f32 v69, v24, v25
s_nop 1
v_mfma_f32_16x16x16_bf16 v[112:115], v[26:27], v[68:69], v[112:115]
v_mfma_f32_16x16x16_bf16 v[116:119], v[124:125], v[68:69], v[116:119]
v_mfma_f32_16x16x16_bf16 v[120:123], v[126:127], v[68:69], v[120:123]
v_rcp_f32 v112, v112
v_mov_b64 v[40:41], 0
v_mov_b64 v[42:43], 0
v_mov_b64 v[44:45], 0
v_pk_mul_f32 v[116:117], v[116:117], v[112:113] op_sel_hi:[1,0]
v_pk_mul_f32 v[118:119], v[118:119], v[112:113] op_sel_hi:[1,0]
v_cvt_pk_bf16_f32 v124, v116, v117
v_cvt_pk_bf16_f32 v125, v118, v119
v_pk_mul_f32 v[120:121], v[120:121], v[112:113] op_sel_hi:[1,0]
v_pk_mul_f32 v[122:123], v[122:123], v[112:113] op_sel_hi:[1,0]
v_cvt_pk_bf16_f32 v126, v120, v121
v_cvt_pk_bf16_f32 v127, v122, v123
ds_write_b128 v9, v[124:127]
v_lshrrev_b32 v23, 2, v0
v_min_u32 v23, 124, v23
v_mov_b32_dpp v124, v124 row_shr:8 row_mask:0xf bank_mask:0xc
v_mov_b32_dpp v125, v125 row_shr:8 row_mask:0xf bank_mask:0xc
v_mov_b32_dpp v126, v126 row_shr:8 row_mask:0xf bank_mask:0xc
v_mov_b32_dpp v127, v127 row_shr:8 row_mask:0xf bank_mask:0xc
s_waitcnt vmcnt(2)
s_waitcnt lgkmcnt(0)
s_barrier
ds_read_b128 v[112:115], v10 offset:16
ds_read_b128 v[116:119], v10 offset:32
ds_read_b128 v[120:123], v10 offset:48
v_smfmac_f32_16x16x64_bf16 v[30:33], v[124:127], v[192:199], v2
ds_read_b128 v[96:99], v3 offset:16384
ds_read_b128 v[100:103], v3 offset:17408
v_smfmac_f32_16x16x64_bf16 v[34:37], v[124:127], v[200:207], v2
ds_read_b128 v[80:83], v3 offset:24576
ds_read_b128 v[84:87], v3 offset:25600
v_smfmac_f32_16x16x64_bf16 v[38:41], v[124:127], v[208:215], v2
ds_read_b128 v[46:49], v3 offset:20480
v_smfmac_f32_16x16x64_bf16 v[42:45], v[124:127], v[216:223], v2
ds_read_b128 v[50:53], v3 offset:21504
s_waitcnt lgkmcnt(8)
v_smfmac_f32_16x16x64_bf16 v[30:33], v[112:115], v[224:231], v2
global_load_dword v18, v23, s[40:41] sc1
ds_read_b128 v[64:67], v3 offset:28672
s_waitcnt lgkmcnt(8)
s_waitcnt lgkmcnt(5)
v_smfmac_f32_16x16x64_bf16 v[30:33], v[116:119], v[96:103], v2
ds_read_b128 v[68:71], v3 offset:29696
s_waitcnt lgkmcnt(4)
v_smfmac_f32_16x16x64_bf16 v[30:33], v[120:123], v[80:87], v2
ds_read_b128 v[54:57], v3 offset:22528
v_smfmac_f32_16x16x64_bf16 v[34:37], v[112:115], v[232:239], v2
global_load_dword v19, v23, s[40:41] sc1
ds_read_b128 v[58:61], v3 offset:23552
v_smfmac_f32_16x16x64_bf16 v[34:37], v[116:119], v[104:111], v2
ds_read_b128 v[72:75], v3 offset:30720
v_cvt_pk_bf16_f32 v96, v30, v31
v_cvt_pk_bf16_f32 v97, v32, v33
v_smfmac_f32_16x16x64_bf16 v[34:37], v[120:123], v[88:95], v2
ds_read_b128 v[76:79], v3 offset:31744
v_smfmac_f32_16x16x64_bf16 v[38:41], v[112:115], v[240:247], v2
global_load_dword v20, v23, s[40:41] sc1
s_waitcnt lgkmcnt(6)
v_smfmac_f32_16x16x64_bf16 v[38:41], v[116:119], v[46:53], v2
v_cvt_pk_bf16_f32 v98, v34, v35
v_cvt_pk_bf16_f32 v99, v36, v37
global_store_dwordx4 v11, v[96:99], s[64:65] sc1
s_waitcnt lgkmcnt(4)
v_smfmac_f32_16x16x64_bf16 v[38:41], v[120:123], v[64:71], v2
v_smfmac_f32_16x16x64_bf16 v[42:45], v[112:115], v[248:255], v2
global_load_dword v21, v23, s[40:41] sc1
s_waitcnt lgkmcnt(2)
v_smfmac_f32_16x16x64_bf16 v[42:45], v[116:119], v[54:61], v2
v_cvt_pk_bf16_f32 v100, v38, v39
v_cvt_pk_bf16_f32 v101, v40, v41
s_waitcnt lgkmcnt(0)
v_smfmac_f32_16x16x64_bf16 v[42:45], v[120:123], v[72:79], v2
v_add_u32 v14, 0x10000, v14
v_add_u32 v15, 0x10000, v15
v_xor_b32 v7, 0x2000, v7
v_xor_b32 v8, 0x2000, v8
s_nop 3
v_cvt_pk_bf16_f32 v102, v42, v43
v_cvt_pk_bf16_f32 v103, v44, v45
global_store_dwordx4 v11, v[100:103], s[66:67] sc1
v_and_b32 v63, 0xf0, v0
v_add_u32 v63, 162048, v63
ds_read_b128 v[100:103], v63
s_add_u32 s74, s34, s55
s_addc_u32 s75, s35, 0
s_add_u32 s78, s74, 4096
s_addc_u32 s79, s75, 0
s_add_u32 s44, s54, 1
global_load_dword v22, v23, s[40:41] sc1
s_nop 7
s_nop 7
s_nop 7
s_waitcnt vmcnt(6)
v_cmp_gt_u32 vcc, s44, v18
s_cbranch_vccz L_ogo10
global_load_dword v18, v23, s[40:41] sc1
s_nop 7
s_waitcnt vmcnt(6)
v_cmp_gt_u32 vcc, s44, v19
s_cbranch_vccz L_ogo10
global_load_dword v19, v23, s[40:41] sc1
s_nop 7
s_waitcnt vmcnt(6)
v_cmp_gt_u32 vcc, s44, v20
s_cbranch_vccz L_ogo10
global_load_dword v20, v23, s[40:41] sc1
s_nop 7
s_waitcnt vmcnt(5)
v_cmp_gt_u32 vcc, s44, v21
s_cbranch_vccz L_ogo10
global_load_dword v21, v23, s[40:41] sc1
s_nop 7
s_waitcnt vmcnt(4)
v_cmp_gt_u32 vcc, s44, v22
s_cbranch_vccz L_ogo10
global_load_dword v22, v23, s[40:41] sc1
s_nop 7
s_mov_b32 s45, 0
L_opoll10:
s_waitcnt vmcnt(4)
v_cmp_gt_u32 vcc, s44, v18
s_cbranch_vccz L_or10
global_load_dword v18, v23, s[40:41] sc1
s_nop 7
s_waitcnt vmcnt(4)
v_cmp_gt_u32 vcc, s44, v19
s_cbranch_vccz L_or10
global_load_dword v19, v23, s[40:41] sc1
s_nop 7
s_waitcnt vmcnt(4)
v_cmp_gt_u32 vcc, s44, v20
s_cbranch_vccz L_or10
global_load_dword v20, v23, s[40:41] sc1
s_nop 7
s_waitcnt vmcnt(4)
v_cmp_gt_u32 vcc, s44, v21
s_cbranch_vccz L_or10
global_load_dword v21, v23, s[40:41] sc1
s_nop 7
s_waitcnt vmcnt(4)
v_cmp_gt_u32 vcc, s44, v22
s_cbranch_vccz L_or10
global_load_dword v22, v23, s[40:41] sc1
s_nop 7
s_add_u32 s45, s45, 1
s_cmp_lt_u32 s45, 20000
s_cbranch_scc1 L_opoll10
L_or10:
L_ogo10:
global_load_dwordx4 v[64:67], v0, s[74:75] offset:0 sc1
global_load_dwordx4 v[68:71], v0, s[74:75] offset:1024 sc1
global_load_dwordx4 v[72:75], v0, s[74:75] offset:2048 sc1
global_load_dwordx4 v[76:79], v0, s[74:75] offset:3072 sc1
global_load_dwordx4 v[80:83], v0, s[78:79] offset:0 sc1
global_load_dwordx4 v[84:87], v0, s[78:79] offset:1024 sc1
global_load_dwordx4 v[88:91], v0, s[78:79] offset:2048 sc1
global_load_dwordx4 v[92:95], v0, s[78:79] offset:3072 sc1
s_add_u32 s80, s36, s57
s_addc_u32 s81, s37, 0
s_add_u32 s82, s36, s56
s_addc_u32 s83, s37, 0
s_add_u32 s68, s36, s57
s_addc_u32 s69, s37, 0
s_add_u32 s68, s68, 0
s_addc_u32 s69, s69, 0
ds_read_b128 v[112:115], v3 offset:0
ds_read_b128 v[116:119], v3 offset:1024
ds_read_b128 v[120:123], v3 offset:2048
ds_read_b128 v[124:127], v3 offset:3072
v_xor_b32 v11, 524288, v11
s_xor_b32 s55, s55, 524288
s_xor_b32 s59, s59, 0x2000
s_mov_b32 s56, s57
s_add_u32 s57, s57, 8704
s_cmp_eq_u32 s57, 26112
s_cselect_b32 s57, 0, s57
s_add_u32 s54, s54, 1
s_add_u32 s96, s96, 0x40000
s_addc_u32 s97, s97, 0
s_add_u32 s48, s48, 0x40000
s_addc_u32 s49, s49, 0
s_waitcnt lgkmcnt(0)
s_waitcnt vmcnt(7)
v_mfma_f32_16x16x32_bf16 v[96:99], v[64:67], v[100:103], 0
s_waitcnt vmcnt(6)
v_mfma_f32_16x16x32_bf16 v[96:99], v[68:71], v[100:103], v[96:99]
v_max_u32 v62, v64, v68
s_waitcnt vmcnt(5)
v_mfma_f32_16x16x32_bf16 v[96:99], v[72:75], v[100:103], v[96:99]
s_waitcnt vmcnt(4)
v_mfma_f32_16x16x32_bf16 v[96:99], v[76:79], v[100:103], v[96:99]
v_max3_u32 v62, v62, v72, v76
s_waitcnt vmcnt(3)
v_mfma_f32_16x16x32_bf16 v[96:99], v[80:83], v[100:103], v[96:99]
s_waitcnt vmcnt(2)
v_mfma_f32_16x16x32_bf16 v[96:99], v[84:87], v[100:103], v[96:99]
v_max3_u32 v62, v62, v80, v84
s_waitcnt vmcnt(1)
v_mfma_f32_16x16x32_bf16 v[96:99], v[88:91], v[100:103], v[96:99]
s_waitcnt vmcnt(0)
v_mfma_f32_16x16x32_bf16 v[96:99], v[92:95], v[100:103], v[96:99]
v_max3_u32 v62, v62, v88, v92
v_cmp_eq_u32 vcc, -1, v62
s_cbranch_vccnz L_rret10
L_rok10:
s_nop 4
v_cvt_pk_bf16_f32 v96, v96, v97
v_cvt_pk_bf16_f32 v97, v98, v99
s_mov_b64 exec, s[60:61]
global_store_dwordx2 v12, v[96:97], s[80:81] sc1
s_mov_b64 exec, -1
v_mov_b64 v[18:19], 0
v_mov_b64 v[20:21], 0
v_mov_b64 v[22:23], 0
v_mov_b64 v[24:25], 0
v_mov_b64 v[26:27], 0
v_mov_b64 v[28:29], 0
v_mov_b64 v[100:101], -1
v_mov_b64 v[102:103], -1
s_nop 7
s_nop 7
s_nop 7
s_nop 7
s_nop 3
s_branch L_gat10
L_gret10:
global_load_dwordx4 v[104:107], v17, s[68:69] offset:0 sc1
global_load_dwordx4 v[108:111], v17, s[68:69] offset:1024 sc1
s_add_u32 s45, s45, 1
s_add_u32 s38, s38, 1
s_waitcnt vmcnt(1)
ds_write_b128 v1, v[104:107] offset:0
v_max_u32 v62, v104, v106
s_waitcnt vmcnt(0)
ds_write_b128 v1, v[108:111] offset:1024
v_max3_u32 v62, v62, v108, v110
v_cmp_eq_u32 vcc, -1, v62
s_cbranch_vccz L_gok10
s_cmp_lt_u32 s45, 20000
s_cbranch_scc1 L_gret10
s_branch L_gok10
L_rret10:
s_mov_b32 s45, 0
L_rret210:
global_load_dwordx4 v[64:67], v0, s[74:75] offset:0 sc1
global_load_dwordx4 v[68:71], v0, s[74:75] offset:1024 sc1
global_load_dwordx4 v[72:75], v0, s[74:75] offset:2048 sc1
global_load_dwordx4 v[76:79], v0, s[74:75] offset:3072 sc1
global_load_dwordx4 v[80:83], v0, s[78:79] offset:0 sc1
global_load_dwordx4 v[84:87], v0, s[78:79] offset:1024 sc1
global_load_dwordx4 v[88:91], v0, s[78:79] offset:2048 sc1
global_load_dwordx4 v[92:95], v0, s[78:79] offset:3072 sc1
s_add_u32 s45, s45, 1
s_add_u32 s39, s39, 1
s_waitcnt vmcnt(7)
v_mfma_f32_16x16x32_bf16 v[96:99], v[64:67], v[100:103], 0
s_waitcnt vmcnt(6)
v_mfma_f32_16x16x32_bf16 v[96:99], v[68:71], v[100:103], v[96:99]
v_max_u32 v62, v64, v68
s_waitcnt vmcnt(5)
v_mfma_f32_16x16x32_bf16 v[96:99], v[72:75], v[100:103], v[96:99]
s_waitcnt vmcnt(4)
v_mfma_f32_16x16x32_bf16 v[96:99], v[76:79], v[100:103], v[96:99]
v_max3_u32 v62, v62, v72, v76
s_waitcnt vmcnt(3)
v_mfma_f32_16x16x32_bf16 v[96:99], v[80:83], v[100:103], v[96:99]
s_waitcnt vmcnt(2)
v_mfma_f32_16x16x32_bf16 v[96:99], v[84:87], v[100:103], v[96:99]
v_max3_u32 v62, v62, v80, v84
s_waitcnt vmcnt(1)
v_mfma_f32_16x16x32_bf16 v[96:99], v[88:91], v[100:103], v[96:99]
s_waitcnt vmcnt(0)
v_mfma_f32_16x16x32_bf16 v[96:99], v[92:95], v[100:103], v[96:99]
v_max3_u32 v62, v62, v88, v92
v_cmp_eq_u32 vcc, -1, v62
s_cbranch_vccz L_rok10
s_cmp_lt_u32 s45, 20000
s_cbranch_scc1 L_rret210
s_branch L_rok10
L_gat11:
s_barrier
global_load_dwordx4 v[104:107], v17, s[68:69] offset:0 sc1
global_load_dwordx4 v[108:111], v17, s[68:69] offset:1024 sc1
ds_read_b128 v[30:33], v7 offset:0
ds_read_b128 v[34:37], v7 offset:1024
ds_read_b128 v[38:41], v7 offset:2048
ds_read_b128 v[42:45], v7 offset:3072
ds_read_b128 v[46:49], v7 offset:4096
ds_read_b128 v[50:53], v7 offset:5120
ds_read_b128 v[54:57], v7 offset:6144
ds_read_b128 v[58:61], v7 offset:7168
s_mov_b32 s45, 0
s_waitcnt vmcnt(1)
ds_write_b128 v1, v[104:107] offset:2048
v_max_u32 v62, v104, v106
s_waitcnt vmcnt(0)
ds_write_b128 v1, v[108:111] offset:3072
v_max3_u32 v62, v62, v108, v110
v_cmp_eq_u32 vcc, -1, v62
s_cbranch_vccnz L_gret11
L_gok11:
L_pre11:
v_smfmac_f32_16x16x64_bf16 v[18:21], v[104:107], a[64:71], v2
v_smfmac_f32_16x16x64_bf16 v[22:25], v[104:107], a[72:79], v2
v_smfmac_f32_16x16x64_bf16 v[18:21], v[108:111], a[96:103], v2
s_waitcnt lgkmcnt(0)
L_step11:
s_barrier
ds_read_b128 v[96:99], v1 offset:4096
ds_read_b128 v[100:103], v1 offset:5120
v_smfmac_f32_16x16x64_bf16 v[26:29], v[104:107], v[112:119], v2
ds_read_b128 v[112:115], v3 offset:8192
global_load_lds_dwordx4 v0, s[48:49] sc1
v_smfmac_f32_16x16x64_bf16 v[26:29], v[108:111], v[120:127], v2
ds_read_b128 v[116:119], v3 offset:9216
v_smfmac_f32_16x16x64_bf16 v[22:25], v[108:111], a[104:111], v2
ds_read_b128 v[120:123], v3 offset:10240
global_load_lds_dwordx4 v0, s[48:49] offset:1024 sc1
s_waitcnt lgkmcnt(4)
v_smfmac_f32_16x16x64_bf16 v[18:21], v[96:99], a[128:135], v2
ds_read_b128 v[124:127], v3 offset:11264
s_xor_b32 m0, s59, 0x2000
v_smfmac_f32_16x16x64_bf16 v[22:25], v[96:99], a[136:143], v2
ds_read_b128 v[104:107], v1 offset:6144
global_load_lds_dwordx4 v0, s[96:97] sc1
s_waitcnt lgkmcnt(3)
v_smfmac_f32_16x16x64_bf16 v[26:29], v[96:99], v[112:119], v2
ds_read_b128 v[108:111], v1 offset:7168
v_smfmac_f32_16x16x64_bf16 v[18:21], v[100:103], a[160:167], v2
ds_read_b128 v[96:99], v1 offset:0
global_load_lds_dwordx4 v0, s[96:97] offset:1024 sc1
v_smfmac_f32_16x16x64_bf16 v[22:25], v[100:103], a[168:175], v2
ds_read_b128 v[112:115], v3 offset:12288
s_waitcnt lgkmcnt(4)
v_smfmac_f32_16x16x64_bf16 v[26:29], v[100:103], v[120:127], v2
ds_read_b128 v[116:119], v3 offset:13312
s_waitcnt lgkmcnt(4)
v_smfmac_f32_16x16x64_bf16 v[18:21], v[104:107], a[192:199], v2
ds_read_b128 v[100:103], v1 offset:1024
v_smfmac_f32_16x16x64_bf16 v[22:25], v[104:107], a[200:207], v2
ds_read_b128 v[120:123], v3 offset:14336
v_mov_b32 v63, -1
s_waitcnt lgkmcnt(5)
v_smfmac_f32_16x16x64_bf16 v[18:21], v[108:111], a[224:231], v2
ds_read_b128 v[124:127], v3 offset:15360
v_smfmac_f32_16x16x64_bf16 v[22:25], v[108:111], a[232:239], v2
ds_read_b128 v[64:67], v13 offset:512
global_store_dword v0, v63, s[74:75] sc1
s_waitcnt lgkmcnt(6)
v_smfmac_f32_16x16x64_bf16 v[18:21], v[96:99], a[0:7], v2
ds_read_b128 v[68:71], v13 offset:1536
v_smfmac_f32_16x16x64_bf16 v[22:25], v[96:99], a[8:15], v2
ds_read_b128 v[72:75], v13 offset:2560
global_store_dword v0, v63, s[74:75] offset:1024 sc1
s_waitcnt lgkmcnt(5)
v_smfmac_f32_16x16x64_bf16 v[18:21], v[100:103], a[32:39], v2
ds_read_b128 v[76:79], v13 offset:3584
v_smfmac_f32_16x16x64_bf16 v[22:25], v[100:103], a[40:47], v2
ds_read_b128 v[80:83], v13 offset:4608
s_waitcnt lgkmcnt(4)
v_smfmac_f32_16x16x64_bf16 v[18:21], v[64:67], a[16:23], v2
ds_read_b128 v[84:87], v13 offset:5632
v_smfmac_f32_16x16x64_bf16 v[22:25], v[64:67], a[24:31], v2
ds_read_b128 v[88:91], v13 offset:6656
s_waitcnt lgkmcnt(5)
v_smfmac_f32_16x16x64_bf16 v[18:21], v[68:71], a[48:55], v2
ds_read_b128 v[92:95], v13 offset:7680
v_smfmac_f32_16x16x64_bf16 v[22:25], v[68:71], a[56:63], v2
s_waitcnt lgkmcnt(5)
v_smfmac_f32_16x16x64_bf16 v[18:21], v[72:75], a[80:87], v2
v_smfmac_f32_16x16x64_bf16 v[22:25], v[72:75], a[88:95], v2
s_waitcnt lgkmcnt(4)
v_smfmac_f32_16x16x64_bf16 v[18:21], v[76:79], a[112:119], v2
v_smfmac_f32_16x16x64_bf16 v[22:25], v[76:79], a[120:127], v2
s_waitcnt lgkmcnt(3)
v_smfmac_f32_16x16x64_bf16 v[18:21], v[80:83], a[144:151], v2
v_smfmac_f32_16x16x64_bf16 v[22:25], v[80:83], a[152:159], v2
s_waitcnt lgkmcnt(2)
v_smfmac_f32_16x16x64_bf16 v[18:21], v[84:87], a[176:183], v2
v_smfmac_f32_16x16x64_bf16 v[22:25], v[84:87], a[184:191], v2
s_waitcnt lgkmcnt(1)
v_smfmac_f32_16x16x64_bf16 v[18:21], v[88:91], a[208:215], v2
v_smfmac_f32_16x16x64_bf16 v[22:25], v[88:91], a[216:223], v2
s_waitcnt lgkmcnt(0)
v_smfmac_f32_16x16x64_bf16 v[18:21], v[92:95], a[240:247], v2
v_smfmac_f32_16x16x64_bf16 v[22:25], v[92:95], a[248:255], v2
v_smfmac_f32_16x16x64_bf16 v[26:29], v[80:83], v[160:167], v2
v_cvt_pk_bf16_f32 v18, v18, v19
v_cvt_pk_bf16_f32 v19, v20, v21
ds_write_b64 v4, v[18:19]
s_nop 0
v_cvt_pk_bf16_f32 v20, v22, v23
v_cvt_pk_bf16_f32 v21, v24, v25
ds_write_b64 v4, v[20:21] offset:32
v_smfmac_f32_16x16x64_bf16 v[26:29], v[84:87], v[168:175], v2
ds_read_b128 v[80:83], v3 offset:0
v_smfmac_f32_16x16x64_bf16 v[26:29], v[88:91], v[176:183], v2
ds_read_b128 v[84:87], v3 offset:1024
v_smfmac_f32_16x16x64_bf16 v[26:29], v[92:95], v[184:191], v2
ds_read_b128 v[88:91], v3 offset:2048
v_smfmac_f32_16x16x64_bf16 v[26:29], v[64:67], v[128:135], v2
ds_read_b128 v[92:95], v3 offset:3072
v_smfmac_f32_16x16x64_bf16 v[26:29], v[68:71], v[136:143], v2
v_mov_b32 v22, v16
v_mov_b32 v23, v16
v_smfmac_f32_16x16x64_bf16 v[26:29], v[72:75], v[144:151], v2
v_mov_b32 v24, v16
v_mov_b32 v25, v16
v_smfmac_f32_16x16x64_bf16 v[26:29], v[76:79], v[152:159], v2
s_waitcnt lgkmcnt(4)
s_barrier
ds_read_b64_tr_b16 v[64:65], v5 offset:0
ds_read_b64_tr_b16 v[66:67], v5 offset:32
ds_read_b64_tr_b16 v[68:69], v5 offset:1536
ds_read_b64_tr_b16 v[70:71], v5 offset:1568
v_smfmac_f32_16x16x64_bf16 v[26:29], v[104:107], v[112:119], v2
ds_read_b64_tr_b16 v[72:73], v5 offset:3072
v_smfmac_f32_16x16x64_bf16 v[26:29], v[108:111], v[120:127], v2
ds_read_b64_tr_b16 v[74:75], v5 offset:3104
s_waitcnt lgkmcnt(8)
v_smfmac_f32_16x16x64_bf16 v[26:29], v[96:99], v[80:87], v2
ds_read_b64_tr_b16 v[76:77], v5 offset:4608
s_waitcnt lgkmcnt(7)
v_smfmac_f32_16x16x64_bf16 v[26:29], v[100:103], v[88:95], v2
ds_read_b64_tr_b16 v[78:79], v5 offset:4640
s_waitcnt lgkmcnt(6)
v_mfma_f32_16x16x32_bf16 v[22:25], v[64:67], v[64:67], v[22:25]
s_waitcnt lgkmcnt(4)
v_mfma_f32_16x16x32_bf16 v[22:25], v[68:71], v[68:71], v[22:25]
s_waitcnt lgkmcnt(2)
v_mfma_f32_16x16x32_bf16 v[22:25], v[72:75], v[72:75], v[22:25]
ds_read_b128 v[104:107], v3 offset:18432
s_waitcnt lgkmcnt(1)
v_mfma_f32_16x16x32_bf16 v[22:25], v[76:79], v[76:79], v[22:25]
ds_read_b128 v[108:111], v3 offset:19456
ds_read_b64_tr_b16 v[18:19], v6
v_mfma_f32_16x16x32_bf16 v[112:115], v[30:33], v[64:67], 0
v_cvt_pk_bf16_f32 v124, v26, v27
v_cvt_pk_bf16_f32 v125, v28, v29
v_mfma_f32_16x16x32_bf16 v[112:115], v[38:41], v[68:71], v[112:115]
v_cvt_pk_bf16_f32 v126, v26, v27
v_cvt_pk_bf16_f32 v127, v28, v29
v_mfma_f32_16x16x32_bf16 v[112:115], v[46:49], v[72:75], v[112:115]
ds_read_b128 v[88:91], v3 offset:26624
global_store_dwordx2 v15, v[124:125], s[72:73] sc1
v_mfma_f32_16x16x32_bf16 v[112:115], v[54:57], v[76:79], v[112:115]
ds_read_b128 v[92:95], v3 offset:27648
v_max3_f32 v62, v22, v23, v24
v_mfma_f32_16x16x32_bf16 v[116:119], v[34:37], v[64:67], 0
v_permlane32_swap_b32 v124, v126
v_permlane32_swap_b32 v125, v127
v_mfma_f32_16x16x32_bf16 v[116:119], v[42:45], v[68:71], v[116:119]
s_waitcnt lgkmcnt(2)
global_store_dwordx2 v14, v[18:19], s[70:71] sc1
v_mfma_f32_16x16x32_bf16 v[116:119], v[50:53], v[72:75], v[116:119]
v_max3_f32 v62, v62, v25, v112
v_max3_f32 v63, v113, v114, v115
v_mfma_f32_16x16x32_bf16 v[116:119], v[58:61], v[76:79], v[116:119]
v_max_f32 v62, v62, v63
s_cmp_eq_u32 s54, 63
s_cbranch_scc1 L_chain_end
v_mov_b64 v[26:27], s[42:43]
v_mov_b64 v[30:31], 0
v_mov_b64 v[32:33], 0
s_nop 1
v_max3_f32 v63, v116, v117, v118
v_max3_f32 v62, v62, v63, v119
v_mov_b32 v63, v62
v_mov_b64 v[34:35], 0
v_mov_b64 v[36:37], 0
v_permlane32_swap_b32 v62, v63
v_max_f32 v62, v62, v63
v_mov_b32 v63, v62
v_mov_b64 v[38:39], 0
v_mov_b64 v[28:29], s[42:43]
v_permlane16_swap_b32 v62, v63
v_max_f32 v62, v62, v63
v_mul_f32 v62, s88, v62
v_pk_fma_f32 v[112:113], v[112:113], s[88:89], v[62:63] op_sel_hi:[1,1,0] neg_lo:[0,0,1] neg_hi:[0,0,1]
v_pk_fma_f32 v[114:115], v[114:115], s[88:89], v[62:63] op_sel_hi:[1,1,0] neg_lo:[0,0,1] neg_hi:[0,0,1]
v_pk_fma_f32 v[116:117], v[116:117], s[88:89], v[62:63] op_sel_hi:[1,1,0] neg_lo:[0,0,1] neg_hi:[0,0,1]
v_pk_fma_f32 v[118:119], v[118:119], s[88:89], v[62:63] op_sel_hi:[1,1,0] neg_lo:[0,0,1] neg_hi:[0,0,1]
v_pk_fma_f32 v[22:23], v[22:23], s[88:89], v[62:63] op_sel_hi:[1,1,0] neg_lo:[0,0,1] neg_hi:[0,0,1]
v_pk_fma_f32 v[24:25], v[24:25], s[88:89], v[62:63] op_sel_hi:[1,1,0] neg_lo:[0,0,1] neg_hi:[0,0,1]
v_exp_f32 v112, v112
v_exp_f32 v113, v113
v_exp_f32 v114, v114
v_exp_f32 v115, v115
s_waitcnt vmcnt(6)
ds_read_b128 v[72:75], v8 offset:0
ds_read_b128 v[76:79], v8 offset:1024
v_exp_f32 v116, v116
v_exp_f32 v117, v117
v_cvt_pk_bf16_f32 v64, v112, v113
v_cvt_pk_bf16_f32 v65, v114, v115
v_exp_f32 v118, v118
v_exp_f32 v119, v119
v_cvt_pk_bf16_f32 v66, v116, v117
v_cvt_pk_bf16_f32 v67, v118, v119
s_waitcnt lgkmcnt(0)
v_exp_f32 v22, v22
v_mfma_f32_16x16x32_bf16 v[112:115], v[26:29], v[64:67], 0
v_exp_f32 v23, v23
v_mfma_f32_16x16x32_bf16 v[116:119], v[72:75], v[64:67], 0
v_exp_f32 v24, v24
v_mfma_f32_16x16x32_bf16 v[120:123], v[76:79], v[64:67], 0
v_exp_f32 v25, v25
v_cvt_pk_bf16_f32 v68, v22, v23
v_cvt_pk_bf16_f32 v69, v24, v25
s_nop 1
v_mfma_f32_16x16x16_bf16 v[112:115], v[26:27], v[68:69], v[112:115]
v_mfma_f32_16x16x16_bf16 v[116:119], v[124:125], v[68:69], v[116:119]
v_mfma_f32_16x16x16_bf16 v[120:123], v[126:127], v[68:69], v[120:123]
v_rcp_f32 v112, v112
v_mov_b64 v[40:41], 0
v_mov_b64 v[42:43], 0
v_mov_b64 v[44:45], 0
v_pk_mul_f32 v[116:117], v[116:117], v[112:113] op_sel_hi:[1,0]
v_pk_mul_f32 v[118:119], v[118:119], v[112:113] op_sel_hi:[1,0]
v_cvt_pk_bf16_f32 v124, v116, v117
v_cvt_pk_bf16_f32 v125, v118, v119
v_pk_mul_f32 v[120:121], v[120:121], v[112:113] op_sel_hi:[1,0]
v_pk_mul_f32 v[122:123], v[122:123], v[112:113] op_sel_hi:[1,0]
v_cvt_pk_bf16_f32 v126, v120, v121
v_cvt_pk_bf16_f32 v127, v122, v123
ds_write_b128 v9, v[124:127]
v_mov_b32_dpp v124, v124 row_shr:8 row_mask:0xf bank_mask:0xc
v_mov_b32_dpp v125, v125 row_shr:8 row_mask:0xf bank_mask:0xc
v_mov_b32_dpp v126, v126 row_shr:8 row_mask:0xf bank_mask:0xc
v_mov_b32_dpp v127, v127 row_shr:8 row_mask:0xf bank_mask:0xc
s_waitcnt vmcnt(2)
s_waitcnt lgkmcnt(0)
s_barrier
ds_read_b128 v[112:115], v10 offset:32
ds_read_b128 v[116:119], v10 offset:48
ds_read_b128 v[120:123], v10 offset:0
v_smfmac_f32_16x16x64_bf16 v[30:33], v[124:127], v[192:199], v2
ds_read_b128 v[96:99], v3 offset:16384
ds_read_b128 v[100:103], v3 offset:17408
v_smfmac_f32_16x16x64_bf16 v[34:37], v[124:127], v[200:207], v2
ds_read_b128 v[80:83], v3 offset:24576
ds_read_b128 v[84:87], v3 offset:25600
v_smfmac_f32_16x16x64_bf16 v[38:41], v[124:127], v[208:215], v2
ds_read_b128 v[46:49], v3 offset:20480
v_smfmac_f32_16x16x64_bf16 v[42:45], v[124:127], v[216:223], v2
ds_read_b128 v[50:53], v3 offset:21504
s_waitcnt lgkmcnt(8)
v_smfmac_f32_16x16x64_bf16 v[30:33], v[112:115], v[224:231], v2
ds_read_b128 v[64:67], v3 offset:28672
s_waitcnt lgkmcnt(8)
s_waitcnt lgkmcnt(5)
v_smfmac_f32_16x16x64_bf16 v[30:33], v[116:119], v[96:103], v2
ds_read_b128 v[68:71], v3 offset:29696
s_waitcnt lgkmcnt(4)
v_smfmac_f32_16x16x64_bf16 v[30:33], v[120:123], v[80:87], v2
ds_read_b128 v[54:57], v3 offset:22528
v_smfmac_f32_16x16x64_bf16 v[34:37], v[112:115], v[232:239], v2
ds_read_b128 v[58:61], v3 offset:23552
v_smfmac_f32_16x16x64_bf16 v[34:37], v[116:119], v[104:111], v2
ds_read_b128 v[72:75], v3 offset:30720
v_cvt_pk_bf16_f32 v96, v30, v31
v_cvt_pk_bf16_f32 v97, v32, v33
v_smfmac_f32_16x16x64_bf16 v[34:37], v[120:123], v[88:95], v2
ds_read_b128 v[76:79], v3 offset:31744
v_smfmac_f32_16x16x64_bf16 v[38:41], v[112:115], v[240:247], v2
s_waitcnt lgkmcnt(6)
v_smfmac_f32_16x16x64_bf16 v[38:41], v[116:119], v[46:53], v2
v_cvt_pk_bf16_f32 v98, v34, v35
v_cvt_pk_bf16_f32 v99, v36, v37
global_store_dwordx4 v11, v[96:99], s[64:65] sc1
s_waitcnt lgkmcnt(4)
v_smfmac_f32_16x16x64_bf16 v[38:41], v[120:123], v[64:71], v2
v_smfmac_f32_16x16x64_bf16 v[42:45], v[112:115], v[248:255], v2
s_waitcnt lgkmcnt(2)
v_smfmac_f32_16x16x64_bf16 v[42:45], v[116:119], v[54:61], v2
v_cvt_pk_bf16_f32 v100, v38, v39
v_cvt_pk_bf16_f32 v101, v40, v41
s_waitcnt lgkmcnt(0)
v_smfmac_f32_16x16x64_bf16 v[42:45], v[120:123], v[72:79], v2
v_add_u32 v14, 0x10000, v14
v_add_u32 v15, 0x10000, v15
v_xor_b32 v7, 0x2000, v7
v_xor_b32 v8, 0x2000, v8
v_mov_b64 v[18:19], 0
v_mov_b64 v[20:21], 0
v_mov_b64 v[22:23], 0
v_mov_b64 v[24:25], 0
v_cvt_pk_bf16_f32 v102, v42, v43
v_cvt_pk_bf16_f32 v103, v44, v45
global_store_dwordx4 v11, v[100:103], s[66:67] sc1
ds_read_b128 v[112:115], v3 offset:4096
ds_read_b128 v[116:119], v3 offset:5120
ds_read_b128 v[120:123], v3 offset:6144
ds_read_b128 v[124:127], v3 offset:7168
s_add_u32 s68, s36, s57
s_addc_u32 s69, s37, 0
s_add_u32 s68, s68, 2048
s_addc_u32 s69, s69, 0
s_add_u32 s74, s34, s55
s_addc_u32 s75, s35, 0
v_xor_b32 v11, 524288, v11
s_xor_b32 s55, s55, 524288
s_xor_b32 s59, s59, 0x2000
s_mov_b32 s56, s57
s_add_u32 s57, s57, 8704
s_cmp_eq_u32 s57, 26112
s_cselect_b32 s57, 0, s57
s_add_u32 s54, s54, 1
s_add_u32 s96, s96, 0x40000
s_addc_u32 s97, s97, 0
s_add_u32 s48, s48, 0x40000
s_addc_u32 s49, s49, 0
v_mov_b64 v[26:27], 0
v_mov_b64 v[28:29], 0
v_mov_b64 v[100:101], -1
v_mov_b64 v[102:103], -1
s_waitcnt vmcnt(0) lgkmcnt(0)
s_branch L_gat11
L_gret11:
global_load_dwordx4 v[104:107], v17, s[68:69] offset:0 sc1
global_load_dwordx4 v[108:111], v17, s[68:69] offset:1024 sc1
s_add_u32 s45, s45, 1
s_add_u32 s38, s38, 1
s_waitcnt vmcnt(1)
ds_write_b128 v1, v[104:107] offset:2048
v_max_u32 v62, v104, v106
s_waitcnt vmcnt(0)
ds_write_b128 v1, v[108:111] offset:3072
v_max3_u32 v62, v62, v108, v110
v_cmp_eq_u32 vcc, -1, v62
s_cbranch_vccz L_gok11
s_cmp_lt_u32 s45, 20000
s_cbranch_scc1 L_gret11
s_branch L_gok11
L_gat12:
s_barrier
global_load_dwordx4 v[104:107], v17, s[68:69] offset:0 sc1
global_load_dwordx4 v[108:111], v17, s[68:69] offset:1024 sc1
ds_read_b128 v[30:33], v7 offset:0
ds_read_b128 v[34:37], v7 offset:1024
ds_read_b128 v[38:41], v7 offset:2048
ds_read_b128 v[42:45], v7 offset:3072
ds_read_b128 v[46:49], v7 offset:4096
ds_read_b128 v[50:53], v7 offset:5120
ds_read_b128 v[54:57], v7 offset:6144
ds_read_b128 v[58:61], v7 offset:7168
s_mov_b32 s45, 0
s_waitcnt vmcnt(1)
ds_write_b128 v1, v[104:107] offset:4096
v_max_u32 v62, v104, v106
s_waitcnt vmcnt(0)
ds_write_b128 v1, v[108:111] offset:5120
v_max3_u32 v62, v62, v108, v110
v_cmp_eq_u32 vcc, -1, v62
s_cbranch_vccnz L_gret12
L_gok12:
L_pre12:
v_smfmac_f32_16x16x64_bf16 v[18:21], v[104:107], a[128:135], v2
v_smfmac_f32_16x16x64_bf16 v[22:25], v[104:107], a[136:143], v2
v_smfmac_f32_16x16x64_bf16 v[18:21], v[108:111], a[160:167], v2
s_waitcnt lgkmcnt(0)
L_step12:
s_barrier
ds_read_b128 v[96:99], v1 offset:6144
ds_read_b128 v[100:103], v1 offset:7168
v_smfmac_f32_16x16x64_bf16 v[26:29], v[104:107], v[112:119], v2
ds_read_b128 v[112:115], v3 offset:12288
global_load_lds_dwordx4 v0, s[48:49] sc1
v_smfmac_f32_16x16x64_bf16 v[26:29], v[108:111], v[120:127], v2
ds_read_b128 v[116:119], v3 offset:13312
v_smfmac_f32_16x16x64_bf16 v[22:25], v[108:111], a[168:175], v2
ds_read_b128 v[120:123], v3 offset:14336
global_load_lds_dwordx4 v0, s[48:49] offset:1024 sc1
s_waitcnt lgkmcnt(4)
v_smfmac_f32_16x16x64_bf16 v[18:21], v[96:99], a[192:199], v2
ds_read_b128 v[124:127], v3 offset:15360
s_xor_b32 m0, s59, 0x2000
v_smfmac_f32_16x16x64_bf16 v[22:25], v[96:99], a[200:207], v2
ds_read_b128 v[104:107], v1 offset:0
global_load_lds_dwordx4 v0, s[96:97] sc1
s_waitcnt lgkmcnt(3)
v_smfmac_f32_16x16x64_bf16 v[26:29], v[96:99], v[112:119], v2
ds_read_b128 v[108:111], v1 offset:1024
v_smfmac_f32_16x16x64_bf16 v[18:21], v[100:103], a[224:231], v2
ds_read_b128 v[96:99], v1 offset:2048
global_load_lds_dwordx4 v0, s[96:97] offset:1024 sc1
v_smfmac_f32_16x16x64_bf16 v[22:25], v[100:103], a[232:239], v2
ds_read_b128 v[112:115], v3 offset:0
s_waitcnt lgkmcnt(4)
v_smfmac_f32_16x16x64_bf16 v[26:29], v[100:103], v[120:127], v2
ds_read_b128 v[116:119], v3 offset:1024
s_waitcnt lgkmcnt(4)
v_smfmac_f32_16x16x64_bf16 v[18:21], v[104:107], a[0:7], v2
ds_read_b128 v[100:103], v1 offset:3072
v_smfmac_f32_16x16x64_bf16 v[22:25], v[104:107], a[8:15], v2
ds_read_b128 v[120:123], v3 offset:2048
v_mov_b32 v63, -1
s_waitcnt lgkmcnt(5)
v_smfmac_f32_16x16x64_bf16 v[18:21], v[108:111], a[32:39], v2
ds_read_b128 v[124:127], v3 offset:3072
v_smfmac_f32_16x16x64_bf16 v[22:25], v[108:111], a[40:47], v2
ds_read_b128 v[64:67], v13 offset:512
global_store_dword v0, v63, s[74:75] sc1
s_waitcnt lgkmcnt(6)
v_smfmac_f32_16x16x64_bf16 v[18:21], v[96:99], a[64:71], v2
ds_read_b128 v[68:71], v13 offset:1536
v_smfmac_f32_16x16x64_bf16 v[22:25], v[96:99], a[72:79], v2
ds_read_b128 v[72:75], v13 offset:2560
global_store_dword v0, v63, s[74:75] offset:1024 sc1
s_waitcnt lgkmcnt(5)
v_smfmac_f32_16x16x64_bf16 v[18:21], v[100:103], a[96:103], v2
ds_read_b128 v[76:79], v13 offset:3584
v_smfmac_f32_16x16x64_bf16 v[22:25], v[100:103], a[104:111], v2
ds_read_b128 v[80:83], v13 offset:4608
s_waitcnt lgkmcnt(4)
v_smfmac_f32_16x16x64_bf16 v[18:21], v[64:67], a[16:23], v2
ds_read_b128 v[84:87], v13 offset:5632
v_smfmac_f32_16x16x64_bf16 v[22:25], v[64:67], a[24:31], v2
ds_read_b128 v[88:91], v13 offset:6656
s_waitcnt lgkmcnt(5)
v_smfmac_f32_16x16x64_bf16 v[18:21], v[68:71], a[48:55], v2
ds_read_b128 v[92:95], v13 offset:7680
v_smfmac_f32_16x16x64_bf16 v[22:25], v[68:71], a[56:63], v2
s_waitcnt lgkmcnt(5)
v_smfmac_f32_16x16x64_bf16 v[18:21], v[72:75], a[80:87], v2
v_smfmac_f32_16x16x64_bf16 v[22:25], v[72:75], a[88:95], v2
s_waitcnt lgkmcnt(4)
v_smfmac_f32_16x16x64_bf16 v[18:21], v[76:79], a[112:119], v2
v_smfmac_f32_16x16x64_bf16 v[22:25], v[76:79], a[120:127], v2
s_waitcnt lgkmcnt(3)
v_smfmac_f32_16x16x64_bf16 v[18:21], v[80:83], a[144:151], v2
v_smfmac_f32_16x16x64_bf16 v[22:25], v[80:83], a[152:159], v2
s_waitcnt lgkmcnt(2)
v_smfmac_f32_16x16x64_bf16 v[18:21], v[84:87], a[176:183], v2
v_smfmac_f32_16x16x64_bf16 v[22:25], v[84:87], a[184:191], v2
s_waitcnt lgkmcnt(1)
v_smfmac_f32_16x16x64_bf16 v[18:21], v[88:91], a[208:215], v2
v_smfmac_f32_16x16x64_bf16 v[22:25], v[88:91], a[216:223], v2
s_waitcnt lgkmcnt(0)
v_smfmac_f32_16x16x64_bf16 v[18:21], v[92:95], a[240:247], v2
v_smfmac_f32_16x16x64_bf16 v[22:25], v[92:95], a[248:255], v2
v_smfmac_f32_16x16x64_bf16 v[26:29], v[80:83], v[160:167], v2
v_cvt_pk_bf16_f32 v18, v18, v19
v_cvt_pk_bf16_f32 v19, v20, v21
ds_write_b64 v4, v[18:19]
s_nop 0
v_cvt_pk_bf16_f32 v20, v22, v23
v_cvt_pk_bf16_f32 v21, v24, v25
ds_write_b64 v4, v[20:21] offset:32
v_smfmac_f32_16x16x64_bf16 v[26:29], v[84:87], v[168:175], v2
ds_read_b128 v[80:83], v3 offset:4096
v_smfmac_f32_16x16x64_bf16 v[26:29], v[88:91], v[176:183], v2
ds_read_b128 v[84:87], v3 offset:5120
v_smfmac_f32_16x16x64_bf16 v[26:29], v[92:95], v[184:191], v2
ds_read_b128 v[88:91], v3 offset:6144
v_smfmac_f32_16x16x64_bf16 v[26:29], v[64:67], v[128:135], v2
ds_read_b128 v[92:95], v3 offset:7168
v_smfmac_f32_16x16x64_bf16 v[26:29], v[68:71], v[136:143], v2
v_mov_b32 v22, v16
v_mov_b32 v23, v16
v_smfmac_f32_16x16x64_bf16 v[26:29], v[72:75], v[144:151], v2
v_mov_b32 v24, v16
v_mov_b32 v25, v16
v_smfmac_f32_16x16x64_bf16 v[26:29], v[76:79], v[152:159], v2
s_waitcnt lgkmcnt(4)
s_barrier
ds_read_b64_tr_b16 v[64:65], v5 offset:0
ds_read_b64_tr_b16 v[66:67], v5 offset:32
ds_read_b64_tr_b16 v[68:69], v5 offset:1536
ds_read_b64_tr_b16 v[70:71], v5 offset:1568
v_smfmac_f32_16x16x64_bf16 v[26:29], v[104:107], v[112:119], v2
ds_read_b64_tr_b16 v[72:73], v5 offset:3072
v_smfmac_f32_16x16x64_bf16 v[26:29], v[108:111], v[120:127], v2
ds_read_b64_tr_b16 v[74:75], v5 offset:3104
s_waitcnt lgkmcnt(8)
v_smfmac_f32_16x16x64_bf16 v[26:29], v[96:99], v[80:87], v2
ds_read_b64_tr_b16 v[76:77], v5 offset:4608
s_waitcnt lgkmcnt(7)
v_smfmac_f32_16x16x64_bf16 v[26:29], v[100:103], v[88:95], v2
ds_read_b64_tr_b16 v[78:79], v5 offset:4640
s_waitcnt lgkmcnt(6)
v_mfma_f32_16x16x32_bf16 v[22:25], v[64:67], v[64:67], v[22:25]
s_waitcnt lgkmcnt(4)
v_mfma_f32_16x16x32_bf16 v[22:25], v[68:71], v[68:71], v[22:25]
s_waitcnt lgkmcnt(2)
v_mfma_f32_16x16x32_bf16 v[22:25], v[72:75], v[72:75], v[22:25]
ds_read_b128 v[104:107], v3 offset:18432
s_waitcnt lgkmcnt(1)
v_mfma_f32_16x16x32_bf16 v[22:25], v[76:79], v[76:79], v[22:25]
ds_read_b128 v[108:111], v3 offset:19456
ds_read_b64_tr_b16 v[18:19], v6
v_mfma_f32_16x16x32_bf16 v[112:115], v[30:33], v[64:67], 0
v_cvt_pk_bf16_f32 v124, v26, v27
v_cvt_pk_bf16_f32 v125, v28, v29
v_mfma_f32_16x16x32_bf16 v[112:115], v[38:41], v[68:71], v[112:115]
v_cvt_pk_bf16_f32 v126, v26, v27
v_cvt_pk_bf16_f32 v127, v28, v29
v_mfma_f32_16x16x32_bf16 v[112:115], v[46:49], v[72:75], v[112:115]
ds_read_b128 v[88:91], v3 offset:26624
global_store_dwordx2 v15, v[124:125], s[72:73] sc1
v_mfma_f32_16x16x32_bf16 v[112:115], v[54:57], v[76:79], v[112:115]
ds_read_b128 v[92:95], v3 offset:27648
v_max3_f32 v62, v22, v23, v24
v_mfma_f32_16x16x32_bf16 v[116:119], v[34:37], v[64:67], 0
v_permlane32_swap_b32 v124, v126
v_permlane32_swap_b32 v125, v127
v_mfma_f32_16x16x32_bf16 v[116:119], v[42:45], v[68:71], v[116:119]
s_waitcnt lgkmcnt(2)
global_store_dwordx2 v14, v[18:19], s[70:71] sc1
v_mfma_f32_16x16x32_bf16 v[116:119], v[50:53], v[72:75], v[116:119]
v_max3_f32 v62, v62, v25, v112
v_max3_f32 v63, v113, v114, v115
v_mfma_f32_16x16x32_bf16 v[116:119], v[58:61], v[76:79], v[116:119]
v_max_f32 v62, v62, v63
s_cmp_eq_u32 s54, 63
s_cbranch_scc1 L_chain_end
v_mov_b64 v[26:27], s[42:43]
v_mov_b64 v[30:31], 0
v_mov_b64 v[32:33], 0
s_nop 1
v_max3_f32 v63, v116, v117, v118
v_max3_f32 v62, v62, v63, v119
v_mov_b32 v63, v62
v_mov_b64 v[34:35], 0
v_mov_b64 v[36:37], 0
v_permlane32_swap_b32 v62, v63
v_max_f32 v62, v62, v63
v_mov_b32 v63, v62
v_mov_b64 v[38:39], 0
v_mov_b64 v[28:29], s[42:43]
v_permlane16_swap_b32 v62, v63
v_max_f32 v62, v62, v63
v_mul_f32 v62, s88, v62
v_pk_fma_f32 v[112:113], v[112:113], s[88:89], v[62:63] op_sel_hi:[1,1,0] neg_lo:[0,0,1] neg_hi:[0,0,1]
v_pk_fma_f32 v[114:115], v[114:115], s[88:89], v[62:63] op_sel_hi:[1,1,0] neg_lo:[0,0,1] neg_hi:[0,0,1]
v_pk_fma_f32 v[116:117], v[116:117], s[88:89], v[62:63] op_sel_hi:[1,1,0] neg_lo:[0,0,1] neg_hi:[0,0,1]
v_pk_fma_f32 v[118:119], v[118:119], s[88:89], v[62:63] op_sel_hi:[1,1,0] neg_lo:[0,0,1] neg_hi:[0,0,1]
v_pk_fma_f32 v[22:23], v[22:23], s[88:89], v[62:63] op_sel_hi:[1,1,0] neg_lo:[0,0,1] neg_hi:[0,0,1]
v_pk_fma_f32 v[24:25], v[24:25], s[88:89], v[62:63] op_sel_hi:[1,1,0] neg_lo:[0,0,1] neg_hi:[0,0,1]
v_exp_f32 v112, v112
v_exp_f32 v113, v113
v_exp_f32 v114, v114
v_exp_f32 v115, v115
s_waitcnt vmcnt(6)
ds_read_b128 v[72:75], v8 offset:0
ds_read_b128 v[76:79], v8 offset:1024
v_exp_f32 v116, v116
v_exp_f32 v117, v117
v_cvt_pk_bf16_f32 v64, v112, v113
v_cvt_pk_bf16_f32 v65, v114, v115
v_exp_f32 v118, v118
v_exp_f32 v119, v119
v_cvt_pk_bf16_f32 v66, v116, v117
v_cvt_pk_bf16_f32 v67, v118, v119
s_waitcnt lgkmcnt(0)
v_exp_f32 v22, v22
v_mfma_f32_16x16x32_bf16 v[112:115], v[26:29], v[64:67], 0
v_exp_f32 v23, v23
v_mfma_f32_16x16x32_bf16 v[116:119], v[72:75], v[64:67], 0
v_exp_f32 v24, v24
v_mfma_f32_16x16x32_bf16 v[120:123], v[76:79], v[64:67], 0
v_exp_f32 v25, v25
v_cvt_pk_bf16_f32 v68, v22, v23
v_cvt_pk_bf16_f32 v69, v24, v25
s_nop 1
v_mfma_f32_16x16x16_bf16 v[112:115], v[26:27], v[68:69], v[112:115]
v_mfma_f32_16x16x16_bf16 v[116:119], v[124:125], v[68:69], v[116:119]
v_mfma_f32_16x16x16_bf16 v[120:123], v[126:127], v[68:69], v[120:123]
v_rcp_f32 v112, v112
v_mov_b64 v[40:41], 0
v_mov_b64 v[42:43], 0
v_mov_b64 v[44:45], 0
v_pk_mul_f32 v[116:117], v[116:117], v[112:113] op_sel_hi:[1,0]
v_pk_mul_f32 v[118:119], v[118:119], v[112:113] op_sel_hi:[1,0]
v_cvt_pk_bf16_f32 v124, v116, v117
v_cvt_pk_bf16_f32 v125, v118, v119
v_pk_mul_f32 v[120:121], v[120:121], v[112:113] op_sel_hi:[1,0]
v_pk_mul_f32 v[122:123], v[122:123], v[112:113] op_sel_hi:[1,0]
v_cvt_pk_bf16_f32 v126, v120, v121
v_cvt_pk_bf16_f32 v127, v122, v123
ds_write_b128 v9, v[124:127]
v_mov_b32_dpp v124, v124 row_shr:8 row_mask:0xf bank_mask:0xc
v_mov_b32_dpp v125, v125 row_shr:8 row_mask:0xf bank_mask:0xc
v_mov_b32_dpp v126, v126 row_shr:8 row_mask:0xf bank_mask:0xc
v_mov_b32_dpp v127, v127 row_shr:8 row_mask:0xf bank_mask:0xc
s_waitcnt vmcnt(2)
s_waitcnt lgkmcnt(0)
s_barrier
ds_read_b128 v[112:115], v10 offset:48
ds_read_b128 v[116:119], v10 offset:0
ds_read_b128 v[120:123], v10 offset:16
v_smfmac_f32_16x16x64_bf16 v[30:33], v[124:127], v[192:199], v2
ds_read_b128 v[96:99], v3 offset:16384
ds_read_b128 v[100:103], v3 offset:17408
v_smfmac_f32_16x16x64_bf16 v[34:37], v[124:127], v[200:207], v2
ds_read_b128 v[80:83], v3 offset:24576
ds_read_b128 v[84:87], v3 offset:25600
v_smfmac_f32_16x16x64_bf16 v[38:41], v[124:127], v[208:215], v2
ds_read_b128 v[46:49], v3 offset:20480
v_smfmac_f32_16x16x64_bf16 v[42:45], v[124:127], v[216:223], v2
ds_read_b128 v[50:53], v3 offset:21504
s_waitcnt lgkmcnt(8)
v_smfmac_f32_16x16x64_bf16 v[30:33], v[112:115], v[224:231], v2
ds_read_b128 v[64:67], v3 offset:28672
s_waitcnt lgkmcnt(8)
s_waitcnt lgkmcnt(5)
v_smfmac_f32_16x16x64_bf16 v[30:33], v[116:119], v[96:103], v2
ds_read_b128 v[68:71], v3 offset:29696
s_waitcnt lgkmcnt(4)
v_smfmac_f32_16x16x64_bf16 v[30:33], v[120:123], v[80:87], v2
ds_read_b128 v[54:57], v3 offset:22528
v_smfmac_f32_16x16x64_bf16 v[34:37], v[112:115], v[232:239], v2
ds_read_b128 v[58:61], v3 offset:23552
v_smfmac_f32_16x16x64_bf16 v[34:37], v[116:119], v[104:111], v2
ds_read_b128 v[72:75], v3 offset:30720
v_cvt_pk_bf16_f32 v96, v30, v31
v_cvt_pk_bf16_f32 v97, v32, v33
v_smfmac_f32_16x16x64_bf16 v[34:37], v[120:123], v[88:95], v2
ds_read_b128 v[76:79], v3 offset:31744
v_smfmac_f32_16x16x64_bf16 v[38:41], v[112:115], v[240:247], v2
s_waitcnt lgkmcnt(6)
v_smfmac_f32_16x16x64_bf16 v[38:41], v[116:119], v[46:53], v2
v_cvt_pk_bf16_f32 v98, v34, v35
v_cvt_pk_bf16_f32 v99, v36, v37
global_store_dwordx4 v11, v[96:99], s[64:65] sc1
s_waitcnt lgkmcnt(4)
v_smfmac_f32_16x16x64_bf16 v[38:41], v[120:123], v[64:71], v2
v_smfmac_f32_16x16x64_bf16 v[42:45], v[112:115], v[248:255], v2
s_waitcnt lgkmcnt(2)
v_smfmac_f32_16x16x64_bf16 v[42:45], v[116:119], v[54:61], v2
v_cvt_pk_bf16_f32 v100, v38, v39
v_cvt_pk_bf16_f32 v101, v40, v41
s_waitcnt lgkmcnt(0)
v_smfmac_f32_16x16x64_bf16 v[42:45], v[120:123], v[72:79], v2
v_add_u32 v14, 0x10000, v14
v_add_u32 v15, 0x10000, v15
v_xor_b32 v7, 0x2000, v7
v_xor_b32 v8, 0x2000, v8
v_mov_b64 v[18:19], 0
v_mov_b64 v[20:21], 0
v_mov_b64 v[22:23], 0
v_mov_b64 v[24:25], 0
v_cvt_pk_bf16_f32 v102, v42, v43
v_cvt_pk_bf16_f32 v103, v44, v45
global_store_dwordx4 v11, v[100:103], s[66:67] sc1
ds_read_b128 v[112:115], v3 offset:8192
ds_read_b128 v[116:119], v3 offset:9216
ds_read_b128 v[120:123], v3 offset:10240
ds_read_b128 v[124:127], v3 offset:11264
s_add_u32 s68, s36, s57
s_addc_u32 s69, s37, 0
s_add_u32 s68, s68, 4096
s_addc_u32 s69, s69, 0
s_add_u32 s74, s34, s55
s_addc_u32 s75, s35, 0
v_xor_b32 v11, 524288, v11
s_xor_b32 s55, s55, 524288
s_xor_b32 s59, s59, 0x2000
s_mov_b32 s56, s57
s_add_u32 s57, s57, 8704
s_cmp_eq_u32 s57, 26112
s_cselect_b32 s57, 0, s57
s_add_u32 s54, s54, 1
s_add_u32 s96, s96, 0x40000
s_addc_u32 s97, s97, 0
s_add_u32 s48, s48, 0x40000
s_addc_u32 s49, s49, 0
s_add_u32 s58, s54, 2
s_min_u32 s58, s58, 63
s_add_u32 s78, s78, 0x40000
s_addc_u32 s79, s79, 0
s_add_u32 s80, s80, 0x40000
s_addc_u32 s81, s81, 0
v_mov_b64 v[26:27], 0
v_mov_b64 v[28:29], 0
v_mov_b64 v[100:101], -1
v_mov_b64 v[102:103], -1
s_cmp_lt_u32 s58, s50
s_cbranch_scc0 L_kvpolls12
L_kvrdys12:
s_waitcnt vmcnt(0) lgkmcnt(0)
s_branch L_gat12
L_gret12:
global_load_dwordx4 v[104:107], v17, s[68:69] offset:0 sc1
global_load_dwordx4 v[108:111], v17, s[68:69] offset:1024 sc1
s_add_u32 s45, s45, 1
s_add_u32 s38, s38, 1
s_waitcnt vmcnt(1)
ds_write_b128 v1, v[104:107] offset:4096
v_max_u32 v62, v104, v106
s_waitcnt vmcnt(0)
ds_write_b128 v1, v[108:111] offset:5120
v_max3_u32 v62, v62, v108, v110
v_cmp_eq_u32 vcc, -1, v62
s_cbranch_vccz L_gok12
s_cmp_lt_u32 s45, 20000
s_cbranch_scc1 L_gret12
s_branch L_gok12
L_kvpolls12:
s_lshl_b32 s44, s32, 7
s_add_u32 s44, s44, 0
s_add_u32 s46, s26, s44
s_addc_u32 s47, s27, 0
v_lshrrev_b32 v63, 2, v0
s_mov_b32 s51, 0
L_kvps12:
global_load_dword v62, v63, s[46:47] sc1
s_add_u32 s51, s51, 1
s_waitcnt vmcnt(0)
v_readlane_b32 s44, v62, 0
v_readlane_b32 s45, v62, 1
v_readlane_b32 s52, v62, 2
s_mul_i32 s44, s44, 3
s_mul_i32 s45, s45, 3
s_mul_i32 s52, s52, 3
s_add_u32 s45, s45, 1
s_add_u32 s52, s52, 2
s_min_u32 s44, s44, s45
s_min_u32 s50, s44, s52
s_cmp_lt_u32 s58, s50
s_cbranch_scc1 L_kvrdys12
s_cmp_lt_u32 s51, 300000
s_cbranch_scc1 L_kvps12
s_branch L_kvrdys12
L_gat13:
s_barrier
global_load_dwordx4 v[104:107], v17, s[68:69] offset:0 sc1
global_load_dwordx4 v[108:111], v17, s[68:69] offset:1024 sc1
ds_read_b128 v[30:33], v7 offset:0
ds_read_b128 v[34:37], v7 offset:1024
ds_read_b128 v[38:41], v7 offset:2048
ds_read_b128 v[42:45], v7 offset:3072
ds_read_b128 v[46:49], v7 offset:4096
ds_read_b128 v[50:53], v7 offset:5120
ds_read_b128 v[54:57], v7 offset:6144
ds_read_b128 v[58:61], v7 offset:7168
s_mov_b32 s45, 0
s_waitcnt vmcnt(1)
ds_write_b128 v1, v[104:107] offset:6144
v_max_u32 v62, v104, v106
s_waitcnt vmcnt(0)
ds_write_b128 v1, v[108:111] offset:7168
v_max3_u32 v62, v62, v108, v110
v_cmp_eq_u32 vcc, -1, v62
s_cbranch_vccnz L_gret13
L_gok13:
v_mov_b32 v63, s54
global_store_dword v18, v63, s[86:87] sc1
L_pre13:
v_smfmac_f32_16x16x64_bf16 v[18:21], v[104:107], a[192:199], v2
v_smfmac_f32_16x16x64_bf16 v[22:25], v[104:107], a[200:207], v2
v_smfmac_f32_16x16x64_bf16 v[18:21], v[108:111], a[224:231], v2
s_waitcnt lgkmcnt(0)
L_step13:
s_barrier
ds_read_b128 v[96:99], v1 offset:0
ds_read_b128 v[100:103], v1 offset:1024
v_smfmac_f32_16x16x64_bf16 v[26:29], v[104:107], v[112:119], v2
ds_read_b128 v[112:115], v3 offset:0
global_load_lds_dwordx4 v0, s[48:49] sc1
v_smfmac_f32_16x16x64_bf16 v[26:29], v[108:111], v[120:127], v2
ds_read_b128 v[116:119], v3 offset:1024
v_smfmac_f32_16x16x64_bf16 v[22:25], v[108:111], a[232:239], v2
ds_read_b128 v[120:123], v3 offset:2048
global_load_lds_dwordx4 v0, s[48:49] offset:1024 sc1
s_waitcnt lgkmcnt(4)
v_smfmac_f32_16x16x64_bf16 v[18:21], v[96:99], a[0:7], v2
ds_read_b128 v[124:127], v3 offset:3072
s_xor_b32 m0, s59, 0x2000
v_smfmac_f32_16x16x64_bf16 v[22:25], v[96:99], a[8:15], v2
ds_read_b128 v[104:107], v1 offset:2048
global_load_lds_dwordx4 v0, s[96:97] sc1
s_waitcnt lgkmcnt(3)
v_smfmac_f32_16x16x64_bf16 v[26:29], v[96:99], v[112:119], v2
ds_read_b128 v[108:111], v1 offset:3072
v_smfmac_f32_16x16x64_bf16 v[18:21], v[100:103], a[32:39], v2
ds_read_b128 v[96:99], v1 offset:4096
global_load_lds_dwordx4 v0, s[96:97] offset:1024 sc1
v_smfmac_f32_16x16x64_bf16 v[22:25], v[100:103], a[40:47], v2
ds_read_b128 v[112:115], v3 offset:4096
s_waitcnt lgkmcnt(4)
v_smfmac_f32_16x16x64_bf16 v[26:29], v[100:103], v[120:127], v2
ds_read_b128 v[116:119], v3 offset:5120
s_waitcnt lgkmcnt(4)
v_smfmac_f32_16x16x64_bf16 v[18:21], v[104:107], a[64:71], v2
ds_read_b128 v[100:103], v1 offset:5120
v_smfmac_f32_16x16x64_bf16 v[22:25], v[104:107], a[72:79], v2
ds_read_b128 v[120:123], v3 offset:6144
v_mov_b32 v63, -1
s_waitcnt lgkmcnt(5)
v_smfmac_f32_16x16x64_bf16 v[18:21], v[108:111], a[96:103], v2
ds_read_b128 v[124:127], v3 offset:7168
v_smfmac_f32_16x16x64_bf16 v[22:25], v[108:111], a[104:111], v2
ds_read_b128 v[64:67], v13 offset:512
global_store_dword v0, v63, s[74:75] sc1
s_waitcnt lgkmcnt(6)
v_smfmac_f32_16x16x64_bf16 v[18:21], v[96:99], a[128:135], v2
ds_read_b128 v[68:71], v13 offset:1536
v_smfmac_f32_16x16x64_bf16 v[22:25], v[96:99], a[136:143], v2
ds_read_b128 v[72:75], v13 offset:2560
global_store_dword v0, v63, s[74:75] offset:1024 sc1
s_waitcnt lgkmcnt(5)
v_smfmac_f32_16x16x64_bf16 v[18:21], v[100:103], a[160:167], v2
ds_read_b128 v[76:79], v13 offset:3584
v_smfmac_f32_16x16x64_bf16 v[22:25], v[100:103], a[168:175], v2
ds_read_b128 v[80:83], v13 offset:4608
s_waitcnt lgkmcnt(4)
v_smfmac_f32_16x16x64_bf16 v[18:21], v[64:67], a[16:23], v2
ds_read_b128 v[84:87], v13 offset:5632
v_smfmac_f32_16x16x64_bf16 v[22:25], v[64:67], a[24:31], v2
ds_read_b128 v[88:91], v13 offset:6656
s_waitcnt lgkmcnt(5)
v_smfmac_f32_16x16x64_bf16 v[18:21], v[68:71], a[48:55], v2
ds_read_b128 v[92:95], v13 offset:7680
v_smfmac_f32_16x16x64_bf16 v[22:25], v[68:71], a[56:63], v2
s_waitcnt lgkmcnt(5)
v_smfmac_f32_16x16x64_bf16 v[18:21], v[72:75], a[80:87], v2
v_smfmac_f32_16x16x64_bf16 v[22:25], v[72:75], a[88:95], v2
s_waitcnt lgkmcnt(4)
v_smfmac_f32_16x16x64_bf16 v[18:21], v[76:79], a[112:119], v2
v_smfmac_f32_16x16x64_bf16 v[22:25], v[76:79], a[120:127], v2
s_waitcnt lgkmcnt(3)
v_smfmac_f32_16x16x64_bf16 v[18:21], v[80:83], a[144:151], v2
v_smfmac_f32_16x16x64_bf16 v[22:25], v[80:83], a[152:159], v2
s_waitcnt lgkmcnt(2)
v_smfmac_f32_16x16x64_bf16 v[18:21], v[84:87], a[176:183], v2
v_smfmac_f32_16x16x64_bf16 v[22:25], v[84:87], a[184:191], v2
s_waitcnt lgkmcnt(1)
v_smfmac_f32_16x16x64_bf16 v[18:21], v[88:91], a[208:215], v2
v_smfmac_f32_16x16x64_bf16 v[22:25], v[88:91], a[216:223], v2
s_waitcnt lgkmcnt(0)
v_smfmac_f32_16x16x64_bf16 v[18:21], v[92:95], a[240:247], v2
v_smfmac_f32_16x16x64_bf16 v[22:25], v[92:95], a[248:255], v2
v_smfmac_f32_16x16x64_bf16 v[26:29], v[80:83], v[160:167], v2
v_cvt_pk_bf16_f32 v18, v18, v19
v_cvt_pk_bf16_f32 v19, v20, v21
ds_write_b64 v4, v[18:19]
s_nop 0
v_cvt_pk_bf16_f32 v20, v22, v23
v_cvt_pk_bf16_f32 v21, v24, v25
ds_write_b64 v4, v[20:21] offset:32
v_smfmac_f32_16x16x64_bf16 v[26:29], v[84:87], v[168:175], v2
ds_read_b128 v[80:83], v3 offset:8192
v_smfmac_f32_16x16x64_bf16 v[26:29], v[88:91], v[176:183], v2
ds_read_b128 v[84:87], v3 offset:9216
v_smfmac_f32_16x16x64_bf16 v[26:29], v[92:95], v[184:191], v2
ds_read_b128 v[88:91], v3 offset:10240
v_smfmac_f32_16x16x64_bf16 v[26:29], v[64:67], v[128:135], v2
ds_read_b128 v[92:95], v3 offset:11264
v_smfmac_f32_16x16x64_bf16 v[26:29], v[68:71], v[136:143], v2
v_mov_b32 v22, v16
v_mov_b32 v23, v16
v_smfmac_f32_16x16x64_bf16 v[26:29], v[72:75], v[144:151], v2
v_mov_b32 v24, v16
v_mov_b32 v25, v16
v_smfmac_f32_16x16x64_bf16 v[26:29], v[76:79], v[152:159], v2
s_waitcnt lgkmcnt(4)
s_barrier
ds_read_b64_tr_b16 v[64:65], v5 offset:0
ds_read_b64_tr_b16 v[66:67], v5 offset:32
ds_read_b64_tr_b16 v[68:69], v5 offset:1536
ds_read_b64_tr_b16 v[70:71], v5 offset:1568
v_smfmac_f32_16x16x64_bf16 v[26:29], v[104:107], v[112:119], v2
ds_read_b64_tr_b16 v[72:73], v5 offset:3072
v_smfmac_f32_16x16x64_bf16 v[26:29], v[108:111], v[120:127], v2
ds_read_b64_tr_b16 v[74:75], v5 offset:3104
s_waitcnt lgkmcnt(8)
v_smfmac_f32_16x16x64_bf16 v[26:29], v[96:99], v[80:87], v2
ds_read_b64_tr_b16 v[76:77], v5 offset:4608
s_waitcnt lgkmcnt(7)
v_smfmac_f32_16x16x64_bf16 v[26:29], v[100:103], v[88:95], v2
ds_read_b64_tr_b16 v[78:79], v5 offset:4640
s_waitcnt lgkmcnt(6)
v_mfma_f32_16x16x32_bf16 v[22:25], v[64:67], v[64:67], v[22:25]
s_waitcnt lgkmcnt(4)
v_mfma_f32_16x16x32_bf16 v[22:25], v[68:71], v[68:71], v[22:25]
s_waitcnt lgkmcnt(2)
v_mfma_f32_16x16x32_bf16 v[22:25], v[72:75], v[72:75], v[22:25]
ds_read_b128 v[104:107], v3 offset:18432
s_waitcnt lgkmcnt(1)
v_mfma_f32_16x16x32_bf16 v[22:25], v[76:79], v[76:79], v[22:25]
ds_read_b128 v[108:111], v3 offset:19456
ds_read_b64_tr_b16 v[18:19], v6
v_mfma_f32_16x16x32_bf16 v[112:115], v[30:33], v[64:67], 0
v_cvt_pk_bf16_f32 v124, v26, v27
v_cvt_pk_bf16_f32 v125, v28, v29
v_mfma_f32_16x16x32_bf16 v[112:115], v[38:41], v[68:71], v[112:115]
v_cvt_pk_bf16_f32 v126, v26, v27
v_cvt_pk_bf16_f32 v127, v28, v29
v_mfma_f32_16x16x32_bf16 v[112:115], v[46:49], v[72:75], v[112:115]
ds_read_b128 v[88:91], v3 offset:26624
global_store_dwordx2 v15, v[124:125], s[72:73] sc1
v_mfma_f32_16x16x32_bf16 v[112:115], v[54:57], v[76:79], v[112:115]
ds_read_b128 v[92:95], v3 offset:27648
v_max3_f32 v62, v22, v23, v24
v_mfma_f32_16x16x32_bf16 v[116:119], v[34:37], v[64:67], 0
v_permlane32_swap_b32 v124, v126
v_permlane32_swap_b32 v125, v127
v_mfma_f32_16x16x32_bf16 v[116:119], v[42:45], v[68:71], v[116:119]
s_waitcnt lgkmcnt(2)
global_store_dwordx2 v14, v[18:19], s[70:71] sc1
v_mfma_f32_16x16x32_bf16 v[116:119], v[50:53], v[72:75], v[116:119]
v_max3_f32 v62, v62, v25, v112
v_max3_f32 v63, v113, v114, v115
v_mfma_f32_16x16x32_bf16 v[116:119], v[58:61], v[76:79], v[116:119]
v_max_f32 v62, v62, v63
s_cmp_eq_u32 s54, 63
s_cbranch_scc1 L_chain_end
v_mov_b64 v[26:27], s[42:43]
v_mov_b64 v[30:31], 0
v_mov_b64 v[32:33], 0
s_nop 1
v_max3_f32 v63, v116, v117, v118
v_max3_f32 v62, v62, v63, v119
v_mov_b32 v63, v62
v_mov_b64 v[34:35], 0
v_mov_b64 v[36:37], 0
v_permlane32_swap_b32 v62, v63
v_max_f32 v62, v62, v63
v_mov_b32 v63, v62
v_mov_b64 v[38:39], 0
v_mov_b64 v[28:29], s[42:43]
v_permlane16_swap_b32 v62, v63
v_max_f32 v62, v62, v63
v_mul_f32 v62, s88, v62
v_pk_fma_f32 v[112:113], v[112:113], s[88:89], v[62:63] op_sel_hi:[1,1,0] neg_lo:[0,0,1] neg_hi:[0,0,1]
v_pk_fma_f32 v[114:115], v[114:115], s[88:89], v[62:63] op_sel_hi:[1,1,0] neg_lo:[0,0,1] neg_hi:[0,0,1]
v_pk_fma_f32 v[116:117], v[116:117], s[88:89], v[62:63] op_sel_hi:[1,1,0] neg_lo:[0,0,1] neg_hi:[0,0,1]
v_pk_fma_f32 v[118:119], v[118:119], s[88:89], v[62:63] op_sel_hi:[1,1,0] neg_lo:[0,0,1] neg_hi:[0,0,1]
v_pk_fma_f32 v[22:23], v[22:23], s[88:89], v[62:63] op_sel_hi:[1,1,0] neg_lo:[0,0,1] neg_hi:[0,0,1]
v_pk_fma_f32 v[24:25], v[24:25], s[88:89], v[62:63] op_sel_hi:[1,1,0] neg_lo:[0,0,1] neg_hi:[0,0,1]
v_exp_f32 v112, v112
v_exp_f32 v113, v113
v_exp_f32 v114, v114
v_exp_f32 v115, v115
s_waitcnt vmcnt(6)
ds_read_b128 v[72:75], v8 offset:0
ds_read_b128 v[76:79], v8 offset:1024
v_exp_f32 v116, v116
v_exp_f32 v117, v117
v_cvt_pk_bf16_f32 v64, v112, v113
v_cvt_pk_bf16_f32 v65, v114, v115
v_exp_f32 v118, v118
v_exp_f32 v119, v119
v_cvt_pk_bf16_f32 v66, v116, v117
v_cvt_pk_bf16_f32 v67, v118, v119
s_waitcnt lgkmcnt(0)
v_exp_f32 v22, v22
v_mfma_f32_16x16x32_bf16 v[112:115], v[26:29], v[64:67], 0
v_exp_f32 v23, v23
v_mfma_f32_16x16x32_bf16 v[116:119], v[72:75], v[64:67], 0
v_exp_f32 v24, v24
v_mfma_f32_16x16x32_bf16 v[120:123], v[76:79], v[64:67], 0
v_exp_f32 v25, v25
v_cvt_pk_bf16_f32 v68, v22, v23
v_cvt_pk_bf16_f32 v69, v24, v25
s_nop 1
v_mfma_f32_16x16x16_bf16 v[112:115], v[26:27], v[68:69], v[112:115]
v_mfma_f32_16x16x16_bf16 v[116:119], v[124:125], v[68:69], v[116:119]
v_mfma_f32_16x16x16_bf16 v[120:123], v[126:127], v[68:69], v[120:123]
v_rcp_f32 v112, v112
v_mov_b64 v[40:41], 0
v_mov_b64 v[42:43], 0
v_mov_b64 v[44:45], 0
v_pk_mul_f32 v[116:117], v[116:117], v[112:113] op_sel_hi:[1,0]
v_pk_mul_f32 v[118:119], v[118:119], v[112:113] op_sel_hi:[1,0]
v_cvt_pk_bf16_f32 v124, v116, v117
v_cvt_pk_bf16_f32 v125, v118, v119
v_pk_mul_f32 v[120:121], v[120:121], v[112:113] op_sel_hi:[1,0]
v_pk_mul_f32 v[122:123], v[122:123], v[112:113] op_sel_hi:[1,0]
v_cvt_pk_bf16_f32 v126, v120, v121
v_cvt_pk_bf16_f32 v127, v122, v123
ds_write_b128 v9, v[124:127]
v_lshlrev_b32 v63, 3, v0
v_and_b32 v63, 896, v63
s_add_u32 s44, s54, 1
v_mov_b32 v62, s44
v_mov_b32_dpp v124, v124 row_shr:8 row_mask:0xf bank_mask:0xc
v_mov_b32_dpp v125, v125 row_shr:8 row_mask:0xf bank_mask:0xc
v_mov_b32_dpp v126, v126 row_shr:8 row_mask:0xf bank_mask:0xc
v_mov_b32_dpp v127, v127 row_shr:8 row_mask:0xf bank_mask:0xc
s_waitcnt vmcnt(2)
s_waitcnt lgkmcnt(0)
s_barrier
ds_read_b128 v[112:115], v10 offset:0
ds_read_b128 v[116:119], v10 offset:16
ds_read_b128 v[120:123], v10 offset:32
s_mov_b64 exec, 0xff
global_store_dword v63, v62, s[40:41] sc1
s_mov_b64 exec, -1
v_smfmac_f32_16x16x64_bf16 v[30:33], v[124:127], v[192:199], v2
ds_read_b128 v[96:99], v3 offset:16384
ds_read_b128 v[100:103], v3 offset:17408
v_smfmac_f32_16x16x64_bf16 v[34:37], v[124:127], v[200:207], v2
ds_read_b128 v[80:83], v3 offset:24576
ds_read_b128 v[84:87], v3 offset:25600
v_smfmac_f32_16x16x64_bf16 v[38:41], v[124:127], v[208:215], v2
ds_read_b128 v[46:49], v3 offset:20480
v_smfmac_f32_16x16x64_bf16 v[42:45], v[124:127], v[216:223], v2
ds_read_b128 v[50:53], v3 offset:21504
s_waitcnt lgkmcnt(8)
v_smfmac_f32_16x16x64_bf16 v[30:33], v[112:115], v[224:231], v2
ds_read_b128 v[64:67], v3 offset:28672
s_waitcnt lgkmcnt(8)
s_waitcnt lgkmcnt(5)
v_smfmac_f32_16x16x64_bf16 v[30:33], v[116:119], v[96:103], v2
ds_read_b128 v[68:71], v3 offset:29696
s_waitcnt lgkmcnt(4)
v_smfmac_f32_16x16x64_bf16 v[30:33], v[120:123], v[80:87], v2
ds_read_b128 v[54:57], v3 offset:22528
v_smfmac_f32_16x16x64_bf16 v[34:37], v[112:115], v[232:239], v2
ds_read_b128 v[58:61], v3 offset:23552
v_smfmac_f32_16x16x64_bf16 v[34:37], v[116:119], v[104:111], v2
ds_read_b128 v[72:75], v3 offset:30720
v_cvt_pk_bf16_f32 v96, v30, v31
v_cvt_pk_bf16_f32 v97, v32, v33
v_smfmac_f32_16x16x64_bf16 v[34:37], v[120:123], v[88:95], v2
ds_read_b128 v[76:79], v3 offset:31744
v_smfmac_f32_16x16x64_bf16 v[38:41], v[112:115], v[240:247], v2
s_waitcnt lgkmcnt(6)
v_smfmac_f32_16x16x64_bf16 v[38:41], v[116:119], v[46:53], v2
v_cvt_pk_bf16_f32 v98, v34, v35
v_cvt_pk_bf16_f32 v99, v36, v37
global_store_dwordx4 v11, v[96:99], s[64:65] sc1
s_waitcnt lgkmcnt(4)
v_smfmac_f32_16x16x64_bf16 v[38:41], v[120:123], v[64:71], v2
v_smfmac_f32_16x16x64_bf16 v[42:45], v[112:115], v[248:255], v2
s_waitcnt lgkmcnt(2)
v_smfmac_f32_16x16x64_bf16 v[42:45], v[116:119], v[54:61], v2
v_cvt_pk_bf16_f32 v100, v38, v39
v_cvt_pk_bf16_f32 v101, v40, v41
s_waitcnt lgkmcnt(0)
v_smfmac_f32_16x16x64_bf16 v[42:45], v[120:123], v[72:79], v2
v_add_u32 v14, 0x10000, v14
v_add_u32 v15, 0x10000, v15
v_xor_b32 v7, 0x2000, v7
v_xor_b32 v8, 0x2000, v8
v_mov_b64 v[18:19], 0
v_mov_b64 v[20:21], 0
v_mov_b64 v[22:23], 0
v_mov_b64 v[24:25], 0
v_cvt_pk_bf16_f32 v102, v42, v43
v_cvt_pk_bf16_f32 v103, v44, v45
global_store_dwordx4 v11, v[100:103], s[66:67] sc1
ds_read_b128 v[112:115], v3 offset:12288
ds_read_b128 v[116:119], v3 offset:13312
ds_read_b128 v[120:123], v3 offset:14336
ds_read_b128 v[124:127], v3 offset:15360
s_add_u32 s68, s36, s57
s_addc_u32 s69, s37, 0
s_add_u32 s68, s68, 6144
s_addc_u32 s69, s69, 0
s_add_u32 s74, s34, s55
s_addc_u32 s75, s35, 0
v_xor_b32 v11, 524288, v11
s_xor_b32 s55, s55, 524288
s_xor_b32 s59, s59, 0x2000
s_mov_b32 s56, s57
s_add_u32 s57, s57, 8704
s_cmp_eq_u32 s57, 26112
s_cselect_b32 s57, 0, s57
s_add_u32 s54, s54, 1
s_add_u32 s96, s96, 0x40000
s_addc_u32 s97, s97, 0
s_add_u32 s48, s48, 0x40000
s_addc_u32 s49, s49, 0
v_mov_b64 v[26:27], 0
v_mov_b64 v[28:29], 0
v_mov_b64 v[100:101], -1
v_mov_b64 v[102:103], -1
s_waitcnt vmcnt(0) lgkmcnt(0)
s_branch L_gat13
L_gret13:
global_load_dwordx4 v[104:107], v17, s[68:69] offset:0 sc1
global_load_dwordx4 v[108:111], v17, s[68:69] offset:1024 sc1
s_add_u32 s45, s45, 1
s_add_u32 s38, s38, 1
s_waitcnt vmcnt(1)
ds_write_b128 v1, v[104:107] offset:6144
v_max_u32 v62, v104, v106
s_waitcnt vmcnt(0)
ds_write_b128 v1, v[108:111] offset:7168
v_max3_u32 v62, v62, v108, v110
v_cmp_eq_u32 vcc, -1, v62
s_cbranch_vccz L_gok13
s_cmp_lt_u32 s45, 20000
s_cbranch_scc1 L_gret13
s_branch L_gok13
L_kvpolli:
s_lshl_b32 s44, s32, 7
s_add_u32 s44, s44, 0
s_add_u32 s46, s26, s44
s_addc_u32 s47, s27, 0
v_lshrrev_b32 v63, 2, v0
s_mov_b32 s51, 0
L_kvpi:
global_load_dword v62, v63, s[46:47] sc1
s_add_u32 s51, s51, 1
s_waitcnt vmcnt(0)
v_readlane_b32 s44, v62, 0
v_readlane_b32 s45, v62, 1
v_readlane_b32 s52, v62, 2
s_mul_i32 s44, s44, 3
s_mul_i32 s45, s45, 3
s_mul_i32 s52, s52, 3
s_add_u32 s45, s45, 1
s_add_u32 s52, s52, 2
s_min_u32 s44, s44, s45
s_min_u32 s50, s44, s52
s_cmp_lt_u32 s58, s50
s_cbranch_scc1 L_kvrdyi
s_cmp_lt_u32 s51, 300000
s_cbranch_scc1 L_kvpi
s_branch L_kvrdyi
L_chain_end:
s_waitcnt vmcnt(0)
s_barrier
s_cmp_eq_u32 s29, 3
s_cbranch_scc0 L_chain_fin
v_mov_b32 v62, 0
v_mov_b32 v63, 64
s_mov_b64 exec, 1
global_store_dword v62, v63, s[86:87] sc1
s_mov_b64 exec, -1
s_waitcnt vmcnt(0)
L_chain_fin:
s_endpgm
L_out_pro:
s_sub_u32 s34, s30, 128
s_lshr_b32 s32, s34, 2
s_and_b32 s33, s34, 3
v_lshrrev_b32 v40, 4, v0
v_and_b32 v41, 15, v0
v_lshrrev_b32 v42, 2, v41
v_and_b32 v43, 3, v41
v_lshlrev_b32 v5, 4, v0
s_lshl_b32 s34, s29, 13
v_add_u32 v1, s34, v5
v_mul_u32_u24 v2, 1056, v41
v_lshlrev_b32 v44, 4, v40
v_add_u32 v2, v2, v44
s_lshl_b32 s34, s29, 14
s_add_u32 s34, s34, 67584
v_add_u32 v3, s34, v5
s_lshl_b32 s34, s29, 11
s_add_u32 s35, s34, 133120
v_add_u32 v4, s35, v5
v_add_u32 v19, s34, v5
v_lshlrev_b32 v45, 3, v0
s_lshl_b32 s34, s29, 3
s_add_u32 s34, s34, 149504
v_add_u32 v6, s34, v5
v_add_u32 v7, 151552, v45
v_add_u32 v8, 151552, v45
v_add_u32 v140, 149504, v5
v_add_u32 v141, 141312, v5
v_lshlrev_b32 v46, 2, v41
v_add_u32 v9, 152576, v46
v_add_u32 v17, 152576, v46
s_and_b32 s34, s29, 1
s_lshl_b32 s34, s34, 6
v_add_u32 v139, s34, v9
s_and_b32 s34, s29, 1
s_lshl_b32 s34, s34, 10
s_add_u32 s34, s34, 133120
v_add_u32 v18, s34, v5
v_lshlrev_b32 v46, 7, v40
v_and_b32 v47, 7, v41
v_lshlrev_b32 v47, 4, v47
v_add_u32 v10, v46, v47
v_add_u32 v10, 16384, v10
s_lshr_b32 s34, s29, 1
s_lshl_b32 s35, s34, 12
s_add_u32 s35, s35, 8192
v_add_u32 v11, s35, v5
s_lshl_b32 s35, s34, 10
s_add_u32 s35, s35, 18432
v_add_u32 v12, s35, v45
s_and_b32 s35, s29, 1
s_lshl_b32 s35, s35, 12
s_lshl_b32 s34, s34, 11
s_add_u32 s34, s34, s35
s_add_u32 s34, s34, 141312
v_add_u32 v13, s34, v5
s_lshl_b32 s34, s29, 17
s_lshl_b32 s35, s32, 10
s_add_u32 s34, s34, s35
v_add_u32 v14, s34, v5
s_lshl_b32 s34, s32, 15
s_lshl_b32 s35, s29, 8
s_add_u32 s34, s34, s35
v_lshlrev_b32 v46, 10, v40
v_lshlrev_b32 v47, 4, v41
v_add_u32 v46, v46, v47
v_add_u32 v15, s34, v46
s_lshr_b32 s34, s32, 4
s_lshl_b32 s34, s34, 14
s_and_b32 s35, s32, 15
s_lshl_b32 s35, s35, 6
s_add_u32 s34, s34, s35
s_lshl_b32 s35, s29, 4
s_add_u32 s34, s34, s35
v_lshlrev_b32 v46, 10, v41
v_lshlrev_b32 v47, 3, v40
v_add_u32 v46, v46, v47
v_add_u32 v16, s34, v46
v_cmp_gt_u32 s[60:61], 32, v0
v_mov_b32 v32, 0x3f803f80
v_mov_b32 v33, 0x3f803f80
v_mov_b32 v34, 0x3f803f80
v_mov_b32 v35, 0x3f803f80
v_mov_b32 v48, 0xf149f2ca
v_cmp_le_u32 vcc, 2, v40
s_nop 1
v_cndmask_b32 v20, 0, v48, vcc
v_mov_b32 v21, v20
v_mov_b32 v22, v20
v_mov_b32 v23, v20
s_and_b32 s34, s29, 1
s_lshl_b32 s34, s34, 4
v_add_u32 v49, s34, v41
v_lshlrev_b32 v50, 2, v40
v_add_u32 v51, 0, v50
v_cmp_gt_u32 vcc, v51, v49
s_nop 1
v_cndmask_b32 v24, 0, v48, vcc
v_add_u32 v51, 1, v50
v_cmp_gt_u32 vcc, v51, v49
s_nop 1
v_cndmask_b32 v25, 0, v48, vcc
v_add_u32 v51, 2, v50
v_cmp_gt_u32 vcc, v51, v49
s_nop 1
v_cndmask_b32 v26, 0, v48, vcc
v_add_u32 v51, 3, v50
v_cmp_gt_u32 vcc, v51, v49
s_nop 1
v_cndmask_b32 v27, 0, v48, vcc
v_add_u32 v51, 16, v50
v_cmp_gt_u32 vcc, v51, v49
s_nop 1
v_cndmask_b32 v28, 0, v48, vcc
v_add_u32 v51, 17, v50
v_cmp_gt_u32 vcc, v51, v49
s_nop 1
v_cndmask_b32 v29, 0, v48, vcc
v_add_u32 v51, 18, v50
v_cmp_gt_u32 vcc, v51, v49
s_nop 1
v_cndmask_b32 v30, 0, v48, vcc
v_add_u32 v51, 19, v50
v_cmp_gt_u32 vcc, v51, v49
s_nop 1
v_cndmask_b32 v31, 0, v48, vcc
v_mov_b32 v51, 0x3f80
v_mov_b32 v52, 0x3f800000
v_mov_b32 v36, 0
v_cmp_eq_u32 vcc, 0, v41
s_nop 1
v_cndmask_b32 v36, v36, v51, vcc
v_cmp_eq_u32 vcc, 1, v41
s_nop 1
v_cndmask_b32 v36, v36, v52, vcc
v_mov_b32 v37, 0
v_cmp_eq_u32 vcc, 2, v41
s_nop 1
v_cndmask_b32 v37, v37, v51, vcc
v_cmp_eq_u32 vcc, 3, v41
s_nop 1
v_cndmask_b32 v37, v37, v52, vcc
v_mov_b32 v38, 0
v_cmp_eq_u32 vcc, 4, v41
s_nop 1
v_cndmask_b32 v38, v38, v51, vcc
v_cmp_eq_u32 vcc, 5, v41
s_nop 1
v_cndmask_b32 v38, v38, v52, vcc
v_mov_b32 v39, 0
v_cmp_eq_u32 vcc, 6, v41
s_nop 1
v_cndmask_b32 v39, v39, v51, vcc
v_cmp_eq_u32 vcc, 7, v41
s_nop 1
v_cndmask_b32 v39, v39, v52, vcc
s_mov_b32 s54, s33
s_mov_b32 s55, 0
s_lshl_b32 s50, s54, 15
s_add_u32 s50, s4, s50
s_addc_u32 s51, s5, 0
s_mul_i32 s52, s29, 8448
s_add_u32 s52, s52, s55
s_add_u32 m0, s52, 0
s_nop 0
global_load_lds_dwordx4 v1, s[50:51] offset:0
s_add_u32 m0, s52, 32
s_nop 0
global_load_lds_dwordx4 v1, s[50:51] offset:1024
s_add_u32 m0, s52, 64
s_nop 0
global_load_lds_dwordx4 v1, s[50:51] offset:2048
s_add_u32 m0, s52, 96
s_nop 0
global_load_lds_dwordx4 v1, s[50:51] offset:3072
s_add_u32 s50, s50, 4096
s_addc_u32 s51, s51, 0
s_add_u32 m0, s52, 4224
s_nop 0
global_load_lds_dwordx4 v1, s[50:51] offset:0
s_add_u32 m0, s52, 4256
s_nop 0
global_load_lds_dwordx4 v1, s[50:51] offset:1024
s_add_u32 m0, s52, 4288
s_nop 0
global_load_lds_dwordx4 v1, s[50:51] offset:2048
s_add_u32 m0, s52, 4320
s_nop 0
global_load_lds_dwordx4 v1, s[50:51] offset:3072
s_lshl_b32 s34, s29, 3
v_add_u32 v51, s34, v40
v_lshlrev_b32 v44, 13, v51
v_lshlrev_b32 v52, 4, v41
v_add_u32 v44, v44, v52
v_add_u32 v45, 0x8000, v44
v_mul_u32_u24 v46, 288, v51
v_add_u32 v46, v46, v52
v_add_u32 v46, 33792, v46
v_lshlrev_b32 v53, 3, v40
v_add_u32 v53, v53, v42
v_mul_u32_u24 v47, 288, v53
v_lshlrev_b32 v54, 3, v43
s_lshl_b32 s34, s29, 6
v_add_u32 v54, s34, v54
v_add_u32 v47, v47, v54
v_add_u32 v47, 33792, v47
s_mul_i32 s34, s29, 13824
s_add_u32 s34, s34, 67584
v_mul_u32_u24 v49, 288, v40
v_add_u32 v49, v49, v52
v_add_u32 v49, s34, v49
v_lshlrev_b32 v53, 2, v40
v_add_u32 v53, v53, v42
v_mul_u32_u24 v48, 288, v53
v_lshlrev_b32 v54, 4, v43
v_add_u32 v48, v48, v54
v_add_u32 v48, s34, v48
v_lshlrev_b32 v50, 10, v40
v_add_u32 v50, v50, v52
s_lshl_b32 s34, s29, 8
v_add_u32 v50, s34, v50
s_lshl_b32 s46, s32, 8
s_add_u32 s48, s8, s46
s_addc_u32 s49, s9, 0
global_load_dwordx4 v[64:67], v44, s[48:49]
global_load_dwordx4 v[68:71], v45, s[48:49]
s_add_u32 s48, s48, 0x40000
s_addc_u32 s49, s49, 0
global_load_dwordx4 v[72:75], v44, s[48:49]
global_load_dwordx4 v[76:79], v45, s[48:49]
s_add_u32 s48, s48, 0x40000
s_addc_u32 s49, s49, 0
global_load_dwordx4 v[80:83], v44, s[48:49]
global_load_dwordx4 v[84:87], v45, s[48:49]
s_add_u32 s48, s48, 0x40000
s_addc_u32 s49, s49, 0
global_load_dwordx4 v[88:91], v44, s[48:49]
global_load_dwordx4 v[92:95], v45, s[48:49]
s_add_u32 s48, s48, 0x40000
s_addc_u32 s49, s49, 0
global_load_dwordx4 v[96:99], v44, s[48:49]
global_load_dwordx4 v[100:103], v45, s[48:49]
s_add_u32 s48, s48, 0x40000
s_addc_u32 s49, s49, 0
global_load_dwordx4 v[104:107], v44, s[48:49]
global_load_dwordx4 v[108:111], v45, s[48:49]
s_add_u32 s48, s48, 0x40000
s_addc_u32 s49, s49, 0
global_load_dwordx4 v[112:115], v44, s[48:49]
global_load_dwordx4 v[116:119], v45, s[48:49]
s_add_u32 s48, s48, 0x40000
s_addc_u32 s49, s49, 0
global_load_dwordx4 v[120:123], v44, s[48:49]
global_load_dwordx4 v[124:127], v45, s[48:49]
s_waitcnt vmcnt(14)
ds_write_b128 v46, v[64:67] offset:0
ds_write_b128 v46, v[68:71] offset:1152
s_add_u32 s48, s48, 0x40000
s_addc_u32 s49, s49, 0
global_load_dwordx4 v[64:67], v44, s[48:49]
global_load_dwordx4 v[68:71], v45, s[48:49]
s_waitcnt lgkmcnt(0)
s_barrier
s_cmp_eq_u32 s29, 0
s_cbranch_scc0 L_arr_3
v_mov_b32 v52, 192
v_mov_b32 v54, 1
s_mov_b64 exec, 1
global_atomic_add v52, v54, s[24:25] sc1
s_mov_b64 exec, -1
L_arr_3:
ds_read_b64_tr_b16 a[0:1], v47 offset:0
ds_read_b64_tr_b16 a[2:3], v47 offset:1152
ds_read_b64_tr_b16 a[64:65], v47 offset:32
ds_read_b64_tr_b16 a[66:67], v47 offset:1184
s_waitcnt vmcnt(14)
ds_write_b128 v46, v[72:75] offset:9216
ds_write_b128 v46, v[76:79] offset:10368
s_add_u32 s48, s48, 0x40000
s_addc_u32 s49, s49, 0
global_load_dwordx4 v[72:75], v44, s[48:49]
global_load_dwordx4 v[76:79], v45, s[48:49]
s_waitcnt lgkmcnt(0)
s_barrier
ds_read_b64_tr_b16 a[4:5], v47 offset:9216
ds_read_b64_tr_b16 a[6:7], v47 offset:10368
ds_read_b64_tr_b16 a[68:69], v47 offset:9248
ds_read_b64_tr_b16 a[70:71], v47 offset:10400
s_waitcnt vmcnt(14)
ds_write_b128 v46, v[80:83] offset:0
ds_write_b128 v46, v[84:87] offset:1152
s_add_u32 s48, s48, 0x40000
s_addc_u32 s49, s49, 0
global_load_dwordx4 v[80:83], v44, s[48:49]
global_load_dwordx4 v[84:87], v45, s[48:49]
s_waitcnt lgkmcnt(0)
s_barrier
ds_read_b64_tr_b16 a[8:9], v47 offset:0
ds_read_b64_tr_b16 a[10:11], v47 offset:1152
ds_read_b64_tr_b16 a[72:73], v47 offset:32
ds_read_b64_tr_b16 a[74:75], v47 offset:1184
s_waitcnt vmcnt(14)
ds_write_b128 v46, v[88:91] offset:9216
ds_write_b128 v46, v[92:95] offset:10368
s_add_u32 s48, s48, 0x40000
s_addc_u32 s49, s49, 0
global_load_dwordx4 v[88:91], v44, s[48:49]
global_load_dwordx4 v[92:95], v45, s[48:49]
s_waitcnt lgkmcnt(0)
s_barrier
ds_read_b64_tr_b16 a[12:13], v47 offset:9216
ds_read_b64_tr_b16 a[14:15], v47 offset:10368
ds_read_b64_tr_b16 a[76:77], v47 offset:9248
ds_read_b64_tr_b16 a[78:79], v47 offset:10400
s_waitcnt vmcnt(14)
ds_write_b128 v46, v[96:99] offset:0
ds_write_b128 v46, v[100:103] offset:1152
s_add_u32 s48, s48, 0x40000
s_addc_u32 s49, s49, 0
global_load_dwordx4 v[96:99], v44, s[48:49]
global_load_dwordx4 v[100:103], v45, s[48:49]
s_waitcnt lgkmcnt(0)
s_barrier
ds_read_b64_tr_b16 a[16:17], v47 offset:0
ds_read_b64_tr_b16 a[18:19], v47 offset:1152
ds_read_b64_tr_b16 a[80:81], v47 offset:32
ds_read_b64_tr_b16 a[82:83], v47 offset:1184
s_waitcnt vmcnt(14)
ds_write_b128 v46, v[104:107] offset:9216
ds_write_b128 v46, v[108:111] offset:10368
s_add_u32 s48, s48, 0x40000
s_addc_u32 s49, s49, 0
global_load_dwordx4 v[104:107], v44, s[48:49]
global_load_dwordx4 v[108:111], v45, s[48:49]
s_waitcnt lgkmcnt(0)
s_barrier
ds_read_b64_tr_b16 a[20:21], v47 offset:9216
ds_read_b64_tr_b16 a[22:23], v47 offset:10368
ds_read_b64_tr_b16 a[84:85], v47 offset:9248
ds_read_b64_tr_b16 a[86:87], v47 offset:10400
s_waitcnt vmcnt(14)
ds_write_b128 v46, v[112:115] offset:0
ds_write_b128 v46, v[116:119] offset:1152
s_add_u32 s48, s48, 0x40000
s_addc_u32 s49, s49, 0
global_load_dwordx4 v[112:115], v44, s[48:49]
global_load_dwordx4 v[116:119], v45, s[48:49]
s_waitcnt lgkmcnt(0)
s_barrier
ds_read_b64_tr_b16 a[24:25], v47 offset:0
ds_read_b64_tr_b16 a[26:27], v47 offset:1152
ds_read_b64_tr_b16 a[88:89], v47 offset:32
ds_read_b64_tr_b16 a[90:91], v47 offset:1184
s_waitcnt vmcnt(14)
ds_write_b128 v46, v[120:123] offset:9216
ds_write_b128 v46, v[124:127] offset:10368
s_add_u32 s48, s48, 0x40000
s_addc_u32 s49, s49, 0
global_load_dwordx4 v[120:123], v44, s[48:49]
global_load_dwordx4 v[124:127], v45, s[48:49]
s_waitcnt lgkmcnt(0)
s_barrier
ds_read_b64_tr_b16 a[28:29], v47 offset:9216
ds_read_b64_tr_b16 a[30:31], v47 offset:10368
ds_read_b64_tr_b16 a[92:93], v47 offset:9248
ds_read_b64_tr_b16 a[94:95], v47 offset:10400
s_waitcnt vmcnt(14)
ds_write_b128 v46, v[64:67] offset:0
ds_write_b128 v46, v[68:71] offset:1152
s_waitcnt lgkmcnt(0)
s_barrier
ds_read_b64_tr_b16 a[32:33], v47 offset:0
ds_read_b64_tr_b16 a[34:35], v47 offset:1152
ds_read_b64_tr_b16 a[96:97], v47 offset:32
ds_read_b64_tr_b16 a[98:99], v47 offset:1184
s_waitcnt vmcnt(12)
ds_write_b128 v46, v[72:75] offset:9216
ds_write_b128 v46, v[76:79] offset:10368
s_waitcnt lgkmcnt(0)
s_barrier
ds_read_b64_tr_b16 a[36:37], v47 offset:9216
ds_read_b64_tr_b16 a[38:39], v47 offset:10368
ds_read_b64_tr_b16 a[100:101], v47 offset:9248
ds_read_b64_tr_b16 a[102:103], v47 offset:10400
s_waitcnt vmcnt(10)
ds_write_b128 v46, v[80:83] offset:0
ds_write_b128 v46, v[84:87] offset:1152
s_waitcnt lgkmcnt(0)
s_barrier
ds_read_b64_tr_b16 a[40:41], v47 offset:0
ds_read_b64_tr_b16 a[42:43], v47 offset:1152
ds_read_b64_tr_b16 a[104:105], v47 offset:32
ds_read_b64_tr_b16 a[106:107], v47 offset:1184
s_waitcnt vmcnt(8)
ds_write_b128 v46, v[88:91] offset:9216
ds_write_b128 v46, v[92:95] offset:10368
s_waitcnt lgkmcnt(0)
s_barrier
ds_read_b64_tr_b16 a[44:45], v47 offset:9216
ds_read_b64_tr_b16 a[46:47], v47 offset:10368
ds_read_b64_tr_b16 a[108:109], v47 offset:9248
ds_read_b64_tr_b16 a[110:111], v47 offset:10400
s_waitcnt vmcnt(6)
ds_write_b128 v46, v[96:99] offset:0
ds_write_b128 v46, v[100:103] offset:1152
s_waitcnt lgkmcnt(0)
s_barrier
ds_read_b64_tr_b16 a[48:49], v47 offset:0
ds_read_b64_tr_b16 a[50:51], v47 offset:1152
ds_read_b64_tr_b16 a[112:113], v47 offset:32
ds_read_b64_tr_b16 a[114:115], v47 offset:1184
s_waitcnt vmcnt(4)
ds_write_b128 v46, v[104:107] offset:9216
ds_write_b128 v46, v[108:111] offset:10368
s_waitcnt lgkmcnt(0)
s_barrier
ds_read_b64_tr_b16 a[52:53], v47 offset:9216
ds_read_b64_tr_b16 a[54:55], v47 offset:10368
ds_read_b64_tr_b16 a[116:117], v47 offset:9248
ds_read_b64_tr_b16 a[118:119], v47 offset:10400
s_waitcnt vmcnt(2)
ds_write_b128 v46, v[112:115] offset:0
ds_write_b128 v46, v[116:119] offset:1152
s_waitcnt lgkmcnt(0)
s_barrier
ds_read_b64_tr_b16 a[56:57], v47 offset:0
ds_read_b64_tr_b16 a[58:59], v47 offset:1152
ds_read_b64_tr_b16 a[120:121], v47 offset:32
ds_read_b64_tr_b16 a[122:123], v47 offset:1184
s_waitcnt vmcnt(0)
ds_write_b128 v46, v[120:123] offset:9216
ds_write_b128 v46, v[124:127] offset:10368
s_waitcnt lgkmcnt(0)
s_barrier
ds_read_b64_tr_b16 a[60:61], v47 offset:9216
ds_read_b64_tr_b16 a[62:63], v47 offset:10368
ds_read_b64_tr_b16 a[124:125], v47 offset:9248
ds_read_b64_tr_b16 a[126:127], v47 offset:10400
s_waitcnt lgkmcnt(0)
s_barrier
s_lshl_b32 s46, s32, 17
s_add_u32 s48, s14, s46
s_addc_u32 s49, s15, 0
global_load_dwordx4 v[64:67], v50, s[48:49]
s_add_u32 s48, s48, 4096
s_addc_u32 s49, s49, 0
global_load_dwordx4 v[68:71], v50, s[48:49]
s_add_u32 s48, s48, 4096
s_addc_u32 s49, s49, 0
global_load_dwordx4 v[72:75], v50, s[48:49]
s_add_u32 s48, s48, 4096
s_addc_u32 s49, s49, 0
global_load_dwordx4 v[76:79], v50, s[48:49]
s_add_u32 s48, s48, 4096
s_addc_u32 s49, s49, 0
global_load_dwordx4 v[80:83], v50, s[48:49]
s_add_u32 s48, s48, 4096
s_addc_u32 s49, s49, 0
global_load_dwordx4 v[84:87], v50, s[48:49]
s_add_u32 s48, s48, 4096
s_addc_u32 s49, s49, 0
global_load_dwordx4 v[88:91], v50, s[48:49]
s_add_u32 s48, s48, 4096
s_addc_u32 s49, s49, 0
global_load_dwordx4 v[92:95], v50, s[48:49]
s_add_u32 s48, s48, 4096
s_addc_u32 s49, s49, 0
global_load_dwordx4 v[96:99], v50, s[48:49]
s_add_u32 s48, s48, 4096
s_addc_u32 s49, s49, 0
global_load_dwordx4 v[100:103], v50, s[48:49]
s_add_u32 s48, s48, 4096
s_addc_u32 s49, s49, 0
global_load_dwordx4 v[104:107], v50, s[48:49]
s_add_u32 s48, s48, 4096
s_addc_u32 s49, s49, 0
global_load_dwordx4 v[108:111], v50, s[48:49]
s_add_u32 s48, s48, 4096
s_addc_u32 s49, s49, 0
global_load_dwordx4 v[112:115], v50, s[48:49]
s_add_u32 s48, s48, 4096
s_addc_u32 s49, s49, 0
global_load_dwordx4 v[116:119], v50, s[48:49]
s_add_u32 s48, s48, 4096
s_addc_u32 s49, s49, 0
global_load_dwordx4 v[120:123], v50, s[48:49]
s_add_u32 s48, s48, 4096
s_addc_u32 s49, s49, 0
global_load_dwordx4 v[124:127], v50, s[48:49]
s_add_u32 s48, s48, 4096
s_addc_u32 s49, s49, 0
s_waitcnt vmcnt(8)
ds_write_b128 v49, v[64:67] offset:0
ds_write_b128 v49, v[68:71] offset:1152
ds_write_b128 v49, v[72:75] offset:2304
ds_write_b128 v49, v[76:79] offset:3456
ds_write_b128 v49, v[80:83] offset:4608
ds_write_b128 v49, v[84:87] offset:5760
ds_write_b128 v49, v[88:91] offset:6912
ds_write_b128 v49, v[92:95] offset:8064
s_waitcnt lgkmcnt(0)
ds_read_b64_tr_b16 a[128:129], v48 offset:0
ds_read_b64_tr_b16 a[130:131], v48 offset:4608
ds_read_b64_tr_b16 a[144:145], v48 offset:8
ds_read_b64_tr_b16 a[146:147], v48 offset:4616
ds_read_b64_tr_b16 a[160:161], v48 offset:64
ds_read_b64_tr_b16 a[162:163], v48 offset:4672
ds_read_b64_tr_b16 a[176:177], v48 offset:72
ds_read_b64_tr_b16 a[178:179], v48 offset:4680
ds_read_b64_tr_b16 a[192:193], v48 offset:128
ds_read_b64_tr_b16 a[194:195], v48 offset:4736
ds_read_b64_tr_b16 a[208:209], v48 offset:136
ds_read_b64_tr_b16 a[210:211], v48 offset:4744
ds_read_b64_tr_b16 a[224:225], v48 offset:192
ds_read_b64_tr_b16 a[226:227], v48 offset:4800
ds_read_b64_tr_b16 a[240:241], v48 offset:200
ds_read_b64_tr_b16 a[242:243], v48 offset:4808
s_waitcnt lgkmcnt(0)
s_waitcnt vmcnt(0)
ds_write_b128 v49, v[96:99] offset:0
ds_write_b128 v49, v[100:103] offset:1152
ds_write_b128 v49, v[104:107] offset:2304
ds_write_b128 v49, v[108:111] offset:3456
ds_write_b128 v49, v[112:115] offset:4608
ds_write_b128 v49, v[116:119] offset:5760
ds_write_b128 v49, v[120:123] offset:6912
ds_write_b128 v49, v[124:127] offset:8064
s_waitcnt lgkmcnt(0)
ds_read_b64_tr_b16 a[132:133], v48 offset:0
ds_read_b64_tr_b16 a[134:135], v48 offset:4608
ds_read_b64_tr_b16 a[148:149], v48 offset:8
ds_read_b64_tr_b16 a[150:151], v48 offset:4616
ds_read_b64_tr_b16 a[164:165], v48 offset:64
ds_read_b64_tr_b16 a[166:167], v48 offset:4672
ds_read_b64_tr_b16 a[180:181], v48 offset:72
ds_read_b64_tr_b16 a[182:183], v48 offset:4680
ds_read_b64_tr_b16 a[196:197], v48 offset:128
ds_read_b64_tr_b16 a[198:199], v48 offset:4736
ds_read_b64_tr_b16 a[212:213], v48 offset:136
ds_read_b64_tr_b16 a[214:215], v48 offset:4744
ds_read_b64_tr_b16 a[228:229], v48 offset:192
ds_read_b64_tr_b16 a[230:231], v48 offset:4800
ds_read_b64_tr_b16 a[244:245], v48 offset:200
ds_read_b64_tr_b16 a[246:247], v48 offset:4808
s_waitcnt lgkmcnt(0)
global_load_dwordx4 v[64:67], v50, s[48:49]
s_add_u32 s48, s48, 4096
s_addc_u32 s49, s49, 0
global_load_dwordx4 v[68:71], v50, s[48:49]
s_add_u32 s48, s48, 4096
s_addc_u32 s49, s49, 0
global_load_dwordx4 v[72:75], v50, s[48:49]
s_add_u32 s48, s48, 4096
s_addc_u32 s49, s49, 0
global_load_dwordx4 v[76:79], v50, s[48:49]
s_add_u32 s48, s48, 4096
s_addc_u32 s49, s49, 0
global_load_dwordx4 v[80:83], v50, s[48:49]
s_add_u32 s48, s48, 4096
s_addc_u32 s49, s49, 0
global_load_dwordx4 v[84:87], v50, s[48:49]
s_add_u32 s48, s48, 4096
s_addc_u32 s49, s49, 0
global_load_dwordx4 v[88:91], v50, s[48:49]
s_add_u32 s48, s48, 4096
s_addc_u32 s49, s49, 0
global_load_dwordx4 v[92:95], v50, s[48:49]
s_add_u32 s48, s48, 4096
s_addc_u32 s49, s49, 0
global_load_dwordx4 v[96:99], v50, s[48:49]
s_add_u32 s48, s48, 4096
s_addc_u32 s49, s49, 0
global_load_dwordx4 v[100:103], v50, s[48:49]
s_add_u32 s48, s48, 4096
s_addc_u32 s49, s49, 0
global_load_dwordx4 v[104:107], v50, s[48:49]
s_add_u32 s48, s48, 4096
s_addc_u32 s49, s49, 0
global_load_dwordx4 v[108:111], v50, s[48:49]
s_add_u32 s48, s48, 4096
s_addc_u32 s49, s49, 0
global_load_dwordx4 v[112:115], v50, s[48:49]
s_add_u32 s48, s48, 4096
s_addc_u32 s49, s49, 0
global_load_dwordx4 v[116:119], v50, s[48:49]
s_add_u32 s48, s48, 4096
s_addc_u32 s49, s49, 0
global_load_dwordx4 v[120:123], v50, s[48:49]
s_add_u32 s48, s48, 4096
s_addc_u32 s49, s49, 0
global_load_dwordx4 v[124:127], v50, s[48:49]
s_add_u32 s48, s48, 4096
s_addc_u32 s49, s49, 0
s_waitcnt vmcnt(8)
ds_write_b128 v49, v[64:67] offset:0
ds_write_b128 v49, v[68:71] offset:1152
ds_write_b128 v49, v[72:75] offset:2304
ds_write_b128 v49, v[76:79] offset:3456
ds_write_b128 v49, v[80:83] offset:4608
ds_write_b128 v49, v[84:87] offset:5760
ds_write_b128 v49, v[88:91] offset:6912
ds_write_b128 v49, v[92:95] offset:8064
s_waitcnt lgkmcnt(0)
ds_read_b64_tr_b16 a[136:137], v48 offset:0
ds_read_b64_tr_b16 a[138:139], v48 offset:4608
ds_read_b64_tr_b16 a[152:153], v48 offset:8
ds_read_b64_tr_b16 a[154:155], v48 offset:4616
ds_read_b64_tr_b16 a[168:169], v48 offset:64
ds_read_b64_tr_b16 a[170:171], v48 offset:4672
ds_read_b64_tr_b16 a[184:185], v48 offset:72
ds_read_b64_tr_b16 a[186:187], v48 offset:4680
ds_read_b64_tr_b16 a[200:201], v48 offset:128
ds_read_b64_tr_b16 a[202:203], v48 offset:4736
ds_read_b64_tr_b16 a[216:217], v48 offset:136
ds_read_b64_tr_b16 a[218:219], v48 offset:4744
ds_read_b64_tr_b16 a[232:233], v48 offset:192
ds_read_b64_tr_b16 a[234:235], v48 offset:4800
ds_read_b64_tr_b16 a[248:249], v48 offset:200
ds_read_b64_tr_b16 a[250:251], v48 offset:4808
s_waitcnt lgkmcnt(0)
s_waitcnt vmcnt(0)
ds_write_b128 v49, v[96:99] offset:0
ds_write_b128 v49, v[100:103] offset:1152
ds_write_b128 v49, v[104:107] offset:2304
ds_write_b128 v49, v[108:111] offset:3456
ds_write_b128 v49, v[112:115] offset:4608
ds_write_b128 v49, v[116:119] offset:5760
ds_write_b128 v49, v[120:123] offset:6912
ds_write_b128 v49, v[124:127] offset:8064
s_waitcnt lgkmcnt(0)
ds_read_b64_tr_b16 a[140:141], v48 offset:0
ds_read_b64_tr_b16 a[142:143], v48 offset:4608
ds_read_b64_tr_b16 a[156:157], v48 offset:8
ds_read_b64_tr_b16 a[158:159], v48 offset:4616
ds_read_b64_tr_b16 a[172:173], v48 offset:64
ds_read_b64_tr_b16 a[174:175], v48 offset:4672
ds_read_b64_tr_b16 a[188:189], v48 offset:72
ds_read_b64_tr_b16 a[190:191], v48 offset:4680
ds_read_b64_tr_b16 a[204:205], v48 offset:128
ds_read_b64_tr_b16 a[206:207], v48 offset:4736
ds_read_b64_tr_b16 a[220:221], v48 offset:136
ds_read_b64_tr_b16 a[222:223], v48 offset:4744
ds_read_b64_tr_b16 a[236:237], v48 offset:192
ds_read_b64_tr_b16 a[238:239], v48 offset:4800
ds_read_b64_tr_b16 a[252:253], v48 offset:200
ds_read_b64_tr_b16 a[254:255], v48 offset:4808
s_waitcnt lgkmcnt(0)
s_mul_i32 s46, s32, 3
s_lshl_b32 s47, s32, 1
s_add_u32 s47, s47, 22
s_cmp_lt_u32 s32, 22
s_cselect_b32 s76, s46, s47
s_cselect_b32 s77, 1, 0
s_lshl_b32 s46, s76, 14
s_add_u32 s48, s18, s46
s_addc_u32 s49, s19, 0
global_load_dwordx4 v[64:67], v50, s[48:49]
s_add_u32 s48, s48, 4096
s_addc_u32 s49, s49, 0
global_load_dwordx4 v[68:71], v50, s[48:49]
s_add_u32 s48, s48, 4096
s_addc_u32 s49, s49, 0
global_load_dwordx4 v[72:75], v50, s[48:49]
s_add_u32 s48, s48, 4096
s_addc_u32 s49, s49, 0
global_load_dwordx4 v[76:79], v50, s[48:49]
s_add_u32 s48, s48, 4096
s_addc_u32 s49, s49, 0
global_load_dwordx4 v[80:83], v50, s[48:49]
s_add_u32 s48, s48, 4096
s_addc_u32 s49, s49, 0
global_load_dwordx4 v[84:87], v50, s[48:49]
s_add_u32 s48, s48, 4096
s_addc_u32 s49, s49, 0
global_load_dwordx4 v[88:91], v50, s[48:49]
s_add_u32 s48, s48, 4096
s_addc_u32 s49, s49, 0
global_load_dwordx4 v[92:95], v50, s[48:49]
s_add_u32 s48, s48, 4096
s_addc_u32 s49, s49, 0
v_mov_b32 v96, 0
v_mov_b32 v97, 0
v_mov_b32 v98, 0
v_mov_b32 v99, 0
v_mov_b32 v100, 0
v_mov_b32 v101, 0
v_mov_b32 v102, 0
v_mov_b32 v103, 0
v_mov_b32 v104, 0
v_mov_b32 v105, 0
v_mov_b32 v106, 0
v_mov_b32 v107, 0
v_mov_b32 v108, 0
v_mov_b32 v109, 0
v_mov_b32 v110, 0
v_mov_b32 v111, 0
s_cmp_eq_u32 s77, 0
s_cbranch_scc1 L_o_no3
global_load_dwordx4 v[96:99], v50, s[48:49]
s_add_u32 s48, s48, 4096
s_addc_u32 s49, s49, 0
global_load_dwordx4 v[100:103], v50, s[48:49]
s_add_u32 s48, s48, 4096
s_addc_u32 s49, s49, 0
global_load_dwordx4 v[104:107], v50, s[48:49]
s_add_u32 s48, s48, 4096
s_addc_u32 s49, s49, 0
global_load_dwordx4 v[108:111], v50, s[48:49]
s_add_u32 s48, s48, 4096
s_addc_u32 s49, s49, 0
L_o_no3:
s_waitcnt vmcnt(0)
ds_write_b128 v49, v[64:67] offset:0
ds_write_b128 v49, v[68:71] offset:1152
ds_write_b128 v49, v[72:75] offset:2304
ds_write_b128 v49, v[76:79] offset:3456
ds_write_b128 v49, v[80:83] offset:4608
ds_write_b128 v49, v[84:87] offset:5760
ds_write_b128 v49, v[88:91] offset:6912
ds_write_b128 v49, v[92:95] offset:8064
ds_write_b128 v49, v[96:99] offset:9216
ds_write_b128 v49, v[100:103] offset:10368
ds_write_b128 v49, v[104:107] offset:11520
ds_write_b128 v49, v[108:111] offset:12672
s_waitcnt lgkmcnt(0)
ds_read_b64_tr_b16 v[208:209], v48 offset:0
ds_read_b64_tr_b16 v[210:211], v48 offset:4608
ds_read_b64_tr_b16 v[212:213], v48 offset:9216
ds_read_b64_tr_b16 v[214:215], v48 offset:8
ds_read_b64_tr_b16 v[216:217], v48 offset:4616
ds_read_b64_tr_b16 v[218:219], v48 offset:9224
ds_read_b64_tr_b16 v[220:221], v48 offset:64
ds_read_b64_tr_b16 v[222:223], v48 offset:4672
ds_read_b64_tr_b16 v[224:225], v48 offset:9280
ds_read_b64_tr_b16 v[226:227], v48 offset:72
ds_read_b64_tr_b16 v[228:229], v48 offset:4680
ds_read_b64_tr_b16 v[230:231], v48 offset:9288
ds_read_b64_tr_b16 v[232:233], v48 offset:128
ds_read_b64_tr_b16 v[234:235], v48 offset:4736
ds_read_b64_tr_b16 v[236:237], v48 offset:9344
ds_read_b64_tr_b16 v[238:239], v48 offset:136
ds_read_b64_tr_b16 v[240:241], v48 offset:4744
ds_read_b64_tr_b16 v[242:243], v48 offset:9352
ds_read_b64_tr_b16 v[244:245], v48 offset:192
ds_read_b64_tr_b16 v[246:247], v48 offset:4800
ds_read_b64_tr_b16 v[248:249], v48 offset:9408
ds_read_b64_tr_b16 v[250:251], v48 offset:200
ds_read_b64_tr_b16 v[252:253], v48 offset:4808
ds_read_b64_tr_b16 v[254:255], v48 offset:9416
s_waitcnt lgkmcnt(0)
s_barrier
s_cmp_eq_u32 s29, 3
s_cbranch_scc1 L_o_gate
s_cmp_eq_u32 s29, 2
s_cselect_b32 s46, s77, 1
s_cmp_eq_u32 s46, 0
s_cbranch_scc1 L_o_zero
v_lshrrev_b32 v51, 1, v0
v_mul_u32_u24 v50, 2752, v51
v_and_b32 v52, 1, v0
v_lshlrev_b32 v52, 4, v52
v_add_u32 v50, v50, v52
s_add_u32 s46, s76, s29
s_lshl_b32 s46, s46, 5
s_add_u32 s48, s16, s46
s_addc_u32 s49, s17, 0
s_mul_i32 s34, s29, 6144
s_add_u32 s34, s34, 33792
v_mul_u32_u24 v49, 48, v51
v_add_u32 v49, v49, v52
v_add_u32 v49, s34, v49
v_lshlrev_b32 v53, 3, v40
v_add_u32 v53, v53, v42
v_mul_u32_u24 v48, 48, v53
v_lshlrev_b32 v54, 3, v43
v_add_u32 v48, v48, v54
v_add_u32 v48, s34, v48
global_load_dwordx4 v[64:67], v50, s[48:49]
s_add_u32 s48, s48, 88064
s_addc_u32 s49, s49, 0
global_load_dwordx4 v[68:71], v50, s[48:49]
s_add_u32 s48, s48, 88064
s_addc_u32 s49, s49, 0
global_load_dwordx4 v[72:75], v50, s[48:49]
s_add_u32 s48, s48, 88064
s_addc_u32 s49, s49, 0
global_load_dwordx4 v[76:79], v50, s[48:49]
s_add_u32 s48, s48, 88064
s_addc_u32 s49, s49, 0
global_load_dwordx4 v[80:83], v50, s[48:49]
s_add_u32 s48, s48, 88064
s_addc_u32 s49, s49, 0
global_load_dwordx4 v[84:87], v50, s[48:49]
s_add_u32 s48, s48, 88064
s_addc_u32 s49, s49, 0
global_load_dwordx4 v[88:91], v50, s[48:49]
s_add_u32 s48, s48, 88064
s_addc_u32 s49, s49, 0
global_load_dwordx4 v[92:95], v50, s[48:49]
s_add_u32 s48, s48, 88064
s_addc_u32 s49, s49, 0
global_load_dwordx4 v[96:99], v50, s[48:49]
s_add_u32 s48, s48, 88064
s_addc_u32 s49, s49, 0
global_load_dwordx4 v[100:103], v50, s[48:49]
s_add_u32 s48, s48, 88064
s_addc_u32 s49, s49, 0
global_load_dwordx4 v[104:107], v50, s[48:49]
s_add_u32 s48, s48, 88064
s_addc_u32 s49, s49, 0
global_load_dwordx4 v[108:111], v50, s[48:49]
s_add_u32 s48, s48, 88064
s_addc_u32 s49, s49, 0
global_load_dwordx4 v[112:115], v50, s[48:49]
s_add_u32 s48, s48, 88064
s_addc_u32 s49, s49, 0
global_load_dwordx4 v[116:119], v50, s[48:49]
s_add_u32 s48, s48, 88064
s_addc_u32 s49, s49, 0
global_load_dwordx4 v[120:123], v50, s[48:49]
s_add_u32 s48, s48, 88064
s_addc_u32 s49, s49, 0
global_load_dwordx4 v[124:127], v50, s[48:49]
s_add_u32 s48, s48, 88064
s_addc_u32 s49, s49, 0
s_waitcnt vmcnt(12)
ds_write_b128 v49, v[64:67] offset:0
ds_write_b128 v49, v[68:71] offset:1536
ds_write_b128 v49, v[72:75] offset:3072
ds_write_b128 v49, v[76:79] offset:4608
s_waitcnt lgkmcnt(0)
ds_read_b64_tr_b16 v[144:145], v48 offset:0
ds_read_b64_tr_b16 v[146:147], v48 offset:192
ds_read_b64_tr_b16 v[148:149], v48 offset:1536
ds_read_b64_tr_b16 v[150:151], v48 offset:1728
ds_read_b64_tr_b16 v[152:153], v48 offset:3072
ds_read_b64_tr_b16 v[154:155], v48 offset:3264
ds_read_b64_tr_b16 v[156:157], v48 offset:4608
ds_read_b64_tr_b16 v[158:159], v48 offset:4800
s_waitcnt lgkmcnt(0)
ds_write_b128 v3, v[144:147] offset:0
ds_write_b128 v3, v[148:151] offset:1024
ds_write_b128 v3, v[152:155] offset:2048
ds_write_b128 v3, v[156:159] offset:3072
s_waitcnt lgkmcnt(0)
s_waitcnt vmcnt(8)
ds_write_b128 v49, v[80:83] offset:0
ds_write_b128 v49, v[84:87] offset:1536
ds_write_b128 v49, v[88:91] offset:3072
ds_write_b128 v49, v[92:95] offset:4608
s_waitcnt lgkmcnt(0)
ds_read_b64_tr_b16 v[144:145], v48 offset:0
ds_read_b64_tr_b16 v[146:147], v48 offset:192
ds_read_b64_tr_b16 v[148:149], v48 offset:1536
ds_read_b64_tr_b16 v[150:151], v48 offset:1728
ds_read_b64_tr_b16 v[152:153], v48 offset:3072
ds_read_b64_tr_b16 v[154:155], v48 offset:3264
ds_read_b64_tr_b16 v[156:157], v48 offset:4608
ds_read_b64_tr_b16 v[158:159], v48 offset:4800
s_waitcnt lgkmcnt(0)
ds_write_b128 v3, v[144:147] offset:4096
ds_write_b128 v3, v[148:151] offset:5120
ds_write_b128 v3, v[152:155] offset:6144
ds_write_b128 v3, v[156:159] offset:7168
s_waitcnt lgkmcnt(0)
s_waitcnt vmcnt(4)
ds_write_b128 v49, v[96:99] offset:0
ds_write_b128 v49, v[100:103] offset:1536
ds_write_b128 v49, v[104:107] offset:3072
ds_write_b128 v49, v[108:111] offset:4608
s_waitcnt lgkmcnt(0)
ds_read_b64_tr_b16 v[144:145], v48 offset:0
ds_read_b64_tr_b16 v[146:147], v48 offset:192
ds_read_b64_tr_b16 v[148:149], v48 offset:1536
ds_read_b64_tr_b16 v[150:151], v48 offset:1728
ds_read_b64_tr_b16 v[152:153], v48 offset:3072
ds_read_b64_tr_b16 v[154:155], v48 offset:3264
ds_read_b64_tr_b16 v[156:157], v48 offset:4608
ds_read_b64_tr_b16 v[158:159], v48 offset:4800
s_waitcnt lgkmcnt(0)
ds_write_b128 v3, v[144:147] offset:8192
ds_write_b128 v3, v[148:151] offset:9216
ds_write_b128 v3, v[152:155] offset:10240
ds_write_b128 v3, v[156:159] offset:11264
s_waitcnt lgkmcnt(0)
s_waitcnt vmcnt(0)
ds_write_b128 v49, v[112:115] offset:0
ds_write_b128 v49, v[116:119] offset:1536
ds_write_b128 v49, v[120:123] offset:3072
ds_write_b128 v49, v[124:127] offset:4608
s_waitcnt lgkmcnt(0)
ds_read_b64_tr_b16 v[144:145], v48 offset:0
ds_read_b64_tr_b16 v[146:147], v48 offset:192
ds_read_b64_tr_b16 v[148:149], v48 offset:1536
ds_read_b64_tr_b16 v[150:151], v48 offset:1728
ds_read_b64_tr_b16 v[152:153], v48 offset:3072
ds_read_b64_tr_b16 v[154:155], v48 offset:3264
ds_read_b64_tr_b16 v[156:157], v48 offset:4608
ds_read_b64_tr_b16 v[158:159], v48 offset:4800
s_waitcnt lgkmcnt(0)
ds_write_b128 v3, v[144:147] offset:12288
ds_write_b128 v3, v[148:151] offset:13312
ds_write_b128 v3, v[152:155] offset:14336
ds_write_b128 v3, v[156:159] offset:15360
s_waitcnt lgkmcnt(0)
s_branch L_o_w1done
L_o_zero:
v_mov_b32 v144, 0
v_mov_b32 v145, 0
v_mov_b32 v146, 0
v_mov_b32 v147, 0
ds_write_b128 v3, v[144:147] offset:0
ds_write_b128 v3, v[144:147] offset:1024
ds_write_b128 v3, v[144:147] offset:2048
ds_write_b128 v3, v[144:147] offset:3072
ds_write_b128 v3, v[144:147] offset:4096
ds_write_b128 v3, v[144:147] offset:5120
ds_write_b128 v3, v[144:147] offset:6144
ds_write_b128 v3, v[144:147] offset:7168
ds_write_b128 v3, v[144:147] offset:8192
ds_write_b128 v3, v[144:147] offset:9216
ds_write_b128 v3, v[144:147] offset:10240
ds_write_b128 v3, v[144:147] offset:11264
ds_write_b128 v3, v[144:147] offset:12288
ds_write_b128 v3, v[144:147] offset:13312
ds_write_b128 v3, v[144:147] offset:14336
ds_write_b128 v3, v[144:147] offset:15360
s_branch L_o_w1done
L_o_gate:
v_lshlrev_b32 v50, 4, v40
global_load_dwordx4 v[64:67], v50, s[20:21] offset:0
global_load_dwordx4 v[68:71], v50, s[20:21] offset:64
global_load_dwordx4 v[72:75], v50, s[20:21] offset:128
global_load_dwordx4 v[76:79], v50, s[20:21] offset:192
global_load_dwordx4 v[80:83], v50, s[20:21] offset:256
global_load_dwordx4 v[84:87], v50, s[20:21] offset:320
global_load_dwordx4 v[88:91], v50, s[20:21] offset:384
global_load_dwordx4 v[92:95], v50, s[20:21] offset:448
global_load_dwordx4 v[96:99], v50, s[20:21] offset:512
global_load_dwordx4 v[100:103], v50, s[20:21] offset:576
global_load_dwordx4 v[104:107], v50, s[20:21] offset:640
global_load_dwordx4 v[108:111], v50, s[20:21] offset:704
global_load_dwordx4 v[112:115], v50, s[20:21] offset:768
global_load_dwordx4 v[116:119], v50, s[20:21] offset:832
global_load_dwordx4 v[120:123], v50, s[20:21] offset:896
global_load_dwordx4 v[124:127], v50, s[20:21] offset:960
s_waitcnt vmcnt(0)
ds_write_b128 v3, v[64:67] offset:0
ds_write_b128 v3, v[68:71] offset:1024
ds_write_b128 v3, v[72:75] offset:2048
ds_write_b128 v3, v[76:79] offset:3072
ds_write_b128 v3, v[80:83] offset:4096
ds_write_b128 v3, v[84:87] offset:5120
ds_write_b128 v3, v[88:91] offset:6144
ds_write_b128 v3, v[92:95] offset:7168
ds_write_b128 v3, v[96:99] offset:8192
ds_write_b128 v3, v[100:103] offset:9216
ds_write_b128 v3, v[104:107] offset:10240
ds_write_b128 v3, v[108:111] offset:11264
ds_write_b128 v3, v[112:115] offset:12288
ds_write_b128 v3, v[116:119] offset:13312
ds_write_b128 v3, v[120:123] offset:14336
ds_write_b128 v3, v[124:127] offset:15360
L_o_w1done:
s_waitcnt vmcnt(0) lgkmcnt(0)
s_barrier
s_mov_b32 s43, 0
v_lshlrev_b32 v142, 2, v0
L_sb_poll_out:
global_load_dword v143, v142, s[24:25] sc1
s_add_u32 s43, s43, 1
s_waitcnt vmcnt(0)
v_readlane_b32 s34, v143, 0
v_readlane_b32 s35, v143, 1
v_readlane_b32 s36, v143, 32
v_readlane_b32 s37, v143, 48
s_lshl_b32 s36, s36, 8
s_add_u32 s36, s36, s37
s_lshr_b32 s37, s35, 16
s_lshl_b32 s37, s37, 16
s_add_u32 s36, s36, s37
s_cmp_eq_u32 s36, 2121856
s_cbranch_scc1 L_sb_done_out
s_cmp_lt_u32 s43, 400000
s_cbranch_scc1 L_sb_poll_out
L_sb_done_out:
s_mov_b32 s56, 0
L_o_loop:
s_add_u32 s57, s54, 4
s_xor_b32 s58, s55, 33792
s_cmp_lt_u32 s57, 64
s_cbranch_scc0 L_o_nopf
s_lshl_b32 s50, s57, 15
s_add_u32 s50, s4, s50
s_addc_u32 s51, s5, 0
s_mul_i32 s52, s29, 8448
s_add_u32 s52, s52, s58
s_add_u32 m0, s52, 0
s_nop 0
global_load_lds_dwordx4 v1, s[50:51] offset:0
s_add_u32 m0, s52, 32
s_nop 0
global_load_lds_dwordx4 v1, s[50:51] offset:1024
s_add_u32 m0, s52, 64
s_nop 0
global_load_lds_dwordx4 v1, s[50:51] offset:2048
s_add_u32 m0, s52, 96
s_nop 0
global_load_lds_dwordx4 v1, s[50:51] offset:3072
s_add_u32 s50, s50, 4096
s_addc_u32 s51, s51, 0
s_add_u32 m0, s52, 4224
s_nop 0
global_load_lds_dwordx4 v1, s[50:51] offset:0
s_add_u32 m0, s52, 4256
s_nop 0
global_load_lds_dwordx4 v1, s[50:51] offset:1024
s_add_u32 m0, s52, 4288
s_nop 0
global_load_lds_dwordx4 v1, s[50:51] offset:2048
s_add_u32 m0, s52, 4320
s_nop 0
global_load_lds_dwordx4 v1, s[50:51] offset:3072
L_o_nopf:
v_add_u32 v112, s55, v2
ds_read_b128 v[40:43], v112 offset:0
ds_read_b128 v[44:47], v112 offset:16896
ds_read_b128 v[72:75], v3 offset:0
ds_read_b128 v[48:51], v112 offset:64
ds_read_b128 v[52:55], v112 offset:16960
ds_read_b128 v[76:79], v3 offset:1024
ds_read_b128 v[56:59], v112 offset:128
ds_read_b128 v[60:63], v112 offset:17024
ds_read_b128 v[80:83], v3 offset:2048
ds_read_b128 v[64:67], v112 offset:192
ds_read_b128 v[68:71], v112 offset:17088
ds_read_b128 v[84:87], v3 offset:3072
s_waitcnt lgkmcnt(9)
v_mfma_f32_16x16x32_bf16 v[88:91], a[0:3], v[40:43], 0
v_mfma_f32_16x16x32_bf16 v[92:95], a[0:3], v[44:47], 0
v_mfma_f32_16x16x32_bf16 v[96:99], a[64:67], v[40:43], 0
v_mfma_f32_16x16x32_bf16 v[100:103], a[64:67], v[44:47], 0
v_mfma_f32_16x16x32_bf16 v[104:107], v[72:75], v[40:43], 0
v_mfma_f32_16x16x32_bf16 v[108:111], v[72:75], v[44:47], 0
ds_read_b128 v[40:43], v112 offset:256
ds_read_b128 v[44:47], v112 offset:17152
ds_read_b128 v[72:75], v3 offset:4096
s_waitcnt lgkmcnt(9)
v_mfma_f32_16x16x32_bf16 v[88:91], a[4:7], v[48:51], v[88:91]
v_mfma_f32_16x16x32_bf16 v[92:95], a[4:7], v[52:55], v[92:95]
v_mfma_f32_16x16x32_bf16 v[96:99], a[68:71], v[48:51], v[96:99]
v_mfma_f32_16x16x32_bf16 v[100:103], a[68:71], v[52:55], v[100:103]
v_mfma_f32_16x16x32_bf16 v[104:107], v[76:79], v[48:51], v[104:107]
v_mfma_f32_16x16x32_bf16 v[108:111], v[76:79], v[52:55], v[108:111]
ds_read_b128 v[48:51], v112 offset:320
ds_read_b128 v[52:55], v112 offset:17216
ds_read_b128 v[76:79], v3 offset:5120
s_waitcnt lgkmcnt(9)
v_mfma_f32_16x16x32_bf16 v[88:91], a[8:11], v[56:59], v[88:91]
v_mfma_f32_16x16x32_bf16 v[92:95], a[8:11], v[60:63], v[92:95]
v_mfma_f32_16x16x32_bf16 v[96:99], a[72:75], v[56:59], v[96:99]
v_mfma_f32_16x16x32_bf16 v[100:103], a[72:75], v[60:63], v[100:103]
v_mfma_f32_16x16x32_bf16 v[104:107], v[80:83], v[56:59], v[104:107]
v_mfma_f32_16x16x32_bf16 v[108:111], v[80:83], v[60:63], v[108:111]
ds_read_b128 v[56:59], v112 offset:384
ds_read_b128 v[60:63], v112 offset:17280
ds_read_b128 v[80:83], v3 offset:6144
s_waitcnt lgkmcnt(9)
v_mfma_f32_16x16x32_bf16 v[88:91], a[12:15], v[64:67], v[88:91]
v_mfma_f32_16x16x32_bf16 v[92:95], a[12:15], v[68:71], v[92:95]
v_mfma_f32_16x16x32_bf16 v[96:99], a[76:79], v[64:67], v[96:99]
v_mfma_f32_16x16x32_bf16 v[100:103], a[76:79], v[68:71], v[100:103]
v_mfma_f32_16x16x32_bf16 v[104:107], v[84:87], v[64:67], v[104:107]
v_mfma_f32_16x16x32_bf16 v[108:111], v[84:87], v[68:71], v[108:111]
ds_read_b128 v[64:67], v112 offset:448
ds_read_b128 v[68:71], v112 offset:17344
ds_read_b128 v[84:87], v3 offset:7168
s_waitcnt lgkmcnt(9)
v_mfma_f32_16x16x32_bf16 v[88:91], a[16:19], v[40:43], v[88:91]
v_mfma_f32_16x16x32_bf16 v[92:95], a[16:19], v[44:47], v[92:95]
v_mfma_f32_16x16x32_bf16 v[96:99], a[80:83], v[40:43], v[96:99]
v_mfma_f32_16x16x32_bf16 v[100:103], a[80:83], v[44:47], v[100:103]
v_mfma_f32_16x16x32_bf16 v[104:107], v[72:75], v[40:43], v[104:107]
v_mfma_f32_16x16x32_bf16 v[108:111], v[72:75], v[44:47], v[108:111]
ds_read_b128 v[40:43], v112 offset:512
ds_read_b128 v[44:47], v112 offset:17408
ds_read_b128 v[72:75], v3 offset:8192
s_waitcnt lgkmcnt(9)
v_mfma_f32_16x16x32_bf16 v[88:91], a[20:23], v[48:51], v[88:91]
v_mfma_f32_16x16x32_bf16 v[92:95], a[20:23], v[52:55], v[92:95]
v_mfma_f32_16x16x32_bf16 v[96:99], a[84:87], v[48:51], v[96:99]
v_mfma_f32_16x16x32_bf16 v[100:103], a[84:87], v[52:55], v[100:103]
v_mfma_f32_16x16x32_bf16 v[104:107], v[76:79], v[48:51], v[104:107]
v_mfma_f32_16x16x32_bf16 v[108:111], v[76:79], v[52:55], v[108:111]
ds_read_b128 v[48:51], v112 offset:576
ds_read_b128 v[52:55], v112 offset:17472
ds_read_b128 v[76:79], v3 offset:9216
s_waitcnt lgkmcnt(9)
v_mfma_f32_16x16x32_bf16 v[88:91], a[24:27], v[56:59], v[88:91]
v_mfma_f32_16x16x32_bf16 v[92:95], a[24:27], v[60:63], v[92:95]
v_mfma_f32_16x16x32_bf16 v[96:99], a[88:91], v[56:59], v[96:99]
v_mfma_f32_16x16x32_bf16 v[100:103], a[88:91], v[60:63], v[100:103]
v_mfma_f32_16x16x32_bf16 v[104:107], v[80:83], v[56:59], v[104:107]
v_mfma_f32_16x16x32_bf16 v[108:111], v[80:83], v[60:63], v[108:111]
ds_read_b128 v[56:59], v112 offset:640
ds_read_b128 v[60:63], v112 offset:17536
ds_read_b128 v[80:83], v3 offset:10240
s_waitcnt lgkmcnt(9)
v_mfma_f32_16x16x32_bf16 v[88:91], a[28:31], v[64:67], v[88:91]
v_mfma_f32_16x16x32_bf16 v[92:95], a[28:31], v[68:71], v[92:95]
v_mfma_f32_16x16x32_bf16 v[96:99], a[92:95], v[64:67], v[96:99]
v_mfma_f32_16x16x32_bf16 v[100:103], a[92:95], v[68:71], v[100:103]
v_mfma_f32_16x16x32_bf16 v[104:107], v[84:87], v[64:67], v[104:107]
v_mfma_f32_16x16x32_bf16 v[108:111], v[84:87], v[68:71], v[108:111]
ds_read_b128 v[64:67], v112 offset:704
ds_read_b128 v[68:71], v112 offset:17600
ds_read_b128 v[84:87], v3 offset:11264
s_waitcnt lgkmcnt(9)
v_mfma_f32_16x16x32_bf16 v[88:91], a[32:35], v[40:43], v[88:91]
v_mfma_f32_16x16x32_bf16 v[92:95], a[32:35], v[44:47], v[92:95]
v_mfma_f32_16x16x32_bf16 v[96:99], a[96:99], v[40:43], v[96:99]
v_mfma_f32_16x16x32_bf16 v[100:103], a[96:99], v[44:47], v[100:103]
v_mfma_f32_16x16x32_bf16 v[104:107], v[72:75], v[40:43], v[104:107]
v_mfma_f32_16x16x32_bf16 v[108:111], v[72:75], v[44:47], v[108:111]
ds_read_b128 v[40:43], v112 offset:768
ds_read_b128 v[44:47], v112 offset:17664
ds_read_b128 v[72:75], v3 offset:12288
s_waitcnt lgkmcnt(9)
v_mfma_f32_16x16x32_bf16 v[88:91], a[36:39], v[48:51], v[88:91]
v_mfma_f32_16x16x32_bf16 v[92:95], a[36:39], v[52:55], v[92:95]
v_mfma_f32_16x16x32_bf16 v[96:99], a[100:103], v[48:51], v[96:99]
v_mfma_f32_16x16x32_bf16 v[100:103], a[100:103], v[52:55], v[100:103]
v_mfma_f32_16x16x32_bf16 v[104:107], v[76:79], v[48:51], v[104:107]
v_mfma_f32_16x16x32_bf16 v[108:111], v[76:79], v[52:55], v[108:111]
ds_read_b128 v[48:51], v112 offset:832
ds_read_b128 v[52:55], v112 offset:17728
ds_read_b128 v[76:79], v3 offset:13312
s_waitcnt lgkmcnt(9)
v_mfma_f32_16x16x32_bf16 v[88:91], a[40:43], v[56:59], v[88:91]
v_mfma_f32_16x16x32_bf16 v[92:95], a[40:43], v[60:63], v[92:95]
v_mfma_f32_16x16x32_bf16 v[96:99], a[104:107], v[56:59], v[96:99]
v_mfma_f32_16x16x32_bf16 v[100:103], a[104:107], v[60:63], v[100:103]
v_mfma_f32_16x16x32_bf16 v[104:107], v[80:83], v[56:59], v[104:107]
v_mfma_f32_16x16x32_bf16 v[108:111], v[80:83], v[60:63], v[108:111]
ds_read_b128 v[56:59], v112 offset:896
ds_read_b128 v[60:63], v112 offset:17792
ds_read_b128 v[80:83], v3 offset:14336
s_waitcnt lgkmcnt(9)
v_mfma_f32_16x16x32_bf16 v[88:91], a[44:47], v[64:67], v[88:91]
v_mfma_f32_16x16x32_bf16 v[92:95], a[44:47], v[68:71], v[92:95]
v_mfma_f32_16x16x32_bf16 v[96:99], a[108:111], v[64:67], v[96:99]
v_mfma_f32_16x16x32_bf16 v[100:103], a[108:111], v[68:71], v[100:103]
v_mfma_f32_16x16x32_bf16 v[104:107], v[84:87], v[64:67], v[104:107]
v_mfma_f32_16x16x32_bf16 v[108:111], v[84:87], v[68:71], v[108:111]
ds_read_b128 v[64:67], v112 offset:960
ds_read_b128 v[68:71], v112 offset:17856
ds_read_b128 v[84:87], v3 offset:15360
s_waitcnt lgkmcnt(9)
v_mfma_f32_16x16x32_bf16 v[88:91], a[48:51], v[40:43], v[88:91]
v_mfma_f32_16x16x32_bf16 v[92:95], a[48:51], v[44:47], v[92:95]
v_mfma_f32_16x16x32_bf16 v[96:99], a[112:115], v[40:43], v[96:99]
v_mfma_f32_16x16x32_bf16 v[100:103], a[112:115], v[44:47], v[100:103]
v_mfma_f32_16x16x32_bf16 v[104:107], v[72:75], v[40:43], v[104:107]
v_mfma_f32_16x16x32_bf16 v[108:111], v[72:75], v[44:47], v[108:111]
s_waitcnt lgkmcnt(6)
v_mfma_f32_16x16x32_bf16 v[88:91], a[52:55], v[48:51], v[88:91]
v_mfma_f32_16x16x32_bf16 v[92:95], a[52:55], v[52:55], v[92:95]
v_mfma_f32_16x16x32_bf16 v[96:99], a[116:119], v[48:51], v[96:99]
v_mfma_f32_16x16x32_bf16 v[100:103], a[116:119], v[52:55], v[100:103]
v_mfma_f32_16x16x32_bf16 v[104:107], v[76:79], v[48:51], v[104:107]
v_mfma_f32_16x16x32_bf16 v[108:111], v[76:79], v[52:55], v[108:111]
s_waitcnt lgkmcnt(3)
v_mfma_f32_16x16x32_bf16 v[88:91], a[56:59], v[56:59], v[88:91]
v_mfma_f32_16x16x32_bf16 v[92:95], a[56:59], v[60:63], v[92:95]
v_mfma_f32_16x16x32_bf16 v[96:99], a[120:123], v[56:59], v[96:99]
v_mfma_f32_16x16x32_bf16 v[100:103], a[120:123], v[60:63], v[100:103]
v_mfma_f32_16x16x32_bf16 v[104:107], v[80:83], v[56:59], v[104:107]
v_mfma_f32_16x16x32_bf16 v[108:111], v[80:83], v[60:63], v[108:111]
s_waitcnt lgkmcnt(0)
v_mfma_f32_16x16x32_bf16 v[88:91], a[60:63], v[64:67], v[88:91]
v_mfma_f32_16x16x32_bf16 v[92:95], a[60:63], v[68:71], v[92:95]
v_mfma_f32_16x16x32_bf16 v[96:99], a[124:127], v[64:67], v[96:99]
v_mfma_f32_16x16x32_bf16 v[100:103], a[124:127], v[68:71], v[100:103]
v_mfma_f32_16x16x32_bf16 v[104:107], v[84:87], v[64:67], v[104:107]
v_mfma_f32_16x16x32_bf16 v[108:111], v[84:87], v[68:71], v[108:111]
v_cvt_pk_bf16_f32 v40, v88, v89
v_cvt_pk_bf16_f32 v41, v90, v91
v_cvt_pk_bf16_f32 v42, v96, v97
v_cvt_pk_bf16_f32 v43, v98, v99
ds_write_b128 v4, v[40:43] offset:0
v_cvt_pk_bf16_f32 v44, v92, v93
v_cvt_pk_bf16_f32 v45, v94, v95
v_cvt_pk_bf16_f32 v46, v100, v101
v_cvt_pk_bf16_f32 v47, v102, v103
ds_write_b128 v4, v[44:47] offset:1024
s_mov_b32 s46, 0xbfb8aa3b
v_mul_f32 v72, s46, v104
v_mul_f32 v73, s46, v105
v_mul_f32 v74, s46, v106
v_mul_f32 v75, s46, v107
v_mul_f32 v76, s46, v108
v_mul_f32 v77, s46, v109
v_mul_f32 v78, s46, v110
v_mul_f32 v79, s46, v111
v_exp_f32 v72, v72
v_exp_f32 v73, v73
v_exp_f32 v74, v74
v_exp_f32 v75, v75
v_exp_f32 v76, v76
v_exp_f32 v77, v77
v_exp_f32 v78, v78
v_exp_f32 v79, v79
v_add_f32 v72, 1.0, v72
v_add_f32 v73, 1.0, v73
v_add_f32 v74, 1.0, v74
v_add_f32 v75, 1.0, v75
v_add_f32 v76, 1.0, v76
v_add_f32 v77, 1.0, v77
v_add_f32 v78, 1.0, v78
v_add_f32 v79, 1.0, v79
v_rcp_f32 v72, v72
v_rcp_f32 v73, v73
v_rcp_f32 v74, v74
v_rcp_f32 v75, v75
v_rcp_f32 v76, v76
v_rcp_f32 v77, v77
v_rcp_f32 v78, v78
v_rcp_f32 v79, v79
s_cmp_eq_u32 s29, 3
s_cbranch_scc1 L_o_g
v_mul_f32 v104, v104, v72
v_mul_f32 v105, v105, v73
v_mul_f32 v106, v106, v74
v_mul_f32 v107, v107, v75
v_mul_f32 v108, v108, v76
v_mul_f32 v109, v109, v77
v_mul_f32 v110, v110, v78
v_mul_f32 v111, v111, v79
v_cvt_pk_bf16_f32 v80, v104, v105
v_cvt_pk_bf16_f32 v81, v106, v107
v_cvt_pk_bf16_f32 v82, v108, v109
v_cvt_pk_bf16_f32 v83, v110, v111
s_cmp_eq_u32 s29, 2
s_cbranch_scc1 L_o_h2
ds_write_b64 v6, v[80:81] offset:0
ds_write_b64 v6, v[82:83] offset:1024
s_branch L_o_hdone
L_o_h2:
ds_write_b64 v7, v[80:81] offset:0
ds_write_b64 v7, v[82:83] offset:512
s_branch L_o_hdone
L_o_g:
v_cmp_gt_u32 vcc, 16, v0
s_and_saveexec_b64 s[36:37], vcc
ds_write_b32 v17, v72
ds_write_b32 v17, v76 offset:64
s_mov_b64 exec, s[36:37]
L_o_hdone:
s_waitcnt lgkmcnt(0)
s_barrier
s_and_b32 s47, s54, 3
s_mul_i32 s46, s54, 171
s_lshr_b32 s46, s46, 9
s_mul_i32 s47, s46, 3
s_sub_u32 s47, s54, s47
s_add_u32 s46, s46, 1
s_lshl_b32 s47, s47, 2
s_lshl_b32 s50, s32, 7
s_add_u32 s47, s47, s50
s_add_u32 s47, s47, 0
v_mov_b32 v112, s47
s_mov_b32 s45, 0
L_pl_4:
global_load_dword v113, v112, s[26:27] sc1
s_add_u32 s45, s45, 1
s_waitcnt vmcnt(0)
v_readfirstlane_b32 s44, v113
s_cmp_ge_u32 s44, s46
s_cbranch_scc1 L_plo_5
s_cmp_lt_u32 s45, 300000
s_cbranch_scc1 L_pl_4
L_plo_5:
s_lshl_b32 s50, s54, 18
s_lshl_b32 s51, s32, 13
s_add_u32 s50, s50, s51
s_add_u32 s50, s50, 1048576
s_add_u32 s50, s26, s50
s_addc_u32 s51, s27, 0
s_add_u32 s52, s50, 16777216
s_addc_u32 s53, s51, 0
s_lshl_b32 s46, s29, 11
s_add_u32 s46, s46, s55
s_mov_b32 m0, s46
s_nop 0
global_load_lds_dwordx4 v19, s[50:51] sc1
global_load_lds_dwordx4 v19, s[50:51] offset:1024 sc1
s_add_u32 m0, s46, 8192
s_nop 0
global_load_lds_dwordx4 v19, s[52:53] sc1
global_load_lds_dwordx4 v19, s[52:53] offset:1024 sc1
ds_read_b128 v[40:43], v140 offset:0
ds_read_b64 v[48:49], v8 offset:0
ds_read_b32 v52, v9 offset:0
ds_read_b128 v[44:47], v140 offset:1024
ds_read_b64 v[50:51], v8 offset:512
ds_read_b32 v53, v9 offset:64
ds_read_b32 v54, v139
s_waitcnt lgkmcnt(0)
v_mfma_f32_16x16x32_bf16 v[144:147], v[208:211], v[40:43], 0
v_mfma_f32_16x16x32_bf16 v[148:151], v[208:211], v[44:47], 0
v_mfma_f32_16x16x32_bf16 v[152:155], v[214:217], v[40:43], 0
v_mfma_f32_16x16x32_bf16 v[156:159], v[214:217], v[44:47], 0
v_mfma_f32_16x16x32_bf16 v[160:163], v[220:223], v[40:43], 0
v_mfma_f32_16x16x32_bf16 v[164:167], v[220:223], v[44:47], 0
v_mfma_f32_16x16x32_bf16 v[168:171], v[226:229], v[40:43], 0
v_mfma_f32_16x16x32_bf16 v[172:175], v[226:229], v[44:47], 0
v_mfma_f32_16x16x32_bf16 v[176:179], v[232:235], v[40:43], 0
v_mfma_f32_16x16x32_bf16 v[180:183], v[232:235], v[44:47], 0
v_mfma_f32_16x16x32_bf16 v[184:187], v[238:241], v[40:43], 0
v_mfma_f32_16x16x32_bf16 v[188:191], v[238:241], v[44:47], 0
v_mfma_f32_16x16x32_bf16 v[192:195], v[244:247], v[40:43], 0
v_mfma_f32_16x16x32_bf16 v[196:199], v[244:247], v[44:47], 0
v_mfma_f32_16x16x32_bf16 v[200:203], v[250:253], v[40:43], 0
v_mfma_f32_16x16x32_bf16 v[204:207], v[250:253], v[44:47], 0
v_mfma_f32_16x16x16_bf16 v[144:147], v[212:213], v[48:49], v[144:147]
v_mfma_f32_16x16x16_bf16 v[148:151], v[212:213], v[50:51], v[148:151]
v_mfma_f32_16x16x16_bf16 v[152:155], v[218:219], v[48:49], v[152:155]
v_mfma_f32_16x16x16_bf16 v[156:159], v[218:219], v[50:51], v[156:159]
v_mfma_f32_16x16x16_bf16 v[160:163], v[224:225], v[48:49], v[160:163]
v_mfma_f32_16x16x16_bf16 v[164:167], v[224:225], v[50:51], v[164:167]
v_mfma_f32_16x16x16_bf16 v[168:171], v[230:231], v[48:49], v[168:171]
v_mfma_f32_16x16x16_bf16 v[172:175], v[230:231], v[50:51], v[172:175]
v_mfma_f32_16x16x16_bf16 v[176:179], v[236:237], v[48:49], v[176:179]
v_mfma_f32_16x16x16_bf16 v[180:183], v[236:237], v[50:51], v[180:183]
v_mfma_f32_16x16x16_bf16 v[184:187], v[242:243], v[48:49], v[184:187]
v_mfma_f32_16x16x16_bf16 v[188:191], v[242:243], v[50:51], v[188:191]
v_mfma_f32_16x16x16_bf16 v[192:195], v[248:249], v[48:49], v[192:195]
v_mfma_f32_16x16x16_bf16 v[196:199], v[248:249], v[50:51], v[196:199]
v_mfma_f32_16x16x16_bf16 v[200:203], v[254:255], v[48:49], v[200:203]
v_mfma_f32_16x16x16_bf16 v[204:207], v[254:255], v[50:51], v[204:207]
v_sub_f32 v52, 1.0, v52
v_sub_f32 v53, 1.0, v53
v_mul_f32 v144, v144, v52
v_mul_f32 v145, v145, v52
v_mul_f32 v146, v146, v52
v_mul_f32 v147, v147, v52
v_mul_f32 v148, v148, v53
v_mul_f32 v149, v149, v53
v_mul_f32 v150, v150, v53
v_mul_f32 v151, v151, v53
v_mul_f32 v152, v152, v52
v_mul_f32 v153, v153, v52
v_mul_f32 v154, v154, v52
v_mul_f32 v155, v155, v52
v_mul_f32 v156, v156, v53
v_mul_f32 v157, v157, v53
v_mul_f32 v158, v158, v53
v_mul_f32 v159, v159, v53
v_mul_f32 v160, v160, v52
v_mul_f32 v161, v161, v52
v_mul_f32 v162, v162, v52
v_mul_f32 v163, v163, v52
v_mul_f32 v164, v164, v53
v_mul_f32 v165, v165, v53
v_mul_f32 v166, v166, v53
v_mul_f32 v167, v167, v53
v_mul_f32 v168, v168, v52
v_mul_f32 v169, v169, v52
v_mul_f32 v170, v170, v52
v_mul_f32 v171, v171, v52
v_mul_f32 v172, v172, v53
v_mul_f32 v173, v173, v53
v_mul_f32 v174, v174, v53
v_mul_f32 v175, v175, v53
v_mul_f32 v176, v176, v52
v_mul_f32 v177, v177, v52
v_mul_f32 v178, v178, v52
v_mul_f32 v179, v179, v52
v_mul_f32 v180, v180, v53
v_mul_f32 v181, v181, v53
v_mul_f32 v182, v182, v53
v_mul_f32 v183, v183, v53
v_mul_f32 v184, v184, v52
v_mul_f32 v185, v185, v52
v_mul_f32 v186, v186, v52
v_mul_f32 v187, v187, v52
v_mul_f32 v188, v188, v53
v_mul_f32 v189, v189, v53
v_mul_f32 v190, v190, v53
v_mul_f32 v191, v191, v53
v_mul_f32 v192, v192, v52
v_mul_f32 v193, v193, v52
v_mul_f32 v194, v194, v52
v_mul_f32 v195, v195, v52
v_mul_f32 v196, v196, v53
v_mul_f32 v197, v197, v53
v_mul_f32 v198, v198, v53
v_mul_f32 v199, v199, v53
v_mul_f32 v200, v200, v52
v_mul_f32 v201, v201, v52
v_mul_f32 v202, v202, v52
v_mul_f32 v203, v203, v52
v_mul_f32 v204, v204, v53
v_mul_f32 v205, v205, v53
v_mul_f32 v206, v206, v53
v_mul_f32 v207, v207, v53
s_cmp_lt_u32 s56, 1
s_cbranch_scc1 L_o_nored0
s_sub_u32 s78, s54, 4
s_mov_b32 s79, s56
s_lshl_b32 s34, s33, 7
s_add_u32 s34, s34, 8192
v_and_b32 v112, 31, v0
v_lshlrev_b32 v112, 2, v112
v_add_u32 v112, s34, v112
s_mov_b32 s45, 0
L_o_rpa:
global_load_dword v113, v112, s[26:27] sc1
s_add_u32 s45, s45, 1
s_waitcnt vmcnt(0)
v_cmp_gt_u32 vcc, s79, v113
s_cbranch_vccz L_o_roka
s_cmp_lt_u32 s45, 300000
s_cbranch_scc1 L_o_rpa
L_o_roka:
s_lshl_b32 s50, s78, 20
s_add_u32 s50, s50, 67108864
s_add_u32 s50, s26, s50
s_addc_u32 s51, s27, 0
global_load_dwordx4 v[56:59], v15, s[50:51] sc1
s_add_u32 s50, s50, 4096
s_addc_u32 s51, s51, 0
global_load_dwordx4 v[60:63], v15, s[50:51] sc1
s_add_u32 s50, s50, 4096
s_addc_u32 s51, s51, 0
global_load_dwordx4 v[64:67], v15, s[50:51] sc1
s_add_u32 s50, s50, 4096
s_addc_u32 s51, s51, 0
global_load_dwordx4 v[68:71], v15, s[50:51] sc1
s_add_u32 s50, s50, 4096
s_addc_u32 s51, s51, 0
global_load_dwordx4 v[72:75], v15, s[50:51] sc1
s_add_u32 s50, s50, 4096
s_addc_u32 s51, s51, 0
global_load_dwordx4 v[76:79], v15, s[50:51] sc1
s_add_u32 s50, s50, 4096
s_addc_u32 s51, s51, 0
global_load_dwordx4 v[80:83], v15, s[50:51] sc1
s_add_u32 s50, s50, 4096
s_addc_u32 s51, s51, 0
global_load_dwordx4 v[84:87], v15, s[50:51] sc1
s_waitcnt vmcnt(7)
v_mfma_f32_16x16x32_bf16 v[88:91], v[36:39], v[56:59], 0
s_waitcnt vmcnt(6)
v_mfma_f32_16x16x32_bf16 v[88:91], v[36:39], v[60:63], v[88:91]
s_waitcnt vmcnt(5)
v_mfma_f32_16x16x32_bf16 v[88:91], v[36:39], v[64:67], v[88:91]
s_waitcnt vmcnt(4)
v_mfma_f32_16x16x32_bf16 v[88:91], v[36:39], v[68:71], v[88:91]
s_waitcnt vmcnt(3)
v_mfma_f32_16x16x32_bf16 v[88:91], v[36:39], v[72:75], v[88:91]
s_waitcnt vmcnt(2)
v_mfma_f32_16x16x32_bf16 v[88:91], v[36:39], v[76:79], v[88:91]
s_waitcnt vmcnt(1)
v_mfma_f32_16x16x32_bf16 v[88:91], v[36:39], v[80:83], v[88:91]
s_waitcnt vmcnt(0)
v_mfma_f32_16x16x32_bf16 v[88:91], v[36:39], v[84:87], v[88:91]
s_nop 7
v_cvt_pk_bf16_f32 v88, v88, v89
v_cvt_pk_bf16_f32 v89, v90, v91
s_lshl_b32 s50, s78, 15
s_add_u32 s50, s22, s50
s_addc_u32 s51, s23, 0
s_mov_b64 exec, s[60:61]
global_store_dwordx2 v16, v[88:89], s[50:51]
s_mov_b64 exec, -1
L_o_nored0:
s_cmp_ge_u32 s54, 62
s_cbranch_scc1 L_o_nochw
s_lshl_b32 s47, s32, 7
s_add_u32 s47, s47, 4096
s_add_u32 s46, s54, 1
v_mov_b32 v112, s47
s_mov_b32 s45, 0
L_pl_6:
global_load_dword v113, v112, s[26:27] sc1
s_add_u32 s45, s45, 1
s_waitcnt vmcnt(0)
v_readfirstlane_b32 s44, v113
s_cmp_ge_u32 s44, s46
s_cbranch_scc1 L_plo_7
s_cmp_lt_u32 s45, 300000
s_cbranch_scc1 L_pl_6
L_plo_7:
L_o_nochw:
s_lshl_b32 s50, s54, 16
s_lshl_b32 s51, s32, 11
s_add_u32 s50, s50, s51
s_and_b32 s51, s29, 1
s_lshl_b32 s51, s51, 10
s_add_u32 s50, s50, s51
s_cmp_lt_u32 s29, 2
s_mov_b32 s51, 38797312
s_mov_b32 s52, 34603008
s_cselect_b32 s51, s52, s51
s_add_u32 s50, s50, s51
s_add_u32 s50, s26, s50
s_addc_u32 s51, s27, 0
s_lshl_b32 s46, s29, 10
s_add_u32 s46, s46, s55
s_cmp_ge_u32 s54, 62
s_cbranch_scc0 L_o_kmdma
s_add_u32 s46, s46, 16384
v_add_u32 v114, s46, v5
global_load_dwordx4 v[40:43], v5, s[50:51] sc1
s_nop 7
s_nop 7
s_nop 7
s_nop 7
s_nop 7
s_nop 7
s_nop 7
s_nop 7
s_nop 7
s_nop 7
s_nop 7
s_nop 7
s_nop 7
s_nop 7
s_nop 7
s_nop 7
s_nop 7
s_nop 7
s_nop 7
s_nop 7
s_nop 7
s_nop 7
s_nop 7
s_nop 7
s_nop 7
s_nop 7
s_nop 7
s_nop 7
s_nop 7
s_nop 7
s_nop 7
s_nop 7
s_nop 7
s_nop 7
s_nop 7
s_nop 7
s_nop 7
s_nop 7
s_nop 7
s_nop 7
s_nop 7
s_nop 7
s_nop 7
s_nop 5
global_load_dwordx4 v[44:47], v5, s[50:51] sc1
s_mov_b32 s45, 0
L_o_kdp:
s_waitcnt vmcnt(1)
v_max_u32 v112, v40, v42
v_cmp_eq_u32 vcc, -1, v112
s_cbranch_vccz L_o_kgot0
global_load_dwordx4 v[40:43], v5, s[50:51] sc1
s_waitcnt vmcnt(1)
v_max_u32 v112, v44, v46
v_cmp_eq_u32 vcc, -1, v112
s_cbranch_vccz L_o_kgot1
global_load_dwordx4 v[44:47], v5, s[50:51] sc1
s_add_u32 s45, s45, 1
s_cmp_lt_u32 s45, 300000
s_cbranch_scc1 L_o_kdp
s_waitcnt vmcnt(1)
L_o_kgot0:
ds_write_b128 v114, v[40:43]
s_waitcnt lgkmcnt(0)
s_branch L_o_kmok
L_o_kgot1:
ds_write_b128 v114, v[44:47]
s_waitcnt lgkmcnt(0)
s_branch L_o_kmok
L_o_kmdma:
s_add_u32 m0, s46, 16384
s_nop 0
global_load_lds_dwordx4 v5, s[50:51] sc1
s_waitcnt vmcnt(0)
L_o_kmok:
s_barrier
v_add_u32 v132, s55, v5
v_add_u32 v133, s55, v10
v_add_u32 v134, s55, v11
v_add_u32 v135, s55, v12
ds_read_b128 v[56:59], v18 offset:0
ds_read_b128 v[104:107], v133 offset:0
ds_read_b128 v[72:75], v132 offset:0
ds_read_b128 v[76:79], v132 offset:1024
ds_read_b128 v[60:63], v18 offset:2048
ds_read_b128 v[108:111], v133 offset:512
ds_read_b128 v[80:83], v132 offset:2048
ds_read_b128 v[84:87], v132 offset:3072
ds_read_b128 v[64:67], v18 offset:4096
ds_read_b128 v[112:115], v133 offset:1024
ds_read_b128 v[88:91], v132 offset:4096
ds_read_b128 v[92:95], v132 offset:5120
ds_read_b128 v[68:71], v18 offset:6144
ds_read_b128 v[116:119], v133 offset:1536
ds_read_b128 v[96:99], v132 offset:6144
ds_read_b128 v[100:103], v132 offset:7168
s_waitcnt lgkmcnt(0)
v_mfma_f32_16x16x32_bf16 v[120:123], v[104:107], v[56:59], v[20:23]
v_mfma_f32_16x16x32_bf16 v[124:127], v[72:75], v[56:59], v[24:27]
v_mfma_f32_16x16x32_bf16 v[128:131], v[76:79], v[56:59], v[28:31]
v_mfma_f32_16x16x32_bf16 v[120:123], v[108:111], v[60:63], v[120:123]
v_mfma_f32_16x16x32_bf16 v[124:127], v[80:83], v[60:63], v[124:127]
v_mfma_f32_16x16x32_bf16 v[128:131], v[84:87], v[60:63], v[128:131]
v_mfma_f32_16x16x32_bf16 v[120:123], v[112:115], v[64:67], v[120:123]
v_mfma_f32_16x16x32_bf16 v[124:127], v[88:91], v[64:67], v[124:127]
v_mfma_f32_16x16x32_bf16 v[128:131], v[92:95], v[64:67], v[128:131]
v_mfma_f32_16x16x32_bf16 v[120:123], v[116:119], v[68:71], v[120:123]
v_mfma_f32_16x16x32_bf16 v[124:127], v[96:99], v[68:71], v[124:127]
v_mfma_f32_16x16x32_bf16 v[128:131], v[100:103], v[68:71], v[128:131]
ds_read_b128 v[56:59], v134 offset:0
ds_read_b128 v[60:63], v134 offset:1024
ds_read_b64 v[48:49], v135 offset:0
ds_read_b128 v[64:67], v134 offset:2048
ds_read_b128 v[68:71], v134 offset:3072
ds_read_b64 v[50:51], v135 offset:512
s_mov_b32 s46, 0x3e0293ee
v_max3_f32 v132, v124, v125, v126
v_max3_f32 v132, v132, v127, v128
v_max3_f32 v132, v132, v129, v130
v_max3_f32 v132, v132, v131, v120
v_max3_f32 v132, v132, v121, v122
v_max_f32 v132, v132, v123
v_mov_b32 v133, v132
s_nop 1
v_permlane32_swap_b32 v132, v133
v_max_f32 v132, v132, v133
v_mov_b32 v133, v132
s_nop 1
v_permlane16_swap_b32 v132, v133
v_max_f32 v132, v132, v133
v_mul_f32 v134, s46, v132
v_sub_f32 v134, 0, v134
v_fma_f32 v120, v120, s46, v134
v_fma_f32 v121, v121, s46, v134
v_fma_f32 v122, v122, s46, v134
v_fma_f32 v123, v123, s46, v134
v_fma_f32 v124, v124, s46, v134
v_fma_f32 v125, v125, s46, v134
v_fma_f32 v126, v126, s46, v134
v_fma_f32 v127, v127, s46, v134
v_fma_f32 v128, v128, s46, v134
v_fma_f32 v129, v129, s46, v134
v_fma_f32 v130, v130, s46, v134
v_fma_f32 v131, v131, s46, v134
v_exp_f32 v120, v120
v_exp_f32 v121, v121
v_exp_f32 v122, v122
v_exp_f32 v123, v123
v_exp_f32 v124, v124
v_exp_f32 v125, v125
v_exp_f32 v126, v126
v_exp_f32 v127, v127
v_exp_f32 v128, v128
v_exp_f32 v129, v129
v_exp_f32 v130, v130
v_exp_f32 v131, v131
v_cvt_pk_bf16_f32 v72, v124, v125
v_cvt_pk_bf16_f32 v73, v126, v127
v_cvt_pk_bf16_f32 v74, v128, v129
v_cvt_pk_bf16_f32 v75, v130, v131
v_cvt_pk_bf16_f32 v76, v120, v121
v_cvt_pk_bf16_f32 v77, v122, v123
v_mov_b32 v120, v76
v_mov_b32 v121, v77
v_mov_b32 v78, 0
v_mov_b32 v79, 0
s_nop 0
v_permlane32_swap_b32 v78, v120
v_permlane32_swap_b32 v79, v121
s_waitcnt lgkmcnt(0)
v_mfma_f32_16x16x32_bf16 v[80:83], v[56:59], v[72:75], 0
v_mfma_f32_16x16x32_bf16 v[84:87], v[60:63], v[72:75], 0
v_mfma_f32_16x16x32_bf16 v[88:91], v[64:67], v[72:75], 0
v_mfma_f32_16x16x32_bf16 v[92:95], v[68:71], v[72:75], 0
v_mfma_f32_16x16x32_bf16 v[96:99], v[32:35], v[72:75], 0
v_mfma_f32_16x16x16_bf16 v[80:83], v[48:49], v[76:77], v[80:83]
v_mfma_f32_16x16x16_bf16 v[84:87], v[48:49], v[78:79], v[84:87]
v_mfma_f32_16x16x16_bf16 v[88:91], v[50:51], v[76:77], v[88:91]
v_mfma_f32_16x16x16_bf16 v[92:95], v[50:51], v[78:79], v[92:95]
v_mfma_f32_16x16x16_bf16 v[96:99], v[32:33], v[76:77], v[96:99]
s_nop 7
v_rcp_f32 v96, v96
s_nop 0
v_mul_f32 v96, v96, v54
v_mul_f32 v80, v80, v96
v_mul_f32 v81, v81, v96
v_mul_f32 v82, v82, v96
v_mul_f32 v83, v83, v96
v_mul_f32 v84, v84, v96
v_mul_f32 v85, v85, v96
v_mul_f32 v86, v86, v96
v_mul_f32 v87, v87, v96
v_mul_f32 v88, v88, v96
v_mul_f32 v89, v89, v96
v_mul_f32 v90, v90, v96
v_mul_f32 v91, v91, v96
v_mul_f32 v92, v92, v96
v_mul_f32 v93, v93, v96
v_mul_f32 v94, v94, v96
v_mul_f32 v95, v95, v96
v_cvt_pk_bf16_f32 v100, v80, v81
v_cvt_pk_bf16_f32 v101, v82, v83
v_cvt_pk_bf16_f32 v102, v84, v85
v_cvt_pk_bf16_f32 v103, v86, v87
ds_write_b128 v13, v[100:103] offset:0
v_cvt_pk_bf16_f32 v104, v88, v89
v_cvt_pk_bf16_f32 v105, v90, v91
v_cvt_pk_bf16_f32 v106, v92, v93
v_cvt_pk_bf16_f32 v107, v94, v95
ds_write_b128 v13, v[104:107] offset:1024
s_waitcnt lgkmcnt(0)
s_barrier
ds_read_b128 v[56:59], v141 offset:0
ds_read_b128 v[60:63], v141 offset:1024
ds_read_b128 v[64:67], v141 offset:2048
ds_read_b128 v[68:71], v141 offset:3072
ds_read_b128 v[72:75], v141 offset:4096
ds_read_b128 v[76:79], v141 offset:5120
ds_read_b128 v[80:83], v141 offset:6144
ds_read_b128 v[84:87], v141 offset:7168
s_waitcnt lgkmcnt(0)
v_mfma_f32_16x16x32_bf16 v[144:147], a[128:131], v[56:59], v[144:147]
v_mfma_f32_16x16x32_bf16 v[148:151], a[128:131], v[72:75], v[148:151]
v_mfma_f32_16x16x32_bf16 v[152:155], a[144:147], v[56:59], v[152:155]
v_mfma_f32_16x16x32_bf16 v[156:159], a[144:147], v[72:75], v[156:159]
v_mfma_f32_16x16x32_bf16 v[160:163], a[160:163], v[56:59], v[160:163]
v_mfma_f32_16x16x32_bf16 v[164:167], a[160:163], v[72:75], v[164:167]
v_mfma_f32_16x16x32_bf16 v[168:171], a[176:179], v[56:59], v[168:171]
v_mfma_f32_16x16x32_bf16 v[172:175], a[176:179], v[72:75], v[172:175]
v_mfma_f32_16x16x32_bf16 v[176:179], a[192:195], v[56:59], v[176:179]
v_mfma_f32_16x16x32_bf16 v[180:183], a[192:195], v[72:75], v[180:183]
v_mfma_f32_16x16x32_bf16 v[184:187], a[208:211], v[56:59], v[184:187]
v_mfma_f32_16x16x32_bf16 v[188:191], a[208:211], v[72:75], v[188:191]
v_mfma_f32_16x16x32_bf16 v[192:195], a[224:227], v[56:59], v[192:195]
v_mfma_f32_16x16x32_bf16 v[196:199], a[224:227], v[72:75], v[196:199]
v_mfma_f32_16x16x32_bf16 v[200:203], a[240:243], v[56:59], v[200:203]
v_mfma_f32_16x16x32_bf16 v[204:207], a[240:243], v[72:75], v[204:207]
v_mfma_f32_16x16x32_bf16 v[144:147], a[132:135], v[60:63], v[144:147]
v_mfma_f32_16x16x32_bf16 v[148:151], a[132:135], v[76:79], v[148:151]
v_mfma_f32_16x16x32_bf16 v[152:155], a[148:151], v[60:63], v[152:155]
v_mfma_f32_16x16x32_bf16 v[156:159], a[148:151], v[76:79], v[156:159]
v_mfma_f32_16x16x32_bf16 v[160:163], a[164:167], v[60:63], v[160:163]
v_mfma_f32_16x16x32_bf16 v[164:167], a[164:167], v[76:79], v[164:167]
v_mfma_f32_16x16x32_bf16 v[168:171], a[180:183], v[60:63], v[168:171]
v_mfma_f32_16x16x32_bf16 v[172:175], a[180:183], v[76:79], v[172:175]
v_mfma_f32_16x16x32_bf16 v[176:179], a[196:199], v[60:63], v[176:179]
v_mfma_f32_16x16x32_bf16 v[180:183], a[196:199], v[76:79], v[180:183]
v_mfma_f32_16x16x32_bf16 v[184:187], a[212:215], v[60:63], v[184:187]
v_mfma_f32_16x16x32_bf16 v[188:191], a[212:215], v[76:79], v[188:191]
v_mfma_f32_16x16x32_bf16 v[192:195], a[228:231], v[60:63], v[192:195]
v_mfma_f32_16x16x32_bf16 v[196:199], a[228:231], v[76:79], v[196:199]
v_mfma_f32_16x16x32_bf16 v[200:203], a[244:247], v[60:63], v[200:203]
v_mfma_f32_16x16x32_bf16 v[204:207], a[244:247], v[76:79], v[204:207]
v_mfma_f32_16x16x32_bf16 v[144:147], a[136:139], v[64:67], v[144:147]
v_mfma_f32_16x16x32_bf16 v[148:151], a[136:139], v[80:83], v[148:151]
v_mfma_f32_16x16x32_bf16 v[152:155], a[152:155], v[64:67], v[152:155]
v_mfma_f32_16x16x32_bf16 v[156:159], a[152:155], v[80:83], v[156:159]
v_mfma_f32_16x16x32_bf16 v[160:163], a[168:171], v[64:67], v[160:163]
v_mfma_f32_16x16x32_bf16 v[164:167], a[168:171], v[80:83], v[164:167]
v_mfma_f32_16x16x32_bf16 v[168:171], a[184:187], v[64:67], v[168:171]
v_mfma_f32_16x16x32_bf16 v[172:175], a[184:187], v[80:83], v[172:175]
v_mfma_f32_16x16x32_bf16 v[176:179], a[200:203], v[64:67], v[176:179]
v_mfma_f32_16x16x32_bf16 v[180:183], a[200:203], v[80:83], v[180:183]
v_mfma_f32_16x16x32_bf16 v[184:187], a[216:219], v[64:67], v[184:187]
v_mfma_f32_16x16x32_bf16 v[188:191], a[216:219], v[80:83], v[188:191]
v_mfma_f32_16x16x32_bf16 v[192:195], a[232:235], v[64:67], v[192:195]
v_mfma_f32_16x16x32_bf16 v[196:199], a[232:235], v[80:83], v[196:199]
v_mfma_f32_16x16x32_bf16 v[200:203], a[248:251], v[64:67], v[200:203]
v_mfma_f32_16x16x32_bf16 v[204:207], a[248:251], v[80:83], v[204:207]
v_mfma_f32_16x16x32_bf16 v[144:147], a[140:143], v[68:71], v[144:147]
v_mfma_f32_16x16x32_bf16 v[148:151], a[140:143], v[84:87], v[148:151]
v_mfma_f32_16x16x32_bf16 v[152:155], a[156:159], v[68:71], v[152:155]
v_mfma_f32_16x16x32_bf16 v[156:159], a[156:159], v[84:87], v[156:159]
v_mfma_f32_16x16x32_bf16 v[160:163], a[172:175], v[68:71], v[160:163]
v_mfma_f32_16x16x32_bf16 v[164:167], a[172:175], v[84:87], v[164:167]
v_mfma_f32_16x16x32_bf16 v[168:171], a[188:191], v[68:71], v[168:171]
v_mfma_f32_16x16x32_bf16 v[172:175], a[188:191], v[84:87], v[172:175]
v_mfma_f32_16x16x32_bf16 v[176:179], a[204:207], v[68:71], v[176:179]
v_mfma_f32_16x16x32_bf16 v[180:183], a[204:207], v[84:87], v[180:183]
v_mfma_f32_16x16x32_bf16 v[184:187], a[220:223], v[68:71], v[184:187]
v_mfma_f32_16x16x32_bf16 v[188:191], a[220:223], v[84:87], v[188:191]
v_mfma_f32_16x16x32_bf16 v[192:195], a[236:239], v[68:71], v[192:195]
v_mfma_f32_16x16x32_bf16 v[196:199], a[236:239], v[84:87], v[196:199]
v_mfma_f32_16x16x32_bf16 v[200:203], a[252:255], v[68:71], v[200:203]
v_mfma_f32_16x16x32_bf16 v[204:207], a[252:255], v[84:87], v[204:207]
v_cvt_pk_bf16_f32 v88, v144, v145
v_cvt_pk_bf16_f32 v89, v146, v147
v_cvt_pk_bf16_f32 v90, v152, v153
v_cvt_pk_bf16_f32 v91, v154, v155
v_cvt_pk_bf16_f32 v92, v160, v161
v_cvt_pk_bf16_f32 v93, v162, v163
v_cvt_pk_bf16_f32 v94, v168, v169
v_cvt_pk_bf16_f32 v95, v170, v171
v_cvt_pk_bf16_f32 v96, v176, v177
v_cvt_pk_bf16_f32 v97, v178, v179
v_cvt_pk_bf16_f32 v98, v184, v185
v_cvt_pk_bf16_f32 v99, v186, v187
v_cvt_pk_bf16_f32 v100, v192, v193
v_cvt_pk_bf16_f32 v101, v194, v195
v_cvt_pk_bf16_f32 v102, v200, v201
v_cvt_pk_bf16_f32 v103, v202, v203
v_cvt_pk_bf16_f32 v104, v148, v149
v_cvt_pk_bf16_f32 v105, v150, v151
v_cvt_pk_bf16_f32 v106, v156, v157
v_cvt_pk_bf16_f32 v107, v158, v159
v_cvt_pk_bf16_f32 v108, v164, v165
v_cvt_pk_bf16_f32 v109, v166, v167
v_cvt_pk_bf16_f32 v110, v172, v173
v_cvt_pk_bf16_f32 v111, v174, v175
v_cvt_pk_bf16_f32 v112, v180, v181
v_cvt_pk_bf16_f32 v113, v182, v183
v_cvt_pk_bf16_f32 v114, v188, v189
v_cvt_pk_bf16_f32 v115, v190, v191
v_cvt_pk_bf16_f32 v116, v196, v197
v_cvt_pk_bf16_f32 v117, v198, v199
v_cvt_pk_bf16_f32 v118, v204, v205
v_cvt_pk_bf16_f32 v119, v206, v207
s_lshl_b32 s50, s54, 20
s_add_u32 s50, s50, 67108864
s_add_u32 s50, s26, s50
s_addc_u32 s51, s27, 0
s_add_u32 s52, s50, 0
s_addc_u32 s53, s51, 0
global_store_dwordx4 v14, v[88:91], s[52:53] sc1
s_add_u32 s52, s50, 32768
s_addc_u32 s53, s51, 0
global_store_dwordx4 v14, v[92:95], s[52:53] sc1
s_add_u32 s52, s50, 65536
s_addc_u32 s53, s51, 0
global_store_dwordx4 v14, v[96:99], s[52:53] sc1
s_add_u32 s52, s50, 98304
s_addc_u32 s53, s51, 0
global_store_dwordx4 v14, v[100:103], s[52:53] sc1
s_add_u32 s52, s50, 524288
s_addc_u32 s53, s51, 0
global_store_dwordx4 v14, v[104:107], s[52:53] sc1
s_add_u32 s52, s50, 557056
s_addc_u32 s53, s51, 0
global_store_dwordx4 v14, v[108:111], s[52:53] sc1
s_add_u32 s52, s50, 589824
s_addc_u32 s53, s51, 0
global_store_dwordx4 v14, v[112:115], s[52:53] sc1
s_add_u32 s52, s50, 622592
s_addc_u32 s53, s51, 0
global_store_dwordx4 v14, v[116:119], s[52:53] sc1
s_cmp_eq_u32 s56, 0
s_cbranch_scc0 L_o_nplp
s_add_u32 s46, s33, 60
s_cmp_ge_u32 s46, 62
s_cbranch_scc0 L_o_nplp
s_lshl_b32 s50, s46, 20
s_add_u32 s50, s50, 67108864
s_add_u32 s50, s26, s50
s_addc_u32 s51, s27, 0
v_mov_b64 v[56:57], -1
v_mov_b64 v[58:59], -1
s_add_u32 s52, s50, 0
s_addc_u32 s53, s51, 0
global_store_dwordx4 v14, v[56:59], s[52:53] sc1
s_add_u32 s52, s50, 32768
s_addc_u32 s53, s51, 0
global_store_dwordx4 v14, v[56:59], s[52:53] sc1
s_add_u32 s52, s50, 65536
s_addc_u32 s53, s51, 0
global_store_dwordx4 v14, v[56:59], s[52:53] sc1
s_add_u32 s52, s50, 98304
s_addc_u32 s53, s51, 0
global_store_dwordx4 v14, v[56:59], s[52:53] sc1
s_add_u32 s52, s50, 524288
s_addc_u32 s53, s51, 0
global_store_dwordx4 v14, v[56:59], s[52:53] sc1
s_add_u32 s52, s50, 557056
s_addc_u32 s53, s51, 0
global_store_dwordx4 v14, v[56:59], s[52:53] sc1
s_add_u32 s52, s50, 589824
s_addc_u32 s53, s51, 0
global_store_dwordx4 v14, v[56:59], s[52:53] sc1
s_add_u32 s52, s50, 622592
s_addc_u32 s53, s51, 0
global_store_dwordx4 v14, v[56:59], s[52:53] sc1
L_o_nplp:
s_add_u32 s56, s56, 1
s_cmp_ge_u32 s54, 62
s_cbranch_scc1 L_o_noflag
s_waitcnt vmcnt(0)
s_barrier
s_cmp_eq_u32 s29, 0
s_cbranch_scc0 L_o_noflag
s_lshl_b32 s34, s33, 7
s_lshl_b32 s35, s32, 2
s_add_u32 s34, s34, s35
s_add_u32 s34, s34, 8192
v_mov_b32 v112, s34
v_mov_b32 v113, s56
v_cmp_eq_u32 vcc, 0, v0
s_and_saveexec_b64 s[36:37], vcc
global_store_dword v112, v113, s[26:27] sc1
s_mov_b64 exec, s[36:37]
L_o_noflag:
s_mov_b32 s59, s54
s_mov_b32 s54, s57
s_mov_b32 s55, s58
s_cmp_lt_u32 s54, 64
s_cbranch_scc1 L_o_loop
s_cmp_lt_u32 s59, 62
s_cbranch_scc1 L_o_rflagb
s_lshl_b32 s50, s59, 20
s_add_u32 s50, s50, 67108864
s_add_u32 s62, s26, s50
s_addc_u32 s63, s27, 0
s_add_u32 s80, s62, 0x4000
s_addc_u32 s81, s63, 0
s_add_u32 s82, s62, 0x2000
s_addc_u32 s83, s63, 0
s_add_u32 s84, s62, 0x6000
s_addc_u32 s85, s63, 0
v_add_u32 v136, 0x1000, v15
global_load_dwordx4 v[56:59], v15, s[62:63] sc1
global_load_dwordx4 v[60:63], v136, s[62:63] sc1
global_load_dwordx4 v[64:67], v15, s[82:83] sc1
global_load_dwordx4 v[68:71], v136, s[82:83] sc1
global_load_dwordx4 v[72:75], v15, s[80:81] sc1
global_load_dwordx4 v[76:79], v136, s[80:81] sc1
global_load_dwordx4 v[80:83], v15, s[84:85] sc1
global_load_dwordx4 v[84:87], v136, s[84:85] sc1
s_nop 7
s_nop 7
s_nop 7
s_nop 7
s_nop 7
s_nop 7
s_nop 7
s_nop 7
s_nop 7
s_nop 7
s_nop 7
s_nop 7
s_nop 7
s_nop 7
s_nop 7
s_nop 7
s_nop 7
s_nop 7
s_nop 7
s_nop 7
s_nop 7
s_nop 7
s_nop 7
s_nop 7
s_nop 7
s_nop 7
s_nop 7
s_nop 7
s_nop 7
s_nop 7
s_nop 7
s_nop 7
s_nop 7
s_nop 7
s_nop 7
s_nop 7
s_nop 7
s_nop 7
s_nop 7
s_nop 7
s_nop 7
s_nop 7
s_nop 7
s_nop 5
global_load_dwordx4 v[92:95], v15, s[62:63] sc1
global_load_dwordx4 v[96:99], v136, s[62:63] sc1
global_load_dwordx4 v[100:103], v15, s[82:83] sc1
global_load_dwordx4 v[104:107], v136, s[82:83] sc1
global_load_dwordx4 v[108:111], v15, s[80:81] sc1
global_load_dwordx4 v[112:115], v136, s[80:81] sc1
global_load_dwordx4 v[116:119], v15, s[84:85] sc1
global_load_dwordx4 v[120:123], v136, s[84:85] sc1
s_mov_b32 s45, 0
L_o_rdpb:
s_waitcnt vmcnt(8)
v_max3_u32 v124, v56, v60, v64
v_max3_u32 v125, v68, v72, v76
v_max3_u32 v124, v124, v80, v84
v_max_u32 v124, v124, v125
v_cmp_eq_u32 vcc, -1, v124
s_cbranch_vccz L_o_rgot0b
global_load_dwordx4 v[56:59], v15, s[62:63] sc1
global_load_dwordx4 v[60:63], v136, s[62:63] sc1
global_load_dwordx4 v[64:67], v15, s[82:83] sc1
global_load_dwordx4 v[68:71], v136, s[82:83] sc1
global_load_dwordx4 v[72:75], v15, s[80:81] sc1
global_load_dwordx4 v[76:79], v136, s[80:81] sc1
global_load_dwordx4 v[80:83], v15, s[84:85] sc1
global_load_dwordx4 v[84:87], v136, s[84:85] sc1
s_waitcnt vmcnt(8)
v_max3_u32 v124, v92, v96, v100
v_max3_u32 v125, v104, v108, v112
v_max3_u32 v124, v124, v116, v120
v_max_u32 v124, v124, v125
v_cmp_eq_u32 vcc, -1, v124
s_cbranch_vccz L_o_rgot1b
global_load_dwordx4 v[92:95], v15, s[62:63] sc1
global_load_dwordx4 v[96:99], v136, s[62:63] sc1
global_load_dwordx4 v[100:103], v15, s[82:83] sc1
global_load_dwordx4 v[104:107], v136, s[82:83] sc1
global_load_dwordx4 v[108:111], v15, s[80:81] sc1
global_load_dwordx4 v[112:115], v136, s[80:81] sc1
global_load_dwordx4 v[116:119], v15, s[84:85] sc1
global_load_dwordx4 v[120:123], v136, s[84:85] sc1
s_add_u32 s45, s45, 1
s_cmp_lt_u32 s45, 100000
s_cbranch_scc1 L_o_rdpb
s_waitcnt vmcnt(8)
L_o_rgot0b:
v_mfma_f32_16x16x32_bf16 v[88:91], v[36:39], v[56:59], 0
v_mfma_f32_16x16x32_bf16 v[88:91], v[36:39], v[60:63], v[88:91]
v_mfma_f32_16x16x32_bf16 v[88:91], v[36:39], v[64:67], v[88:91]
v_mfma_f32_16x16x32_bf16 v[88:91], v[36:39], v[68:71], v[88:91]
v_mfma_f32_16x16x32_bf16 v[88:91], v[36:39], v[72:75], v[88:91]
v_mfma_f32_16x16x32_bf16 v[88:91], v[36:39], v[76:79], v[88:91]
v_mfma_f32_16x16x32_bf16 v[88:91], v[36:39], v[80:83], v[88:91]
v_mfma_f32_16x16x32_bf16 v[88:91], v[36:39], v[84:87], v[88:91]
s_branch L_o_rfinb
L_o_rgot1b:
v_mfma_f32_16x16x32_bf16 v[88:91], v[36:39], v[92:95], 0
v_mfma_f32_16x16x32_bf16 v[88:91], v[36:39], v[96:99], v[88:91]
v_mfma_f32_16x16x32_bf16 v[88:91], v[36:39], v[100:103], v[88:91]
v_mfma_f32_16x16x32_bf16 v[88:91], v[36:39], v[104:107], v[88:91]
v_mfma_f32_16x16x32_bf16 v[88:91], v[36:39], v[108:111], v[88:91]
v_mfma_f32_16x16x32_bf16 v[88:91], v[36:39], v[112:115], v[88:91]
v_mfma_f32_16x16x32_bf16 v[88:91], v[36:39], v[116:119], v[88:91]
v_mfma_f32_16x16x32_bf16 v[88:91], v[36:39], v[120:123], v[88:91]
s_branch L_o_rfinb
L_o_rflagb:
s_lshl_b32 s34, s33, 7
s_add_u32 s34, s34, 8192
v_and_b32 v112, 31, v0
v_lshlrev_b32 v112, 2, v112
v_add_u32 v112, s34, v112
s_mov_b32 s45, 0
L_o_rpb:
global_load_dword v113, v112, s[26:27] sc1
s_add_u32 s45, s45, 1
s_waitcnt vmcnt(0)
v_cmp_gt_u32 vcc, s56, v113
s_cbranch_vccz L_o_rokb
s_cmp_lt_u32 s45, 300000
s_cbranch_scc1 L_o_rpb
L_o_rokb:
s_lshl_b32 s50, s59, 20
s_add_u32 s50, s50, 67108864
s_add_u32 s50, s26, s50
s_addc_u32 s51, s27, 0
global_load_dwordx4 v[56:59], v15, s[50:51] sc1
s_add_u32 s50, s50, 4096
s_addc_u32 s51, s51, 0
global_load_dwordx4 v[60:63], v15, s[50:51] sc1
s_add_u32 s50, s50, 4096
s_addc_u32 s51, s51, 0
global_load_dwordx4 v[64:67], v15, s[50:51] sc1
s_add_u32 s50, s50, 4096
s_addc_u32 s51, s51, 0
global_load_dwordx4 v[68:71], v15, s[50:51] sc1
s_add_u32 s50, s50, 4096
s_addc_u32 s51, s51, 0
global_load_dwordx4 v[72:75], v15, s[50:51] sc1
s_add_u32 s50, s50, 4096
s_addc_u32 s51, s51, 0
global_load_dwordx4 v[76:79], v15, s[50:51] sc1
s_add_u32 s50, s50, 4096
s_addc_u32 s51, s51, 0
global_load_dwordx4 v[80:83], v15, s[50:51] sc1
s_add_u32 s50, s50, 4096
s_addc_u32 s51, s51, 0
global_load_dwordx4 v[84:87], v15, s[50:51] sc1
s_waitcnt vmcnt(7)
v_mfma_f32_16x16x32_bf16 v[88:91], v[36:39], v[56:59], 0
s_waitcnt vmcnt(6)
v_mfma_f32_16x16x32_bf16 v[88:91], v[36:39], v[60:63], v[88:91]
s_waitcnt vmcnt(5)
v_mfma_f32_16x16x32_bf16 v[88:91], v[36:39], v[64:67], v[88:91]
s_waitcnt vmcnt(4)
v_mfma_f32_16x16x32_bf16 v[88:91], v[36:39], v[68:71], v[88:91]
s_waitcnt vmcnt(3)
v_mfma_f32_16x16x32_bf16 v[88:91], v[36:39], v[72:75], v[88:91]
s_waitcnt vmcnt(2)
v_mfma_f32_16x16x32_bf16 v[88:91], v[36:39], v[76:79], v[88:91]
s_waitcnt vmcnt(1)
v_mfma_f32_16x16x32_bf16 v[88:91], v[36:39], v[80:83], v[88:91]
s_waitcnt vmcnt(0)
v_mfma_f32_16x16x32_bf16 v[88:91], v[36:39], v[84:87], v[88:91]
L_o_rfinb:
s_nop 7
v_cvt_pk_bf16_f32 v88, v88, v89
v_cvt_pk_bf16_f32 v89, v90, v91
s_lshl_b32 s50, s59, 15
s_add_u32 s50, s22, s50
s_addc_u32 s51, s23, 0
s_mov_b64 exec, s[60:61]
global_store_dwordx2 v16, v[88:89], s[50:51]
s_mov_b64 exec, -1
s_waitcnt vmcnt(0)
s_endpgm
L_exit:
s_endpgm
.section .rodata,"a"
.p2align 6
.amdhsa_kernel gated_mix__memory_aug_recurrent_mem_tr__dense_activation_silu__prompt_kernel
.amdhsa_next_free_vgpr 512
.amdhsa_next_free_sgpr 102
.amdhsa_accum_offset 256
.amdhsa_group_segment_fixed_size 0
.amdhsa_kernarg_size 112
.amdhsa_user_sgpr_count 2
.amdhsa_user_sgpr_kernarg_segment_ptr 1
.amdhsa_system_sgpr_workgroup_id_x 1
.end_amdhsa_kernel
```
